```python
import torch

def _softmax(x, axis=-1):
    return torch.softmax(x, dim=axis)
def _gelu(x):
    return torch.nn.functional.gelu(x, approximate="tanh")
def _silu(x):
    return torch.nn.functional.silu(x)
def _sigmoid(x):
    return torch.sigmoid(x)
def _layernorm(x, axis=-1, eps=1e-5):
    m = x.mean(dim=axis, keepdim=True)
    v = x.var(dim=axis, keepdim=True, unbiased=False)
    return (x - m) / torch.sqrt(v + eps)
def _scatter_add(tgt, idx, src, axis=0):
    return tgt.clone().index_add_(axis, idx, src)
def _segment_sum(src, seg, n):
    out = torch.zeros((n,) + src.shape[1:], dtype=src.dtype)
    return out.index_add_(0, seg, src)
def _pad(x, pw):
    flat = tuple(v for pair in reversed(pw) for v in pair)
    return torch.nn.functional.pad(x, flat)

kernel_name = 'parallel_sum__spectral_fnet__dense_activation_relu__prompt'

def setup_inputs():

    _w = (lambda a: (lambda t: t.to(torch.bfloat16) if t.is_floating_point() else t)(torch.as_tensor(a)))
    def _A_setup():
        B, S, D = 1, 2048, 448
        ns = torch.arange(S)[:, None] * torch.arange(S)[None, :]
        nd = torch.arange(D)[:, None] * torch.arange(D)[None, :]
        Ws_re = torch.cos(-2.0 * torch.pi * ns / S).to(float)
        Ws_im = torch.sin(-2.0 * torch.pi * ns / S).to(float)
        Wd_re = torch.cos(-2.0 * torch.pi * nd / D).to(float)
        Wd_im = torch.sin(-2.0 * torch.pi * nd / D).to(float)
        return {
            "x": _w((lambda *s: torch.randn(*s, dtype=torch.bfloat16) * 0.05)(B, S, D)),
            "dft_seq_re": _w(Ws_re),
            "dft_seq_im": _w(Ws_im),
            "dft_hid_re": _w(Wd_re),
            "dft_hid_im": _w(Wd_im),
        }
    _A_in = _A_setup()

    def _B_setup():
        B, S, D, Dff = 1, 2048, 448, 1792
        return {
            "x": _w((lambda *s: torch.randn(*s, dtype=torch.bfloat16) * 0.05)(B, S, D)),
            "w1": _w((lambda *s: torch.randn(*s, dtype=torch.bfloat16) * 0.4)(D, Dff)),
            "w2": _w((lambda *s: torch.randn(*s, dtype=torch.bfloat16) * 0.4)(Dff, D)),
        }
    _B_in = _B_setup()

    return {
        "A_x": _A_in["x"],
        "A_dft_seq_re": _A_in["dft_seq_re"],
        "A_dft_seq_im": _A_in["dft_seq_im"],
        "A_dft_hid_re": _A_in["dft_hid_re"],
        "A_dft_hid_im": _A_in["dft_hid_im"],
        "B_x": _B_in["x"],
        "B_w1": _B_in["w1"],
        "B_w2": _B_in["w2"],
    }

def reference(A_x, A_dft_seq_re, A_dft_seq_im, A_dft_hid_re, A_dft_hid_im, B_x, B_w1, B_w2):
    def _A_ref(x, dft_seq_re, dft_seq_im, dft_hid_re, dft_hid_im):
        a = torch.einsum("bsd,ed->bse", x, dft_hid_re)
        b = torch.einsum("bsd,ed->bse", x, dft_hid_im)
        y = torch.einsum("ts,bse->bte", dft_seq_re, a) - torch.einsum("ts,bse->bte", dft_seq_im, b)
        return y

    def _B_ref(x, w1, w2):
        h = torch.einsum("bsd,df->bsf", x, w1)
        zero = torch.zeros_like(h)
        h = torch.maximum(h, zero)
        return torch.einsum("bsf,fd->bsd", h, w2)

    x = A_x
    xn = _layernorm(x, axis=-1)
    return x + _A_ref(xn, A_dft_seq_re, A_dft_seq_im, A_dft_hid_re, A_dft_hid_im) + _B_ref(xn, B_w1, B_w2)
```

```asm
; @launch grid=(256,1,1) block=(512,1,1) lds=163840
.amdgcn_target "amdgcn-amd-amdhsa--gfx950"
.text
.globl parallel_sum__spectral_fnet__dense_activation_relu__prompt_kernel
.p2align 8
.type parallel_sum__spectral_fnet__dense_activation_relu__prompt_kernel,@function
parallel_sum__spectral_fnet__dense_activation_relu__prompt_kernel:
    s_load_dwordx16 s[4:19], s[0:1], 0
    s_load_dwordx4 s[20:23], s[0:1], 64
    s_load_dwordx2 s[24:25], s[0:1], 80
    s_cmp_ge_u32 s2, 256
    s_cbranch_scc1 L_end
    s_lshr_b32 s62, s2, 3
    s_getpc_b64 s[48:49]
L_pc0:
    v_cmp_gt_u32 vcc, 10, v0
    s_sub_u32 s48, s48, L_pc0-parallel_sum__spectral_fnet__dense_activation_relu__prompt_kernel
    s_subb_u32 s49, s49, 0
    s_mov_b32 s50, L_code_end-parallel_sum__spectral_fnet__dense_activation_relu__prompt_kernel
    s_mov_b32 s51, 0x20000
    s_lshl_b32 s3, s62, 7
    v_lshlrev_b32 v254, 12, v0
    s_and_saveexec_b64 s[26:27], vcc
    s_cbranch_execz L_ct0
    buffer_load_dword v255, v254, s[48:51], s3 offen
L_ct0:
    s_mov_b64 exec, s[26:27]
    v_lshrrev_b32 v2, 6, v0
    v_and_b32 v1, 63, v0
    s_and_b32 s61, s2, 7
    v_readfirstlane_b32 s60, v2
    s_cmp_lt_u32 s62, 28
    s_cbranch_scc1 L_ffn
    s_sub_u32 s3, s62, 28
    s_lshl_b32 s63, s61, 2
    s_add_u32 s63, s63, s3
    s_lshr_b32 s96, s61, 1
    s_mov_b32 s97, s3
    s_and_b32 s98, s61, 1
    s_and_b32 s99, s96, 1
    s_lshl_b32 s3, s63, 4
    s_lshl_b32 s27, s60, 1
    s_add_u32 s3, s3, s27
    v_lshrrev_b32 v2, 5, v1
    v_add_u32 v4, s3, v2
    v_and_b32 v3, 31, v1
    v_sub_u32 v5, 2048, v4
    v_sub_u32 v6, 1024, v4
    v_add_u32 v7, 1024, v4
    v_cmp_eq_u32 s[100:101], 0, v4
    v_mov_b32 v8, 512
    v_mov_b32 v9, 1536
    v_mov_b32 v12, 2147483392
    v_cndmask_b32 v5, v5, v8, s[100:101]
    v_cndmask_b32 v7, v7, v9, s[100:101]
    v_cmp_gt_u32 vcc, 28, v3
    v_lshlrev_b32 v8, 4, v3
    v_sub_u32 v9, 880, v8
    v_cndmask_b32 v8, v12, v8, vcc
    v_cndmask_b32 v9, v12, v9, vcc
    s_waitcnt lgkmcnt(0)
    s_mov_b32 s28, s4
    s_and_b32 s29, s5, 0xffff
    s_mov_b32 s30, 1835008
    s_mov_b32 s31, 0x20000
    s_mov_b32 s40, s24
    s_and_b32 s41, s25, 0xffff
    s_mov_b32 s42, 13762560
    s_mov_b32 s43, 0x20000
    s_lshl_b32 s3, s61, 9
    s_add_u32 s3, s3, 9523200
    v_lshl_add_u32 v190, v1, 7, s3
    s_and_b32 s3, s61, 1
    s_lshl_b32 s3, s3, 2
    s_add_u32 s3, s3, s96
    s_lshl_b32 s3, s3, 7
    s_add_u32 s3, s3, 9527296
    v_lshl_add_u32 v192, v1, 10, s3
    v_cmp_lt_u32 s[26:27], 3, v1
    v_cmp_lt_u32 s[94:95], 5, v1
    v_mov_b32 v193, 9535488
    v_cndmask_b32 v190, v190, v192, s[26:27]
    v_cndmask_b32 v190, v190, v193, s[94:95]
    s_lshl_b32 s3, s61, 9
    v_and_b32 v192, 3, v1
    v_lshl_add_u32 v192, v192, 7, s3
    v_lshrrev_b32 v193, 2, v1
    v_cmp_eq_u32 s[26:27], 2, v193
    v_cmp_eq_u32 s[94:95], 3, v193
    v_add_u32 v194, 9527296, v192
    v_add_u32 v192, 9519104, v192
    v_cndmask_b32 v190, v190, v194, s[26:27]
    v_cndmask_b32 v190, v190, v192, s[94:95]
    v_cmp_eq_u32 s[26:27], 4, v193
    s_lshl_b32 s3, s63, 8
    v_and_b32 v192, 1, v1
    v_lshl_add_u32 v192, v192, 7, s3
    v_add_u32 v192, 9506816, v192
    v_cndmask_b32 v190, v190, v192, s[26:27]
    buffer_load_dword v191, v190, s[40:43], 0 offen sc1
    v_mul_u32_u24 v222, 896, v4
    v_add_u32 v220, v222, v8
    v_add_u32 v221, v222, v9
    buffer_load_dwordx4 v[32:35], v220, s[28:31], 0 offen
    buffer_load_dwordx4 v[36:39], v221, s[28:31], 0 offen
    v_mul_u32_u24 v222, 896, v5
    v_add_u32 v220, v222, v8
    v_add_u32 v221, v222, v9
    buffer_load_dwordx4 v[40:43], v220, s[28:31], 0 offen
    buffer_load_dwordx4 v[44:47], v221, s[28:31], 0 offen
    v_mul_u32_u24 v222, 896, v6
    v_add_u32 v220, v222, v8
    v_add_u32 v221, v222, v9
    buffer_load_dwordx4 v[48:51], v220, s[28:31], 0 offen
    buffer_load_dwordx4 v[52:55], v221, s[28:31], 0 offen
    v_mul_u32_u24 v222, 896, v7
    v_add_u32 v220, v222, v8
    v_add_u32 v221, v222, v9
    buffer_load_dwordx4 v[56:59], v220, s[28:31], 0 offen
    buffer_load_dwordx4 v[60:63], v221, s[28:31], 0 offen
    s_branch L_dft
L_ffn:
    s_mul_i32 s27, s62, 37
    s_lshr_b32 s27, s27, 8
    s_mul_i32 s3, s27, 7
    s_sub_u32 s26, s62, s3
    s_and_b32 s63, s61, 6
    s_lshl_b32 s63, s63, 1
    s_add_u32 s63, s63, s27
    s_lshl_b32 s27, s27, 1
    s_add_u32 s95, s26, s27
    s_cmp_ge_u32 s95, 7
    s_cselect_b32 s3, 7, 0
    s_sub_u32 s95, s95, s3
    s_and_b32 s86, s61, 1
    s_mul_i32 s3, s86, 7
    s_add_u32 s96, s95, s3
    v_lshrrev_b32 v31, 4, v1
    v_mov_b32 v35, 896
    s_movk_i32 s3, 0xe2
    s_bitcmp1_b32 s3, s60
    s_cbranch_scc1 L_ldw
    s_max_u32 s97, s60, 1
    s_add_u32 s97, s97, s26
    s_add_u32 s97, s97, 3
    s_and_b32 s97, s97, 3
    s_lshl_b32 s3, s63, 6
    s_lshr_b32 s27, s97, 1
    s_add_u32 s3, s3, s27
    v_lshrrev_b32 v30, 3, v1
    v_lshl_add_u32 v30, v30, 1, s3
    v_and_b32 v32, 7, v1
    v_xor_b32 v32, v32, v31
    v_lshlrev_b32 v32, 4, v32
    s_lshl_b32 s52, s97, 12
    s_bitcmp1_b32 s97, 0
    s_cselect_b32 s3, -1, 1
    s_cselect_b32 s27, 2048, 0
    v_mul_i32_i24 v30, s3, v30
    v_add_u32 v30, s27, v30
    s_mul_i32 s3, s3, 14336
    v_mad_u32_u24 v33, v30, v35, v32
    v_lshrrev_b32 v34, 11, v30
    v_mul_u32_u24 v34, 917504, v34
    v_sub_u32 v2, v33, v34
    v_xor_b32 v32, 64, v32
    v_mad_u32_u24 v32, v30, v35, v32
    v_add_u32 v3, s3, v32
    s_lshl_b32 s3, s3, 1
    v_add_u32 v4, s3, v33
    v_add_u32 v5, s3, v3
    s_add_u32 s53, s52, 1024
    s_add_u32 s54, s52, 2048
    s_add_u32 s55, s52, 3072
    s_movk_i32 s99, 128
    s_waitcnt lgkmcnt(0)
    s_mov_b32 s32, s4
    s_and_b32 s33, s5, 0xffff
    s_mov_b32 s34, 1835008
    s_mov_b32 s35, 0x20000
    s_branch L_ldok
L_ldw:
    s_max_u32 s97, s60, 4
    s_add_u32 s97, s97, s63
    s_lshl_b32 s97, s97, 2
    v_lshlrev_b32 v33, 1, v31
    v_and_b32 v34, 15, v1
    v_xor_b32 v33, v33, v34
    v_mul_u32_u24 v34, 3584, v31
    v_lshl_add_u32 v32, v33, 4, v34
    v_xor_b32 v33, 128, v32
    s_and_b32 s52, s97, 15
    s_mul_i32 s27, s52, 14336
    s_lshl_b32 s3, s96, 8
    s_add_u32 s27, s27, s3
    v_add_u32 v2, s27, v32
    v_add_u32 v4, s27, v33
    v_add_u32 v3, 14336, v2
    v_add_u32 v4, 28672, v4
    v_add_u32 v5, 14336, v4
    s_lshl_b32 s52, s52, 10
    s_add_u32 s52, s52, 16384
    s_add_u32 s53, s52, 1024
    s_add_u32 s54, s52, 2048
    s_add_u32 s55, s52, 3072
    s_mov_b32 s99, 229376
    s_waitcnt lgkmcnt(0)
    s_mov_b32 s32, s16
    s_and_b32 s33, s17, 0xffff
    s_mov_b32 s34, 1605632
    s_mov_b32 s35, 0x20000
L_ldok:
    s_mov_b32 s28, s4
    s_and_b32 s29, s5, 0xffff
    s_mov_b32 s30, 1835008
    s_mov_b32 s31, 0x20000
    s_cmp_ge_u32 s60, 2
    s_cbranch_scc1 L_p1b
    s_mul_i32 s97, s99, 0
    s_add_u32 m0, s52, 0
    s_nop 0
    buffer_load_dwordx4 v2, s[32:35], s97 offen  lds
    s_add_u32 m0, s53, 0
    s_nop 0
    buffer_load_dwordx4 v3, s[32:35], s97 offen  lds
    s_add_u32 m0, s54, 0
    s_nop 0
    buffer_load_dwordx4 v4, s[32:35], s97 offen  lds
    s_add_u32 m0, s55, 0
    s_nop 0
    buffer_load_dwordx4 v5, s[32:35], s97 offen  lds
    s_mul_i32 s97, s99, 1
    s_add_u32 m0, s52, 32768
    s_nop 0
    buffer_load_dwordx4 v2, s[32:35], s97 offen  lds
    s_add_u32 m0, s53, 32768
    s_nop 0
    buffer_load_dwordx4 v3, s[32:35], s97 offen  lds
    s_add_u32 m0, s54, 32768
    s_nop 0
    buffer_load_dwordx4 v4, s[32:35], s97 offen  lds
    s_add_u32 m0, s55, 32768
    s_nop 0
    buffer_load_dwordx4 v5, s[32:35], s97 offen  lds
    s_cmp_lg_u32 s60, 0
    s_cbranch_scc1 L_notouch
L_notouch:
    v_and_b32 v32, 15, v1
    v_lshrrev_b32 v33, 1, v32
    v_xor_b32 v33, v33, v31
    v_lshlrev_b32 v33, 4, v33
    v_lshl_add_u32 v33, v32, 7, v33
    s_lshl_b32 s3, s60, 11
    v_add_u32 v8, s3, v33
    v_xor_b32 v9, 2048, v8
    v_xor_b32 v10, 4096, v8
    v_xor_b32 v11, 6144, v8
    v_xor_b32 v12, 64, v8
    v_xor_b32 v13, 64, v9
    v_xor_b32 v14, 64, v10
    v_xor_b32 v15, 64, v11
    v_bfe_u32 v30, v1, 2, 2
    v_lshl_add_u32 v32, v31, 3, v30
    v_lshlrev_b32 v32, 8, v32
    v_and_b32 v33, 3, v1
    v_lshl_add_u32 v32, v33, 3, v32
    v_add_u32 v32, 16384, v32
    v_and_b32 v33, 1, v31
    v_lshl_or_b32 v33, v33, 2, v30
    s_and_b32 s3, s60, 3
    s_lshl_b32 s3, s3, 1
    s_lshr_b32 s27, s60, 2
    s_or_b32 s3, s3, s27
    v_xor_b32 v33, s3, v33
    v_lshl_add_u32 v16, v33, 5, v32
    v_xor_b32 v17, 32, v16
    v_mov_b32 v20, 0x3f803f80
    v_mov_b32 v21, 0x3f803f80
    v_mov_b32 v22, 0x3f803f80
    v_mov_b32 v23, 0x3f803f80
    s_mov_b32 s40, s24
    s_and_b32 s41, s25, 0xffff
    s_mov_b32 s42, 13762560
    s_mov_b32 s43, 0x20000
    s_mov_b32 s14, s95
    s_lshl_b32 s94, s61, 2
    s_and_b32 s3, s63, 3
    s_add_u32 s94, s94, s3
    s_lshl_b32 s94, s94, 7
    s_add_u32 s94, s94, 9519104
    v_mov_b32 v19, 9535488
    s_mov_b32 s36, s18
    s_and_b32 s37, s19, 0xffff
    s_mov_b32 s38, 1605632
    s_mov_b32 s39, 0x20000
    s_lshl_b32 s101, s63, 1
    s_add_u32 s101, s101, s86
    v_lshrrev_b32 v30, 3, v1
    v_mul_u32_u24 v32, 896, v30
    v_and_b32 v30, 6, v30
    v_and_b32 v33, 7, v1
    v_xor_b32 v30, v30, v33
    v_lshl_add_u32 v32, v30, 4, v32
    s_lshl_b32 s3, s26, 7
    s_mul_i32 s27, s60, 7168
    s_add_u32 s3, s3, s27
    v_add_u32 v6, s3, v32
    s_lshl_b32 s56, s60, 10
    s_and_b32 s3, s60, 2
    s_add_u32 s3, s3, s86
    s_lshl_b32 s3, s3, 2
    s_lshr_b32 s27, s101, 3
    s_add_u32 s3, s3, s27
    s_lshl_b32 s3, s3, 7
    s_add_u32 s59, s3, 9531392
    s_waitcnt vmcnt(4)
    s_barrier
    ds_read_b128 v[24:27], v8 offset:0
    ds_read_b128 v[28:31], v9 offset:0
    ds_read_b128 v[32:35], v10 offset:0
    ds_read_b128 v[36:39], v11 offset:0
    ds_read_b64_tr_b16 v[40:41], v16 offset:0
    ds_read_b64_tr_b16 v[42:43], v16 offset:1024
    ds_read_b64_tr_b16 v[44:45], v17 offset:0
    ds_read_b64_tr_b16 v[46:47], v17 offset:1024
    s_waitcnt lgkmcnt(0)
    v_mfma_f32_16x16x32_bf16 v[104:107], v[20:23], v[24:27], 0
    ds_read_b128 v[48:51], v12 offset:0
    buffer_load_dword v18, v19, s[40:43], 0 offen sc1
    v_mfma_f32_16x16x32_bf16 v[108:111], v[40:43], v[20:23], 0
    ds_read_b128 v[52:55], v13 offset:0
    s_mul_i32 s97, s99, 2
    s_add_u32 m0, s52, 65536
    v_mfma_f32_16x16x32_bf16 v[72:75], v[40:43], v[24:27], 0
    ds_read_b128 v[56:59], v14 offset:0
    buffer_load_dwordx4 v2, s[32:35], s97 offen  lds
    v_mfma_f32_16x16x32_bf16 v[76:79], v[40:43], v[28:31], 0
    ds_read_b128 v[60:63], v15 offset:0
    s_add_u32 m0, s53, 65536
    v_mfma_f32_16x16x32_bf16 v[80:83], v[40:43], v[32:35], 0
    ds_read_b64_tr_b16 v[64:65], v16 offset:8192
    buffer_load_dwordx4 v3, s[32:35], s97 offen  lds
    v_mfma_f32_16x16x32_bf16 v[84:87], v[40:43], v[36:39], 0
    ds_read_b64_tr_b16 v[66:67], v16 offset:9216
    s_add_u32 m0, s54, 65536
    v_mfma_f32_16x16x32_bf16 v[88:91], v[44:47], v[24:27], 0
    ds_read_b64_tr_b16 v[68:69], v17 offset:8192
    buffer_load_dwordx4 v4, s[32:35], s97 offen  lds
    v_mfma_f32_16x16x32_bf16 v[92:95], v[44:47], v[28:31], 0
    ds_read_b64_tr_b16 v[70:71], v17 offset:9216
    s_add_u32 m0, s55, 65536
    v_mfma_f32_16x16x32_bf16 v[96:99], v[44:47], v[32:35], 0
    buffer_load_dwordx4 v5, s[32:35], s97 offen  lds
    v_mfma_f32_16x16x32_bf16 v[100:103], v[44:47], v[36:39], 0
    s_waitcnt vmcnt(5) lgkmcnt(0)
    s_barrier
    v_mfma_f32_16x16x32_bf16 v[104:107], v[20:23], v[48:51], v[104:107]
    ds_read_b128 v[24:27], v8 offset:32768
    v_mfma_f32_16x16x32_bf16 v[108:111], v[64:67], v[20:23], v[108:111]
    ds_read_b128 v[28:31], v9 offset:32768
    s_mul_i32 s97, s99, 3
    s_add_u32 m0, s52, 98304
    v_mfma_f32_16x16x32_bf16 v[72:75], v[64:67], v[48:51], v[72:75]
    ds_read_b128 v[32:35], v10 offset:32768
    buffer_load_dwordx4 v2, s[32:35], s97 offen  lds
    v_mfma_f32_16x16x32_bf16 v[76:79], v[64:67], v[52:55], v[76:79]
    ds_read_b128 v[36:39], v11 offset:32768
    s_add_u32 m0, s53, 98304
    v_mfma_f32_16x16x32_bf16 v[80:83], v[64:67], v[56:59], v[80:83]
    ds_read_b64_tr_b16 v[40:41], v16 offset:32768
    buffer_load_dwordx4 v3, s[32:35], s97 offen  lds
    v_mfma_f32_16x16x32_bf16 v[84:87], v[64:67], v[60:63], v[84:87]
    ds_read_b64_tr_b16 v[42:43], v16 offset:33792
    s_add_u32 m0, s54, 98304
    v_mfma_f32_16x16x32_bf16 v[88:91], v[68:71], v[48:51], v[88:91]
    ds_read_b64_tr_b16 v[44:45], v17 offset:32768
    buffer_load_dwordx4 v4, s[32:35], s97 offen  lds
    v_mfma_f32_16x16x32_bf16 v[92:95], v[68:71], v[52:55], v[92:95]
    ds_read_b64_tr_b16 v[46:47], v17 offset:33792
    s_add_u32 m0, s55, 98304
    v_mfma_f32_16x16x32_bf16 v[96:99], v[68:71], v[56:59], v[96:99]
    buffer_load_dwordx4 v5, s[32:35], s97 offen  lds
    v_mfma_f32_16x16x32_bf16 v[100:103], v[68:71], v[60:63], v[100:103]
    s_waitcnt lgkmcnt(0)
    v_mfma_f32_16x16x32_bf16 v[104:107], v[20:23], v[24:27], v[104:107]
    ds_read_b128 v[48:51], v12 offset:32768
    v_mfma_f32_16x16x32_bf16 v[108:111], v[40:43], v[20:23], v[108:111]
    ds_read_b128 v[52:55], v13 offset:32768
    s_mul_i32 s97, s99, 4
    s_add_u32 m0, s52, 131072
    v_mfma_f32_16x16x32_bf16 v[72:75], v[40:43], v[24:27], v[72:75]
    ds_read_b128 v[56:59], v14 offset:32768
    buffer_load_dwordx4 v2, s[32:35], s97 offen  lds
    v_mfma_f32_16x16x32_bf16 v[76:79], v[40:43], v[28:31], v[76:79]
    ds_read_b128 v[60:63], v15 offset:32768
    s_add_u32 m0, s53, 131072
    v_mfma_f32_16x16x32_bf16 v[80:83], v[40:43], v[32:35], v[80:83]
    ds_read_b64_tr_b16 v[64:65], v16 offset:40960
    buffer_load_dwordx4 v3, s[32:35], s97 offen  lds
    v_mfma_f32_16x16x32_bf16 v[84:87], v[40:43], v[36:39], v[84:87]
    ds_read_b64_tr_b16 v[66:67], v16 offset:41984
    s_add_u32 m0, s54, 131072
    v_mfma_f32_16x16x32_bf16 v[88:91], v[44:47], v[24:27], v[88:91]
    ds_read_b64_tr_b16 v[68:69], v17 offset:40960
    buffer_load_dwordx4 v4, s[32:35], s97 offen  lds
    v_mfma_f32_16x16x32_bf16 v[92:95], v[44:47], v[28:31], v[92:95]
    ds_read_b64_tr_b16 v[70:71], v17 offset:41984
    s_add_u32 m0, s55, 131072
    v_mfma_f32_16x16x32_bf16 v[96:99], v[44:47], v[32:35], v[96:99]
    v_add_u32 v8, 65536, v8
    v_add_u32 v9, 65536, v9
    v_add_u32 v10, 65536, v10
    v_add_u32 v11, 65536, v11
    v_add_u32 v12, 65536, v12
    buffer_load_dwordx4 v5, s[32:35], s97 offen  lds
    v_mfma_f32_16x16x32_bf16 v[100:103], v[44:47], v[36:39], v[100:103]
    v_add_u32 v13, 65536, v13
    v_add_u32 v14, 65536, v14
    v_add_u32 v15, 65536, v15
    v_add_u32 v16, 65536, v16
    v_add_u32 v17, 65536, v17
    s_waitcnt vmcnt(8) lgkmcnt(0)
    s_barrier
    v_mfma_f32_16x16x32_bf16 v[104:107], v[20:23], v[48:51], v[104:107]
    ds_read_b128 v[24:27], v8 offset:0
    v_readfirstlane_b32 s58, v18
    v_mfma_f32_16x16x32_bf16 v[108:111], v[64:67], v[20:23], v[108:111]
    ds_read_b128 v[28:31], v9 offset:0
    s_mul_i32 s97, s99, 5
    s_add_u32 m0, s52, 0
    s_lshl_b32 s49, s26, 2
    v_mfma_f32_16x16x32_bf16 v[72:75], v[64:67], v[48:51], v[72:75]
    ds_read_b128 v[32:35], v10 offset:0
    buffer_load_dwordx4 v2, s[32:35], s97 offen  lds
    v_mov_b32 v121, s49
    v_mfma_f32_16x16x32_bf16 v[76:79], v[64:67], v[52:55], v[76:79]
    ds_read_b128 v[36:39], v11 offset:0
    s_add_u32 m0, s53, 0
    s_mul_i32 s58, s58, 2654435761
    v_mfma_f32_16x16x32_bf16 v[80:83], v[64:67], v[56:59], v[80:83]
    ds_read_b64_tr_b16 v[40:41], v16 offset:0
    buffer_load_dwordx4 v3, s[32:35], s97 offen  lds
    s_add_u32 s58, s58, 2135587861
    v_mfma_f32_16x16x32_bf16 v[84:87], v[64:67], v[60:63], v[84:87]
    ds_read_b64_tr_b16 v[42:43], v16 offset:1024
    s_add_u32 m0, s54, 0
    v_min_u32 v123, 6, v1
    v_mfma_f32_16x16x32_bf16 v[88:91], v[68:71], v[48:51], v[88:91]
    ds_read_b64_tr_b16 v[44:45], v17 offset:0
    buffer_load_dwordx4 v4, s[32:35], s97 offen  lds
    v_lshlrev_b32 v123, 2, v123
    v_mfma_f32_16x16x32_bf16 v[92:95], v[68:71], v[52:55], v[92:95]
    ds_read_b64_tr_b16 v[46:47], v17 offset:1024
    s_add_u32 m0, s55, 0
    v_mfma_f32_16x16x32_bf16 v[96:99], v[68:71], v[56:59], v[96:99]
    buffer_load_dwordx4 v5, s[32:35], s97 offen  lds
    v_mfma_f32_16x16x32_bf16 v[100:103], v[68:71], v[60:63], v[100:103]
    s_waitcnt lgkmcnt(0)
    v_mfma_f32_16x16x32_bf16 v[104:107], v[20:23], v[24:27], v[104:107]
    ds_read_b128 v[48:51], v12 offset:0
    v_mfma_f32_16x16x32_bf16 v[108:111], v[40:43], v[20:23], v[108:111]
    ds_read_b128 v[52:55], v13 offset:0
    s_mul_i32 s97, s99, 6
    s_add_u32 m0, s52, 32768
    v_mfma_f32_16x16x32_bf16 v[72:75], v[40:43], v[24:27], v[72:75]
    ds_read_b128 v[56:59], v14 offset:0
    buffer_load_dwordx4 v2, s[32:35], s97 offen  lds
    v_mfma_f32_16x16x32_bf16 v[76:79], v[40:43], v[28:31], v[76:79]
    ds_read_b128 v[60:63], v15 offset:0
    s_add_u32 m0, s53, 32768
    v_mfma_f32_16x16x32_bf16 v[80:83], v[40:43], v[32:35], v[80:83]
    ds_read_b64_tr_b16 v[64:65], v16 offset:8192
    buffer_load_dwordx4 v3, s[32:35], s97 offen  lds
    v_mfma_f32_16x16x32_bf16 v[84:87], v[40:43], v[36:39], v[84:87]
    ds_read_b64_tr_b16 v[66:67], v16 offset:9216
    s_add_u32 m0, s54, 32768
    v_mfma_f32_16x16x32_bf16 v[88:91], v[44:47], v[24:27], v[88:91]
    ds_read_b64_tr_b16 v[68:69], v17 offset:8192
    buffer_load_dwordx4 v4, s[32:35], s97 offen  lds
    v_mfma_f32_16x16x32_bf16 v[92:95], v[44:47], v[28:31], v[92:95]
    ds_read_b64_tr_b16 v[70:71], v17 offset:9216
    s_add_u32 m0, s55, 32768
    v_mfma_f32_16x16x32_bf16 v[96:99], v[44:47], v[32:35], v[96:99]
    buffer_load_dwordx4 v5, s[32:35], s97 offen  lds
    v_mfma_f32_16x16x32_bf16 v[100:103], v[44:47], v[36:39], v[100:103]
    s_waitcnt vmcnt(12) lgkmcnt(0)
    s_barrier
    v_mfma_f32_16x16x32_bf16 v[104:107], v[20:23], v[48:51], v[104:107]
    ds_read_b128 v[24:27], v8 offset:32768
    v_mfma_f32_16x16x32_bf16 v[108:111], v[64:67], v[20:23], v[108:111]
    ds_read_b128 v[28:31], v9 offset:32768
    v_mfma_f32_16x16x32_bf16 v[72:75], v[64:67], v[48:51], v[72:75]
    ds_read_b128 v[32:35], v10 offset:32768
    v_mfma_f32_16x16x32_bf16 v[76:79], v[64:67], v[52:55], v[76:79]
    ds_read_b128 v[36:39], v11 offset:32768
    v_mfma_f32_16x16x32_bf16 v[80:83], v[64:67], v[56:59], v[80:83]
    ds_read_b64_tr_b16 v[40:41], v16 offset:32768
    v_mfma_f32_16x16x32_bf16 v[84:87], v[64:67], v[60:63], v[84:87]
    ds_read_b64_tr_b16 v[42:43], v16 offset:33792
    v_mfma_f32_16x16x32_bf16 v[88:91], v[68:71], v[48:51], v[88:91]
    ds_read_b64_tr_b16 v[44:45], v17 offset:32768
    v_mfma_f32_16x16x32_bf16 v[92:95], v[68:71], v[52:55], v[92:95]
    ds_read_b64_tr_b16 v[46:47], v17 offset:33792
    v_mfma_f32_16x16x32_bf16 v[96:99], v[68:71], v[56:59], v[96:99]
    v_mfma_f32_16x16x32_bf16 v[100:103], v[68:71], v[60:63], v[100:103]
    s_cmp_lg_u32 s60, 1
    s_cbranch_scc1 L_notouch3
    v_lshlrev_b32 v124, 7, v1
    s_mul_i32 s3, s2, 7168
    s_mov_b32 exec_hi, 0xffffff
    buffer_load_dword v125, v124, s[36:39], s3 offen
    s_mov_b64 exec, -1
L_notouch3:
    s_waitcnt lgkmcnt(0)
    v_mfma_f32_16x16x32_bf16 v[104:107], v[20:23], v[24:27], v[104:107]
    ds_read_b128 v[48:51], v12 offset:32768
    v_mfma_f32_16x16x32_bf16 v[108:111], v[40:43], v[20:23], v[108:111]
    ds_read_b128 v[52:55], v13 offset:32768
    v_mfma_f32_16x16x32_bf16 v[72:75], v[40:43], v[24:27], v[72:75]
    ds_read_b128 v[56:59], v14 offset:32768
    v_mfma_f32_16x16x32_bf16 v[76:79], v[40:43], v[28:31], v[76:79]
    ds_read_b128 v[60:63], v15 offset:32768
    v_mfma_f32_16x16x32_bf16 v[80:83], v[40:43], v[32:35], v[80:83]
    ds_read_b64_tr_b16 v[64:65], v16 offset:40960
    v_mfma_f32_16x16x32_bf16 v[84:87], v[40:43], v[36:39], v[84:87]
    ds_read_b64_tr_b16 v[66:67], v16 offset:41984
    v_mfma_f32_16x16x32_bf16 v[88:91], v[44:47], v[24:27], v[88:91]
    ds_read_b64_tr_b16 v[68:69], v17 offset:40960
    v_mfma_f32_16x16x32_bf16 v[92:95], v[44:47], v[28:31], v[92:95]
    ds_read_b64_tr_b16 v[70:71], v17 offset:41984
    v_mfma_f32_16x16x32_bf16 v[96:99], v[44:47], v[32:35], v[96:99]
    v_add_u32 v8, 65536, v8
    v_add_u32 v9, 65536, v9
    v_add_u32 v10, 65536, v10
    v_add_u32 v11, 65536, v11
    v_add_u32 v12, 65536, v12
    v_mfma_f32_16x16x32_bf16 v[100:103], v[44:47], v[36:39], v[100:103]
    v_add_u32 v13, 65536, v13
    v_add_u32 v14, 65536, v14
    v_add_u32 v15, 65536, v15
    v_add_u32 v16, 65536, v16
    v_add_u32 v17, 65536, v17
    s_waitcnt vmcnt(8) lgkmcnt(0)
    s_barrier
    v_mfma_f32_16x16x32_bf16 v[104:107], v[20:23], v[48:51], v[104:107]
    ds_read_b128 v[24:27], v8 offset:0
    v_mfma_f32_16x16x32_bf16 v[108:111], v[64:67], v[20:23], v[108:111]
    ds_read_b128 v[28:31], v9 offset:0
    v_mfma_f32_16x16x32_bf16 v[72:75], v[64:67], v[48:51], v[72:75]
    ds_read_b128 v[32:35], v10 offset:0
    v_mfma_f32_16x16x32_bf16 v[76:79], v[64:67], v[52:55], v[76:79]
    ds_read_b128 v[36:39], v11 offset:0
    v_mfma_f32_16x16x32_bf16 v[80:83], v[64:67], v[56:59], v[80:83]
    ds_read_b64_tr_b16 v[40:41], v16 offset:0
    v_mfma_f32_16x16x32_bf16 v[84:87], v[64:67], v[60:63], v[84:87]
    ds_read_b64_tr_b16 v[42:43], v16 offset:1024
    v_mfma_f32_16x16x32_bf16 v[88:91], v[68:71], v[48:51], v[88:91]
    ds_read_b64_tr_b16 v[44:45], v17 offset:0
    v_mfma_f32_16x16x32_bf16 v[92:95], v[68:71], v[52:55], v[92:95]
    ds_read_b64_tr_b16 v[46:47], v17 offset:1024
    v_mfma_f32_16x16x32_bf16 v[96:99], v[68:71], v[56:59], v[96:99]
    v_mfma_f32_16x16x32_bf16 v[100:103], v[68:71], v[60:63], v[100:103]
    s_waitcnt lgkmcnt(0)
    v_mfma_f32_16x16x32_bf16 v[104:107], v[20:23], v[24:27], v[104:107]
    ds_read_b128 v[48:51], v12 offset:0
    v_mfma_f32_16x16x32_bf16 v[108:111], v[40:43], v[20:23], v[108:111]
    ds_read_b128 v[52:55], v13 offset:0
    s_mul_i32 s57, s86, 7
    s_add_u32 s57, s57, s95
    s_mul_i32 s57, s57, 114688
    s_add_u32 s95, s95, 1
    s_cmp_eq_u32 s95, 7
    s_cselect_b32 s95, 0, s95
    s_add_u32 m0, s56, 65536
    v_mfma_f32_16x16x32_bf16 v[72:75], v[40:43], v[24:27], v[72:75]
    ds_read_b128 v[56:59], v14 offset:0
    buffer_load_dwordx4 v6, s[36:39], s57 offen  lds
    v_mfma_f32_16x16x32_bf16 v[76:79], v[40:43], v[28:31], v[76:79]
    ds_read_b128 v[60:63], v15 offset:0
    v_mfma_f32_16x16x32_bf16 v[80:83], v[40:43], v[32:35], v[80:83]
    ds_read_b64_tr_b16 v[64:65], v16 offset:8192
    v_mfma_f32_16x16x32_bf16 v[84:87], v[40:43], v[36:39], v[84:87]
    ds_read_b64_tr_b16 v[66:67], v16 offset:9216
    s_add_u32 s57, s57, 57344
    s_add_u32 m0, s56, 73728
    v_mfma_f32_16x16x32_bf16 v[88:91], v[44:47], v[24:27], v[88:91]
    ds_read_b64_tr_b16 v[68:69], v17 offset:8192
    buffer_load_dwordx4 v6, s[36:39], s57 offen  lds
    v_mfma_f32_16x16x32_bf16 v[92:95], v[44:47], v[28:31], v[92:95]
    ds_read_b64_tr_b16 v[70:71], v17 offset:9216
    v_mfma_f32_16x16x32_bf16 v[96:99], v[44:47], v[32:35], v[96:99]
    v_add_u32 v8, 4294836224, v8
    v_add_u32 v9, 4294836224, v9
    v_add_u32 v10, 4294836224, v10
    v_add_u32 v11, 4294836224, v11
    v_add_u32 v12, 4294836224, v12
    v_mfma_f32_16x16x32_bf16 v[100:103], v[44:47], v[36:39], v[100:103]
    v_add_u32 v13, 4294836224, v13
    v_add_u32 v14, 4294836224, v14
    v_add_u32 v15, 4294836224, v15
    v_add_u32 v16, 4294836224, v16
    v_add_u32 v17, 4294836224, v17
    s_waitcnt vmcnt(6) lgkmcnt(0)
    s_barrier
    v_mfma_f32_16x16x32_bf16 v[104:107], v[20:23], v[48:51], v[104:107]
    ds_read_b128 v[24:27], v8 offset:0
    v_mfma_f32_16x16x32_bf16 v[108:111], v[64:67], v[20:23], v[108:111]
    ds_read_b128 v[28:31], v9 offset:0
    s_mul_i32 s57, s86, 7
    s_add_u32 s57, s57, s95
    s_mul_i32 s57, s57, 114688
    s_add_u32 s95, s95, 1
    s_cmp_eq_u32 s95, 7
    s_cselect_b32 s95, 0, s95
    s_add_u32 m0, s56, 81920
    v_mfma_f32_16x16x32_bf16 v[72:75], v[64:67], v[48:51], v[72:75]
    ds_read_b128 v[32:35], v10 offset:0
    buffer_load_dwordx4 v6, s[36:39], s57 offen  lds
    v_mfma_f32_16x16x32_bf16 v[76:79], v[64:67], v[52:55], v[76:79]
    ds_read_b128 v[36:39], v11 offset:0
    v_mfma_f32_16x16x32_bf16 v[80:83], v[64:67], v[56:59], v[80:83]
    ds_read_b64_tr_b16 v[40:41], v16 offset:0
    v_mfma_f32_16x16x32_bf16 v[84:87], v[64:67], v[60:63], v[84:87]
    ds_read_b64_tr_b16 v[42:43], v16 offset:1024
    s_add_u32 s57, s57, 57344
    s_add_u32 m0, s56, 90112
    v_mfma_f32_16x16x32_bf16 v[88:91], v[68:71], v[48:51], v[88:91]
    ds_read_b64_tr_b16 v[44:45], v17 offset:0
    buffer_load_dwordx4 v6, s[36:39], s57 offen  lds
    v_mfma_f32_16x16x32_bf16 v[92:95], v[68:71], v[52:55], v[92:95]
    ds_read_b64_tr_b16 v[46:47], v17 offset:1024
    v_mfma_f32_16x16x32_bf16 v[96:99], v[68:71], v[56:59], v[96:99]
    v_mfma_f32_16x16x32_bf16 v[100:103], v[68:71], v[60:63], v[100:103]
    s_waitcnt lgkmcnt(0)
    v_mfma_f32_16x16x32_bf16 v[104:107], v[20:23], v[24:27], v[104:107]
    ds_read_b128 v[48:51], v12 offset:0
    v_mfma_f32_16x16x32_bf16 v[108:111], v[40:43], v[20:23], v[108:111]
    ds_read_b128 v[52:55], v13 offset:0
    s_mul_i32 s57, s86, 7
    s_add_u32 s57, s57, s95
    s_mul_i32 s57, s57, 114688
    s_add_u32 s95, s95, 1
    s_cmp_eq_u32 s95, 7
    s_cselect_b32 s95, 0, s95
    s_add_u32 m0, s56, 98304
    v_mfma_f32_16x16x32_bf16 v[72:75], v[40:43], v[24:27], v[72:75]
    ds_read_b128 v[56:59], v14 offset:0
    buffer_load_dwordx4 v6, s[36:39], s57 offen  lds
    v_mfma_f32_16x16x32_bf16 v[76:79], v[40:43], v[28:31], v[76:79]
    ds_read_b128 v[60:63], v15 offset:0
    v_mfma_f32_16x16x32_bf16 v[80:83], v[40:43], v[32:35], v[80:83]
    ds_read_b64_tr_b16 v[64:65], v16 offset:8192
    v_mfma_f32_16x16x32_bf16 v[84:87], v[40:43], v[36:39], v[84:87]
    ds_read_b64_tr_b16 v[66:67], v16 offset:9216
    s_add_u32 s57, s57, 57344
    s_add_u32 m0, s56, 106496
    v_mfma_f32_16x16x32_bf16 v[88:91], v[44:47], v[24:27], v[88:91]
    ds_read_b64_tr_b16 v[68:69], v17 offset:8192
    buffer_load_dwordx4 v6, s[36:39], s57 offen  lds
    v_mfma_f32_16x16x32_bf16 v[92:95], v[44:47], v[28:31], v[92:95]
    ds_read_b64_tr_b16 v[70:71], v17 offset:9216
    v_mfma_f32_16x16x32_bf16 v[96:99], v[44:47], v[32:35], v[96:99]
    v_mfma_f32_16x16x32_bf16 v[100:103], v[44:47], v[36:39], v[100:103]
    s_waitcnt vmcnt(6) lgkmcnt(0)
    s_barrier
    v_mfma_f32_16x16x32_bf16 v[104:107], v[20:23], v[48:51], v[104:107]
    ds_read_b128 v[24:27], v8 offset:32768
    v_mfma_f32_16x16x32_bf16 v[108:111], v[64:67], v[20:23], v[108:111]
    ds_read_b128 v[28:31], v9 offset:32768
    s_mul_i32 s57, s86, 7
    s_add_u32 s57, s57, s95
    s_mul_i32 s57, s57, 114688
    s_add_u32 s95, s95, 1
    s_cmp_eq_u32 s95, 7
    s_cselect_b32 s95, 0, s95
    s_add_u32 m0, s56, 114688
    v_mfma_f32_16x16x32_bf16 v[72:75], v[64:67], v[48:51], v[72:75]
    ds_read_b128 v[32:35], v10 offset:32768
    buffer_load_dwordx4 v6, s[36:39], s57 offen  lds
    v_mfma_f32_16x16x32_bf16 v[76:79], v[64:67], v[52:55], v[76:79]
    ds_read_b128 v[36:39], v11 offset:32768
    v_mfma_f32_16x16x32_bf16 v[80:83], v[64:67], v[56:59], v[80:83]
    ds_read_b64_tr_b16 v[40:41], v16 offset:32768
    v_mfma_f32_16x16x32_bf16 v[84:87], v[64:67], v[60:63], v[84:87]
    ds_read_b64_tr_b16 v[42:43], v16 offset:33792
    s_add_u32 s57, s57, 57344
    s_add_u32 m0, s56, 122880
    v_mfma_f32_16x16x32_bf16 v[88:91], v[68:71], v[48:51], v[88:91]
    ds_read_b64_tr_b16 v[44:45], v17 offset:32768
    buffer_load_dwordx4 v6, s[36:39], s57 offen  lds
    v_mfma_f32_16x16x32_bf16 v[92:95], v[68:71], v[52:55], v[92:95]
    ds_read_b64_tr_b16 v[46:47], v17 offset:33792
    v_mfma_f32_16x16x32_bf16 v[96:99], v[68:71], v[56:59], v[96:99]
    v_mfma_f32_16x16x32_bf16 v[100:103], v[68:71], v[60:63], v[100:103]
    s_waitcnt lgkmcnt(0)
    v_mfma_f32_16x16x32_bf16 v[104:107], v[20:23], v[24:27], v[104:107]
    ds_read_b128 v[48:51], v12 offset:32768
    v_mfma_f32_16x16x32_bf16 v[108:111], v[40:43], v[20:23], v[108:111]
    ds_read_b128 v[52:55], v13 offset:32768
    s_mul_i32 s57, s86, 7
    s_add_u32 s57, s57, s95
    s_mul_i32 s57, s57, 114688
    s_add_u32 s95, s95, 1
    s_cmp_eq_u32 s95, 7
    s_cselect_b32 s95, 0, s95
    s_add_u32 m0, s56, 131072
    v_mfma_f32_16x16x32_bf16 v[72:75], v[40:43], v[24:27], v[72:75]
    ds_read_b128 v[56:59], v14 offset:32768
    buffer_load_dwordx4 v6, s[36:39], s57 offen  lds
    v_mfma_f32_16x16x32_bf16 v[76:79], v[40:43], v[28:31], v[76:79]
    ds_read_b128 v[60:63], v15 offset:32768
    v_mfma_f32_16x16x32_bf16 v[80:83], v[40:43], v[32:35], v[80:83]
    ds_read_b64_tr_b16 v[64:65], v16 offset:40960
    v_mfma_f32_16x16x32_bf16 v[84:87], v[40:43], v[36:39], v[84:87]
    ds_read_b64_tr_b16 v[66:67], v16 offset:41984
    s_add_u32 s57, s57, 57344
    s_add_u32 m0, s56, 139264
    v_mfma_f32_16x16x32_bf16 v[88:91], v[44:47], v[24:27], v[88:91]
    ds_read_b64_tr_b16 v[68:69], v17 offset:40960
    buffer_load_dwordx4 v6, s[36:39], s57 offen  lds
    v_mfma_f32_16x16x32_bf16 v[92:95], v[44:47], v[28:31], v[92:95]
    ds_read_b64_tr_b16 v[70:71], v17 offset:41984
    v_mfma_f32_16x16x32_bf16 v[96:99], v[44:47], v[32:35], v[96:99]
    v_mfma_f32_16x16x32_bf16 v[100:103], v[44:47], v[36:39], v[100:103]
    s_waitcnt lgkmcnt(0)
    v_mfma_f32_16x16x32_bf16 v[104:107], v[20:23], v[48:51], v[104:107]
    v_and_b32 v30, 15, v1
    v_lshlrev_b32 v30, 2, v30
    v_lshlrev_b32 v16, 4, v1
    v_mov_b32 v7, 0
    v_lshrrev_b32 v124, 4, v1
    v_bfe_u32 v125, v1, 2, 2
    v_lshl_add_u32 v126, v124, 2, v125
    v_lshrrev_b32 v127, 1, v126
    v_and_b32 v127, 3, v127
    v_lshlrev_b32 v126, 7, v126
    v_mfma_f32_16x16x32_bf16 v[108:111], v[64:67], v[20:23], v[108:111]
    s_mul_i32 s57, s86, 7
    s_add_u32 s57, s57, s95
    s_mul_i32 s57, s57, 114688
    s_add_u32 s95, s95, 1
    s_cmp_eq_u32 s95, 7
    s_cselect_b32 s95, 0, s95
    s_add_u32 m0, s56, 147456
    s_lshl_b32 s3, s60, 6
    v_add_u32 v30, s3, v30
    v_and_b32 v125, 3, v1
    v_lshl_add_u32 v126, v125, 3, v126
    v_xor_b32 v125, 0, v127
    v_lshl_add_u32 v8, v125, 5, v126
    v_add_u32 v12, 0x10000, v8
    v_add_u32 v112, 0x20000, v8
    v_xor_b32 v125, 1, v127
    v_mfma_f32_16x16x32_bf16 v[72:75], v[64:67], v[48:51], v[72:75]
    buffer_load_dwordx4 v6, s[36:39], s57 offen  lds
    v_lshrrev_b32 v31, 4, v1
    v_lshlrev_b32 v31, 4, v31
    v_lshl_add_u32 v9, v125, 5, v126
    v_add_u32 v13, 0x10000, v9
    v_add_u32 v113, 0x20000, v9
    v_xor_b32 v125, 2, v127
    v_lshl_add_u32 v10, v125, 5, v126
    v_add_u32 v14, 0x10000, v10
    v_add_u32 v114, 0x20000, v10
    v_mfma_f32_16x16x32_bf16 v[76:79], v[64:67], v[52:55], v[76:79]
    s_and_b32 s27, s60, 3
    s_lshl_b32 s27, s27, 7
    v_xor_b32 v125, 3, v127
    v_lshl_add_u32 v11, v125, 5, v126
    v_add_u32 v15, 0x10000, v11
    v_add_u32 v115, 0x20000, v11
    s_lshl_b32 s48, s101, 2
    s_and_b32 s49, s60, 3
    s_add_u32 s48, s48, s49
    s_mul_i32 s50, s48, 57344
    v_mfma_f32_16x16x32_bf16 v[80:83], v[64:67], v[56:59], v[80:83]
    s_lshr_b32 s3, s60, 2
    s_lshl_b32 s3, s3, 6
    v_add_u32 v2, s50, v16
    s_xor_b32 s50, s48, 4
    s_mul_i32 s50, s50, 57344
    v_add_u32 v3, s50, v16
    s_and_b32 s48, s48, 7
    s_lshl_b32 s48, s48, 12
    s_add_u32 s48, s48, 32768
    v_mfma_f32_16x16x32_bf16 v[84:87], v[64:67], v[60:63], v[84:87]
    s_add_u32 s57, s57, 57344
    s_add_u32 m0, s56, 155648
    s_add_u32 s27, s27, s3
    v_add_u32 v31, s27, v31
    v_add_u32 v238, s48, v16
    v_xor_b32 v239, 16384, v238
    s_lshl_b32 s48, s63, 6
    s_add_u32 s48, s48, s86
    s_and_b32 s49, s60, 1
    s_lshl_b32 s49, s49, 5
    s_add_u32 s49, s49, s48
    v_mfma_f32_16x16x32_bf16 v[88:91], v[68:71], v[48:51], v[88:91]
    buffer_load_dwordx4 v6, s[36:39], s57 offen  lds
    v_xor_b32 v32, 64, v30
    v_xor_b32 v33, 128, v30
    v_lshrrev_b32 v124, 3, v1
    v_lshl_add_u32 v125, v124, 1, s49
    s_bfe_u32 s48, s60, 0x10001
    s_lshl_b32 s49, s48, 11
    s_lshl_b32 s48, s48, 1
    s_sub_u32 s48, 1, s48
    v_mul_i32_i24 v125, s48, v125
    v_add_u32 v125, s49, v125
    v_mfma_f32_16x16x32_bf16 v[92:95], v[68:71], v[52:55], v[92:95]
    v_xor_b32 v34, 192, v30
    v_xor_b32 v35, 64, v31
    s_mul_i32 s48, s48, 14336
    s_lshl_b32 s49, s26, 7
    v_mul_u32_u24 v126, 896, v125
    v_add_u32 v126, s48, v126
    v_lshrrev_b32 v127, 11, v125
    v_lshlrev_b32 v127, 10, v127
    v_sub_u32 v125, v125, v127
    v_mfma_f32_16x16x32_bf16 v[96:99], v[68:71], v[56:59], v[96:99]
    v_mul_u32_u24 v125, 896, v125
    v_and_b32 v127, 7, v1
    v_xor_b32 v127, v127, v124
    v_lshlrev_b32 v127, 4, v127
    v_add_u32 v127, s49, v127
    v_add_u32 v4, v125, v127
    v_add_u32 v5, v126, v127
    v_mfma_f32_16x16x32_bf16 v[100:103], v[68:71], v[60:63], v[100:103]
    ds_write_b32 v30, v104
    ds_write_b128 v31, v[108:111] offset:512
    s_branch L_p1done
L_p1b:
    v_and_b32 v32, 15, v1
    v_lshrrev_b32 v33, 1, v32
    v_xor_b32 v33, v33, v31
    v_lshlrev_b32 v33, 4, v33
    v_lshl_add_u32 v33, v32, 7, v33
    s_lshl_b32 s3, s60, 11
    v_add_u32 v8, s3, v33
    v_xor_b32 v9, 2048, v8
    v_xor_b32 v10, 4096, v8
    v_xor_b32 v11, 6144, v8
    v_xor_b32 v12, 64, v8
    v_xor_b32 v13, 64, v9
    v_xor_b32 v14, 64, v10
    v_xor_b32 v15, 64, v11
    v_bfe_u32 v30, v1, 2, 2
    v_lshl_add_u32 v32, v31, 3, v30
    v_lshlrev_b32 v32, 8, v32
    v_and_b32 v33, 3, v1
    v_lshl_add_u32 v32, v33, 3, v32
    v_add_u32 v32, 16384, v32
    v_and_b32 v33, 1, v31
    v_lshl_or_b32 v33, v33, 2, v30
    s_and_b32 s3, s60, 3
    s_lshl_b32 s3, s3, 1
    s_lshr_b32 s27, s60, 2
    s_or_b32 s3, s3, s27
    v_xor_b32 v33, s3, v33
    v_lshl_add_u32 v16, v33, 5, v32
    v_xor_b32 v17, 32, v16
    v_mov_b32 v20, 0x3f803f80
    v_mov_b32 v21, 0x3f803f80
    v_mov_b32 v22, 0x3f803f80
    v_mov_b32 v23, 0x3f803f80
    s_mul_i32 s97, s99, 0
    s_add_u32 m0, s52, 0
    s_nop 0
    buffer_load_dwordx4 v2, s[32:35], s97 offen  lds
    s_add_u32 m0, s53, 0
    s_nop 0
    buffer_load_dwordx4 v3, s[32:35], s97 offen  lds
    s_add_u32 m0, s54, 0
    s_nop 0
    buffer_load_dwordx4 v4, s[32:35], s97 offen  lds
    s_add_u32 m0, s55, 0
    s_nop 0
    buffer_load_dwordx4 v5, s[32:35], s97 offen  lds
    s_mov_b32 s40, s24
    s_and_b32 s41, s25, 0xffff
    s_mov_b32 s42, 13762560
    s_mov_b32 s43, 0x20000
    s_mov_b32 s14, s95
    s_lshl_b32 s94, s61, 2
    s_and_b32 s3, s63, 3
    s_add_u32 s94, s94, s3
    s_lshl_b32 s94, s94, 7
    s_add_u32 s94, s94, 9519104
    v_mov_b32 v19, 9535488
    s_mov_b32 s36, s18
    s_and_b32 s37, s19, 0xffff
    s_mov_b32 s38, 1605632
    s_mov_b32 s39, 0x20000
    s_lshl_b32 s101, s63, 1
    s_add_u32 s101, s101, s86
    v_lshrrev_b32 v30, 3, v1
    v_mul_u32_u24 v32, 896, v30
    v_and_b32 v30, 6, v30
    v_and_b32 v33, 7, v1
    v_xor_b32 v30, v30, v33
    v_lshl_add_u32 v32, v30, 4, v32
    s_lshl_b32 s3, s26, 7
    s_mul_i32 s27, s60, 7168
    s_add_u32 s3, s3, s27
    v_add_u32 v6, s3, v32
    s_lshl_b32 s56, s60, 10
    s_and_b32 s3, s60, 2
    s_add_u32 s3, s3, s86
    s_lshl_b32 s3, s3, 2
    s_lshr_b32 s27, s101, 3
    s_add_u32 s3, s3, s27
    s_lshl_b32 s3, s3, 7
    s_add_u32 s59, s3, 9531392
    s_mul_i32 s97, s99, 1
    s_add_u32 m0, s52, 32768
    s_nop 0
    buffer_load_dwordx4 v2, s[32:35], s97 offen  lds
    s_add_u32 m0, s53, 32768
    s_nop 0
    buffer_load_dwordx4 v3, s[32:35], s97 offen  lds
    s_add_u32 m0, s54, 32768
    s_nop 0
    buffer_load_dwordx4 v4, s[32:35], s97 offen  lds
    s_add_u32 m0, s55, 32768
    s_nop 0
    buffer_load_dwordx4 v5, s[32:35], s97 offen  lds
    s_waitcnt vmcnt(4)
    s_barrier
    ds_read_b128 v[24:27], v8 offset:0
    ds_read_b128 v[28:31], v9 offset:0
    ds_read_b128 v[32:35], v10 offset:0
    ds_read_b128 v[36:39], v11 offset:0
    ds_read_b64_tr_b16 v[40:41], v16 offset:0
    ds_read_b64_tr_b16 v[42:43], v16 offset:1024
    ds_read_b64_tr_b16 v[44:45], v17 offset:0
    ds_read_b64_tr_b16 v[46:47], v17 offset:1024
    s_waitcnt lgkmcnt(0)
    v_mfma_f32_16x16x32_bf16 v[104:107], v[20:23], v[24:27], 0
    ds_read_b128 v[48:51], v12 offset:0
    buffer_load_dword v18, v19, s[40:43], 0 offen sc1
    v_mfma_f32_16x16x32_bf16 v[108:111], v[40:43], v[20:23], 0
    ds_read_b128 v[52:55], v13 offset:0
    s_mul_i32 s97, s99, 2
    s_add_u32 m0, s52, 65536
    v_mfma_f32_16x16x32_bf16 v[72:75], v[40:43], v[24:27], 0
    ds_read_b128 v[56:59], v14 offset:0
    buffer_load_dwordx4 v2, s[32:35], s97 offen  lds
    v_mfma_f32_16x16x32_bf16 v[76:79], v[40:43], v[28:31], 0
    ds_read_b128 v[60:63], v15 offset:0
    s_add_u32 m0, s53, 65536
    v_mfma_f32_16x16x32_bf16 v[80:83], v[40:43], v[32:35], 0
    ds_read_b64_tr_b16 v[64:65], v16 offset:8192
    buffer_load_dwordx4 v3, s[32:35], s97 offen  lds
    v_mfma_f32_16x16x32_bf16 v[84:87], v[40:43], v[36:39], 0
    ds_read_b64_tr_b16 v[66:67], v16 offset:9216
    s_add_u32 m0, s54, 65536
    v_mfma_f32_16x16x32_bf16 v[88:91], v[44:47], v[24:27], 0
    ds_read_b64_tr_b16 v[68:69], v17 offset:8192
    buffer_load_dwordx4 v4, s[32:35], s97 offen  lds
    v_mfma_f32_16x16x32_bf16 v[92:95], v[44:47], v[28:31], 0
    ds_read_b64_tr_b16 v[70:71], v17 offset:9216
    s_add_u32 m0, s55, 65536
    v_mfma_f32_16x16x32_bf16 v[96:99], v[44:47], v[32:35], 0
    buffer_load_dwordx4 v5, s[32:35], s97 offen  lds
    v_mfma_f32_16x16x32_bf16 v[100:103], v[44:47], v[36:39], 0
    s_waitcnt vmcnt(5) lgkmcnt(0)
    s_barrier
    v_mfma_f32_16x16x32_bf16 v[104:107], v[20:23], v[48:51], v[104:107]
    ds_read_b128 v[24:27], v8 offset:32768
    v_mfma_f32_16x16x32_bf16 v[108:111], v[64:67], v[20:23], v[108:111]
    ds_read_b128 v[28:31], v9 offset:32768
    s_mul_i32 s97, s99, 3
    s_add_u32 m0, s52, 98304
    v_mfma_f32_16x16x32_bf16 v[72:75], v[64:67], v[48:51], v[72:75]
    ds_read_b128 v[32:35], v10 offset:32768
    buffer_load_dwordx4 v2, s[32:35], s97 offen  lds
    v_mfma_f32_16x16x32_bf16 v[76:79], v[64:67], v[52:55], v[76:79]
    ds_read_b128 v[36:39], v11 offset:32768
    v_mfma_f32_16x16x32_bf16 v[80:83], v[64:67], v[56:59], v[80:83]
    ds_read_b64_tr_b16 v[40:41], v16 offset:32768
    v_mfma_f32_16x16x32_bf16 v[84:87], v[64:67], v[60:63], v[84:87]
    ds_read_b64_tr_b16 v[42:43], v16 offset:33792
    s_add_u32 m0, s53, 98304
    v_mfma_f32_16x16x32_bf16 v[88:91], v[68:71], v[48:51], v[88:91]
    ds_read_b64_tr_b16 v[44:45], v17 offset:32768
    buffer_load_dwordx4 v3, s[32:35], s97 offen  lds
    v_mfma_f32_16x16x32_bf16 v[92:95], v[68:71], v[52:55], v[92:95]
    ds_read_b64_tr_b16 v[46:47], v17 offset:33792
    v_mfma_f32_16x16x32_bf16 v[96:99], v[68:71], v[56:59], v[96:99]
    v_mfma_f32_16x16x32_bf16 v[100:103], v[68:71], v[60:63], v[100:103]
    s_waitcnt lgkmcnt(0)
    v_mfma_f32_16x16x32_bf16 v[104:107], v[20:23], v[24:27], v[104:107]
    ds_read_b128 v[48:51], v12 offset:32768
    v_mfma_f32_16x16x32_bf16 v[108:111], v[40:43], v[20:23], v[108:111]
    ds_read_b128 v[52:55], v13 offset:32768
    s_add_u32 m0, s54, 98304
    v_mfma_f32_16x16x32_bf16 v[72:75], v[40:43], v[24:27], v[72:75]
    ds_read_b128 v[56:59], v14 offset:32768
    buffer_load_dwordx4 v4, s[32:35], s97 offen  lds
    v_mfma_f32_16x16x32_bf16 v[76:79], v[40:43], v[28:31], v[76:79]
    ds_read_b128 v[60:63], v15 offset:32768
    v_mfma_f32_16x16x32_bf16 v[80:83], v[40:43], v[32:35], v[80:83]
    ds_read_b64_tr_b16 v[64:65], v16 offset:40960
    v_mfma_f32_16x16x32_bf16 v[84:87], v[40:43], v[36:39], v[84:87]
    ds_read_b64_tr_b16 v[66:67], v16 offset:41984
    s_add_u32 m0, s55, 98304
    v_mfma_f32_16x16x32_bf16 v[88:91], v[44:47], v[24:27], v[88:91]
    ds_read_b64_tr_b16 v[68:69], v17 offset:40960
    buffer_load_dwordx4 v5, s[32:35], s97 offen  lds
    v_mfma_f32_16x16x32_bf16 v[92:95], v[44:47], v[28:31], v[92:95]
    ds_read_b64_tr_b16 v[70:71], v17 offset:41984
    v_mfma_f32_16x16x32_bf16 v[96:99], v[44:47], v[32:35], v[96:99]
    v_add_u32 v8, 65536, v8
    v_add_u32 v9, 65536, v9
    v_add_u32 v10, 65536, v10
    v_add_u32 v11, 65536, v11
    v_add_u32 v12, 65536, v12
    v_mfma_f32_16x16x32_bf16 v[100:103], v[44:47], v[36:39], v[100:103]
    v_add_u32 v13, 65536, v13
    v_add_u32 v14, 65536, v14
    v_add_u32 v15, 65536, v15
    v_add_u32 v16, 65536, v16
    v_add_u32 v17, 65536, v17
    s_waitcnt vmcnt(4) lgkmcnt(0)
    s_barrier
    v_mfma_f32_16x16x32_bf16 v[104:107], v[20:23], v[48:51], v[104:107]
    ds_read_b128 v[24:27], v8 offset:0
    v_readfirstlane_b32 s58, v18
    v_mfma_f32_16x16x32_bf16 v[108:111], v[64:67], v[20:23], v[108:111]
    ds_read_b128 v[28:31], v9 offset:0
    s_mul_i32 s97, s99, 4
    s_add_u32 m0, s52, 131072
    s_lshl_b32 s49, s26, 2
    v_mfma_f32_16x16x32_bf16 v[72:75], v[64:67], v[48:51], v[72:75]
    ds_read_b128 v[32:35], v10 offset:0
    buffer_load_dwordx4 v2, s[32:35], s97 offen  lds
    v_mov_b32 v121, s49
    v_mfma_f32_16x16x32_bf16 v[76:79], v[64:67], v[52:55], v[76:79]
    ds_read_b128 v[36:39], v11 offset:0
    s_mul_i32 s58, s58, 2654435761
    v_mfma_f32_16x16x32_bf16 v[80:83], v[64:67], v[56:59], v[80:83]
    ds_read_b64_tr_b16 v[40:41], v16 offset:0
    s_add_u32 s58, s58, 2135587861
    v_mfma_f32_16x16x32_bf16 v[84:87], v[64:67], v[60:63], v[84:87]
    ds_read_b64_tr_b16 v[42:43], v16 offset:1024
    s_add_u32 m0, s53, 131072
    v_min_u32 v123, 6, v1
    v_mfma_f32_16x16x32_bf16 v[88:91], v[68:71], v[48:51], v[88:91]
    ds_read_b64_tr_b16 v[44:45], v17 offset:0
    buffer_load_dwordx4 v3, s[32:35], s97 offen  lds
    v_lshlrev_b32 v123, 2, v123
    v_mfma_f32_16x16x32_bf16 v[92:95], v[68:71], v[52:55], v[92:95]
    ds_read_b64_tr_b16 v[46:47], v17 offset:1024
    v_mfma_f32_16x16x32_bf16 v[96:99], v[68:71], v[56:59], v[96:99]
    v_mfma_f32_16x16x32_bf16 v[100:103], v[68:71], v[60:63], v[100:103]
    s_waitcnt lgkmcnt(0)
    v_mfma_f32_16x16x32_bf16 v[104:107], v[20:23], v[24:27], v[104:107]
    ds_read_b128 v[48:51], v12 offset:0
    v_mfma_f32_16x16x32_bf16 v[108:111], v[40:43], v[20:23], v[108:111]
    ds_read_b128 v[52:55], v13 offset:0
    s_add_u32 m0, s54, 131072
    v_mfma_f32_16x16x32_bf16 v[72:75], v[40:43], v[24:27], v[72:75]
    ds_read_b128 v[56:59], v14 offset:0
    buffer_load_dwordx4 v4, s[32:35], s97 offen  lds
    v_mfma_f32_16x16x32_bf16 v[76:79], v[40:43], v[28:31], v[76:79]
    ds_read_b128 v[60:63], v15 offset:0
    v_mfma_f32_16x16x32_bf16 v[80:83], v[40:43], v[32:35], v[80:83]
    ds_read_b64_tr_b16 v[64:65], v16 offset:8192
    v_mfma_f32_16x16x32_bf16 v[84:87], v[40:43], v[36:39], v[84:87]
    ds_read_b64_tr_b16 v[66:67], v16 offset:9216
    s_add_u32 m0, s55, 131072
    v_mfma_f32_16x16x32_bf16 v[88:91], v[44:47], v[24:27], v[88:91]
    ds_read_b64_tr_b16 v[68:69], v17 offset:8192
    buffer_load_dwordx4 v5, s[32:35], s97 offen  lds
    v_mfma_f32_16x16x32_bf16 v[92:95], v[44:47], v[28:31], v[92:95]
    ds_read_b64_tr_b16 v[70:71], v17 offset:9216
    v_mfma_f32_16x16x32_bf16 v[96:99], v[44:47], v[32:35], v[96:99]
    v_mfma_f32_16x16x32_bf16 v[100:103], v[44:47], v[36:39], v[100:103]
    s_waitcnt vmcnt(4) lgkmcnt(0)
    s_barrier
    v_mfma_f32_16x16x32_bf16 v[104:107], v[20:23], v[48:51], v[104:107]
    ds_read_b128 v[24:27], v8 offset:32768
    v_mfma_f32_16x16x32_bf16 v[108:111], v[64:67], v[20:23], v[108:111]
    ds_read_b128 v[28:31], v9 offset:32768
    s_mul_i32 s97, s99, 5
    s_add_u32 m0, s52, 0
    v_mfma_f32_16x16x32_bf16 v[72:75], v[64:67], v[48:51], v[72:75]
    ds_read_b128 v[32:35], v10 offset:32768
    buffer_load_dwordx4 v2, s[32:35], s97 offen  lds
    v_mfma_f32_16x16x32_bf16 v[76:79], v[64:67], v[52:55], v[76:79]
    ds_read_b128 v[36:39], v11 offset:32768
    v_mfma_f32_16x16x32_bf16 v[80:83], v[64:67], v[56:59], v[80:83]
    ds_read_b64_tr_b16 v[40:41], v16 offset:32768
    v_mfma_f32_16x16x32_bf16 v[84:87], v[64:67], v[60:63], v[84:87]
    ds_read_b64_tr_b16 v[42:43], v16 offset:33792
    s_add_u32 m0, s53, 0
    v_mfma_f32_16x16x32_bf16 v[88:91], v[68:71], v[48:51], v[88:91]
    ds_read_b64_tr_b16 v[44:45], v17 offset:32768
    buffer_load_dwordx4 v3, s[32:35], s97 offen  lds
    v_mfma_f32_16x16x32_bf16 v[92:95], v[68:71], v[52:55], v[92:95]
    ds_read_b64_tr_b16 v[46:47], v17 offset:33792
    v_mfma_f32_16x16x32_bf16 v[96:99], v[68:71], v[56:59], v[96:99]
    v_mfma_f32_16x16x32_bf16 v[100:103], v[68:71], v[60:63], v[100:103]
    s_waitcnt lgkmcnt(0)
    v_mfma_f32_16x16x32_bf16 v[104:107], v[20:23], v[24:27], v[104:107]
    ds_read_b128 v[48:51], v12 offset:32768
    v_mfma_f32_16x16x32_bf16 v[108:111], v[40:43], v[20:23], v[108:111]
    ds_read_b128 v[52:55], v13 offset:32768
    s_add_u32 m0, s54, 0
    v_mfma_f32_16x16x32_bf16 v[72:75], v[40:43], v[24:27], v[72:75]
    ds_read_b128 v[56:59], v14 offset:32768
    buffer_load_dwordx4 v4, s[32:35], s97 offen  lds
    v_mfma_f32_16x16x32_bf16 v[76:79], v[40:43], v[28:31], v[76:79]
    ds_read_b128 v[60:63], v15 offset:32768
    v_mfma_f32_16x16x32_bf16 v[80:83], v[40:43], v[32:35], v[80:83]
    ds_read_b64_tr_b16 v[64:65], v16 offset:40960
    v_mfma_f32_16x16x32_bf16 v[84:87], v[40:43], v[36:39], v[84:87]
    ds_read_b64_tr_b16 v[66:67], v16 offset:41984
    s_add_u32 m0, s55, 0
    v_mfma_f32_16x16x32_bf16 v[88:91], v[44:47], v[24:27], v[88:91]
    ds_read_b64_tr_b16 v[68:69], v17 offset:40960
    buffer_load_dwordx4 v5, s[32:35], s97 offen  lds
    v_mfma_f32_16x16x32_bf16 v[92:95], v[44:47], v[28:31], v[92:95]
    ds_read_b64_tr_b16 v[70:71], v17 offset:41984
    v_mfma_f32_16x16x32_bf16 v[96:99], v[44:47], v[32:35], v[96:99]
    v_add_u32 v8, 65536, v8
    v_add_u32 v9, 65536, v9
    v_add_u32 v10, 65536, v10
    v_add_u32 v11, 65536, v11
    v_add_u32 v12, 65536, v12
    v_mfma_f32_16x16x32_bf16 v[100:103], v[44:47], v[36:39], v[100:103]
    v_add_u32 v13, 65536, v13
    v_add_u32 v14, 65536, v14
    v_add_u32 v15, 65536, v15
    v_add_u32 v16, 65536, v16
    v_add_u32 v17, 65536, v17
    s_waitcnt vmcnt(4) lgkmcnt(0)
    s_barrier
    v_mfma_f32_16x16x32_bf16 v[104:107], v[20:23], v[48:51], v[104:107]
    ds_read_b128 v[24:27], v8 offset:0
    v_mfma_f32_16x16x32_bf16 v[108:111], v[64:67], v[20:23], v[108:111]
    ds_read_b128 v[28:31], v9 offset:0
    s_mul_i32 s97, s99, 6
    s_add_u32 m0, s52, 32768
    v_mfma_f32_16x16x32_bf16 v[72:75], v[64:67], v[48:51], v[72:75]
    ds_read_b128 v[32:35], v10 offset:0
    buffer_load_dwordx4 v2, s[32:35], s97 offen  lds
    v_mfma_f32_16x16x32_bf16 v[76:79], v[64:67], v[52:55], v[76:79]
    ds_read_b128 v[36:39], v11 offset:0
    v_mfma_f32_16x16x32_bf16 v[80:83], v[64:67], v[56:59], v[80:83]
    ds_read_b64_tr_b16 v[40:41], v16 offset:0
    v_mfma_f32_16x16x32_bf16 v[84:87], v[64:67], v[60:63], v[84:87]
    ds_read_b64_tr_b16 v[42:43], v16 offset:1024
    s_add_u32 m0, s53, 32768
    v_mfma_f32_16x16x32_bf16 v[88:91], v[68:71], v[48:51], v[88:91]
    ds_read_b64_tr_b16 v[44:45], v17 offset:0
    buffer_load_dwordx4 v3, s[32:35], s97 offen  lds
    v_mfma_f32_16x16x32_bf16 v[92:95], v[68:71], v[52:55], v[92:95]
    ds_read_b64_tr_b16 v[46:47], v17 offset:1024
    v_mfma_f32_16x16x32_bf16 v[96:99], v[68:71], v[56:59], v[96:99]
    v_mfma_f32_16x16x32_bf16 v[100:103], v[68:71], v[60:63], v[100:103]
    s_waitcnt lgkmcnt(0)
    v_mfma_f32_16x16x32_bf16 v[104:107], v[20:23], v[24:27], v[104:107]
    ds_read_b128 v[48:51], v12 offset:0
    v_mfma_f32_16x16x32_bf16 v[108:111], v[40:43], v[20:23], v[108:111]
    ds_read_b128 v[52:55], v13 offset:0
    s_add_u32 m0, s54, 32768
    v_mfma_f32_16x16x32_bf16 v[72:75], v[40:43], v[24:27], v[72:75]
    ds_read_b128 v[56:59], v14 offset:0
    buffer_load_dwordx4 v4, s[32:35], s97 offen  lds
    v_mfma_f32_16x16x32_bf16 v[76:79], v[40:43], v[28:31], v[76:79]
    ds_read_b128 v[60:63], v15 offset:0
    s_add_u32 m0, s55, 32768
    v_mfma_f32_16x16x32_bf16 v[80:83], v[40:43], v[32:35], v[80:83]
    ds_read_b64_tr_b16 v[64:65], v16 offset:8192
    buffer_load_dwordx4 v5, s[32:35], s97 offen  lds
    v_mfma_f32_16x16x32_bf16 v[84:87], v[40:43], v[36:39], v[84:87]
    ds_read_b64_tr_b16 v[66:67], v16 offset:9216
    s_mul_i32 s57, s86, 7
    s_add_u32 s57, s57, s95
    s_mul_i32 s57, s57, 114688
    s_add_u32 s95, s95, 1
    s_cmp_eq_u32 s95, 7
    s_cselect_b32 s95, 0, s95
    s_add_u32 m0, s56, 65536
    v_mfma_f32_16x16x32_bf16 v[88:91], v[44:47], v[24:27], v[88:91]
    ds_read_b64_tr_b16 v[68:69], v17 offset:8192
    buffer_load_dwordx4 v6, s[36:39], s57 offen  lds
    v_mfma_f32_16x16x32_bf16 v[92:95], v[44:47], v[28:31], v[92:95]
    ds_read_b64_tr_b16 v[70:71], v17 offset:9216
    s_add_u32 s57, s57, 57344
    s_add_u32 m0, s56, 73728
    v_mfma_f32_16x16x32_bf16 v[96:99], v[44:47], v[32:35], v[96:99]
    v_add_u32 v8, 4294836224, v8
    v_add_u32 v9, 4294836224, v9
    v_add_u32 v10, 4294836224, v10
    v_add_u32 v11, 4294836224, v11
    v_add_u32 v12, 4294836224, v12
    buffer_load_dwordx4 v6, s[36:39], s57 offen  lds
    v_mfma_f32_16x16x32_bf16 v[100:103], v[44:47], v[36:39], v[100:103]
    v_add_u32 v13, 4294836224, v13
    v_add_u32 v14, 4294836224, v14
    v_add_u32 v15, 4294836224, v15
    v_add_u32 v16, 4294836224, v16
    v_add_u32 v17, 4294836224, v17
    s_waitcnt vmcnt(6) lgkmcnt(0)
    s_barrier
    v_mfma_f32_16x16x32_bf16 v[104:107], v[20:23], v[48:51], v[104:107]
    ds_read_b128 v[24:27], v8 offset:0
    v_mfma_f32_16x16x32_bf16 v[108:111], v[64:67], v[20:23], v[108:111]
    ds_read_b128 v[28:31], v9 offset:0
    s_mul_i32 s57, s86, 7
    s_add_u32 s57, s57, s95
    s_mul_i32 s57, s57, 114688
    s_add_u32 s95, s95, 1
    s_cmp_eq_u32 s95, 7
    s_cselect_b32 s95, 0, s95
    s_add_u32 m0, s56, 81920
    v_mfma_f32_16x16x32_bf16 v[72:75], v[64:67], v[48:51], v[72:75]
    ds_read_b128 v[32:35], v10 offset:0
    buffer_load_dwordx4 v6, s[36:39], s57 offen  lds
    v_mfma_f32_16x16x32_bf16 v[76:79], v[64:67], v[52:55], v[76:79]
    ds_read_b128 v[36:39], v11 offset:0
    v_mfma_f32_16x16x32_bf16 v[80:83], v[64:67], v[56:59], v[80:83]
    ds_read_b64_tr_b16 v[40:41], v16 offset:0
    v_mfma_f32_16x16x32_bf16 v[84:87], v[64:67], v[60:63], v[84:87]
    ds_read_b64_tr_b16 v[42:43], v16 offset:1024
    s_add_u32 s57, s57, 57344
    s_add_u32 m0, s56, 90112
    v_mfma_f32_16x16x32_bf16 v[88:91], v[68:71], v[48:51], v[88:91]
    ds_read_b64_tr_b16 v[44:45], v17 offset:0
    buffer_load_dwordx4 v6, s[36:39], s57 offen  lds
    v_mfma_f32_16x16x32_bf16 v[92:95], v[68:71], v[52:55], v[92:95]
    ds_read_b64_tr_b16 v[46:47], v17 offset:1024
    v_mfma_f32_16x16x32_bf16 v[96:99], v[68:71], v[56:59], v[96:99]
    v_mfma_f32_16x16x32_bf16 v[100:103], v[68:71], v[60:63], v[100:103]
    s_waitcnt lgkmcnt(0)
    v_mfma_f32_16x16x32_bf16 v[104:107], v[20:23], v[24:27], v[104:107]
    ds_read_b128 v[48:51], v12 offset:0
    v_mfma_f32_16x16x32_bf16 v[108:111], v[40:43], v[20:23], v[108:111]
    ds_read_b128 v[52:55], v13 offset:0
    s_mul_i32 s57, s86, 7
    s_add_u32 s57, s57, s95
    s_mul_i32 s57, s57, 114688
    s_add_u32 s95, s95, 1
    s_cmp_eq_u32 s95, 7
    s_cselect_b32 s95, 0, s95
    s_add_u32 m0, s56, 98304
    v_mfma_f32_16x16x32_bf16 v[72:75], v[40:43], v[24:27], v[72:75]
    ds_read_b128 v[56:59], v14 offset:0
    buffer_load_dwordx4 v6, s[36:39], s57 offen  lds
    v_mfma_f32_16x16x32_bf16 v[76:79], v[40:43], v[28:31], v[76:79]
    ds_read_b128 v[60:63], v15 offset:0
    v_mfma_f32_16x16x32_bf16 v[80:83], v[40:43], v[32:35], v[80:83]
    ds_read_b64_tr_b16 v[64:65], v16 offset:8192
    v_mfma_f32_16x16x32_bf16 v[84:87], v[40:43], v[36:39], v[84:87]
    ds_read_b64_tr_b16 v[66:67], v16 offset:9216
    s_add_u32 s57, s57, 57344
    s_add_u32 m0, s56, 106496
    v_mfma_f32_16x16x32_bf16 v[88:91], v[44:47], v[24:27], v[88:91]
    ds_read_b64_tr_b16 v[68:69], v17 offset:8192
    buffer_load_dwordx4 v6, s[36:39], s57 offen  lds
    v_mfma_f32_16x16x32_bf16 v[92:95], v[44:47], v[28:31], v[92:95]
    ds_read_b64_tr_b16 v[70:71], v17 offset:9216
    v_mfma_f32_16x16x32_bf16 v[96:99], v[44:47], v[32:35], v[96:99]
    v_mfma_f32_16x16x32_bf16 v[100:103], v[44:47], v[36:39], v[100:103]
    s_waitcnt vmcnt(6) lgkmcnt(0)
    s_barrier
    v_mfma_f32_16x16x32_bf16 v[104:107], v[20:23], v[48:51], v[104:107]
    ds_read_b128 v[24:27], v8 offset:32768
    v_mfma_f32_16x16x32_bf16 v[108:111], v[64:67], v[20:23], v[108:111]
    ds_read_b128 v[28:31], v9 offset:32768
    s_mul_i32 s57, s86, 7
    s_add_u32 s57, s57, s95
    s_mul_i32 s57, s57, 114688
    s_add_u32 s95, s95, 1
    s_cmp_eq_u32 s95, 7
    s_cselect_b32 s95, 0, s95
    s_add_u32 m0, s56, 114688
    v_mfma_f32_16x16x32_bf16 v[72:75], v[64:67], v[48:51], v[72:75]
    ds_read_b128 v[32:35], v10 offset:32768
    buffer_load_dwordx4 v6, s[36:39], s57 offen  lds
    v_mfma_f32_16x16x32_bf16 v[76:79], v[64:67], v[52:55], v[76:79]
    ds_read_b128 v[36:39], v11 offset:32768
    v_mfma_f32_16x16x32_bf16 v[80:83], v[64:67], v[56:59], v[80:83]
    ds_read_b64_tr_b16 v[40:41], v16 offset:32768
    v_mfma_f32_16x16x32_bf16 v[84:87], v[64:67], v[60:63], v[84:87]
    ds_read_b64_tr_b16 v[42:43], v16 offset:33792
    s_add_u32 s57, s57, 57344
    s_add_u32 m0, s56, 122880
    v_mfma_f32_16x16x32_bf16 v[88:91], v[68:71], v[48:51], v[88:91]
    ds_read_b64_tr_b16 v[44:45], v17 offset:32768
    buffer_load_dwordx4 v6, s[36:39], s57 offen  lds
    v_mfma_f32_16x16x32_bf16 v[92:95], v[68:71], v[52:55], v[92:95]
    ds_read_b64_tr_b16 v[46:47], v17 offset:33792
    v_mfma_f32_16x16x32_bf16 v[96:99], v[68:71], v[56:59], v[96:99]
    v_mfma_f32_16x16x32_bf16 v[100:103], v[68:71], v[60:63], v[100:103]
    s_waitcnt lgkmcnt(0)
    v_mfma_f32_16x16x32_bf16 v[104:107], v[20:23], v[24:27], v[104:107]
    ds_read_b128 v[48:51], v12 offset:32768
    v_mfma_f32_16x16x32_bf16 v[108:111], v[40:43], v[20:23], v[108:111]
    ds_read_b128 v[52:55], v13 offset:32768
    s_mul_i32 s57, s86, 7
    s_add_u32 s57, s57, s95
    s_mul_i32 s57, s57, 114688
    s_add_u32 s95, s95, 1
    s_cmp_eq_u32 s95, 7
    s_cselect_b32 s95, 0, s95
    s_add_u32 m0, s56, 131072
    v_mfma_f32_16x16x32_bf16 v[72:75], v[40:43], v[24:27], v[72:75]
    ds_read_b128 v[56:59], v14 offset:32768
    buffer_load_dwordx4 v6, s[36:39], s57 offen  lds
    v_mfma_f32_16x16x32_bf16 v[76:79], v[40:43], v[28:31], v[76:79]
    ds_read_b128 v[60:63], v15 offset:32768
    v_mfma_f32_16x16x32_bf16 v[80:83], v[40:43], v[32:35], v[80:83]
    ds_read_b64_tr_b16 v[64:65], v16 offset:40960
    v_mfma_f32_16x16x32_bf16 v[84:87], v[40:43], v[36:39], v[84:87]
    ds_read_b64_tr_b16 v[66:67], v16 offset:41984
    s_add_u32 s57, s57, 57344
    s_add_u32 m0, s56, 139264
    v_mfma_f32_16x16x32_bf16 v[88:91], v[44:47], v[24:27], v[88:91]
    ds_read_b64_tr_b16 v[68:69], v17 offset:40960
    buffer_load_dwordx4 v6, s[36:39], s57 offen  lds
    v_mfma_f32_16x16x32_bf16 v[92:95], v[44:47], v[28:31], v[92:95]
    ds_read_b64_tr_b16 v[70:71], v17 offset:41984
    v_mfma_f32_16x16x32_bf16 v[96:99], v[44:47], v[32:35], v[96:99]
    v_mfma_f32_16x16x32_bf16 v[100:103], v[44:47], v[36:39], v[100:103]
    s_waitcnt lgkmcnt(0)
    v_mfma_f32_16x16x32_bf16 v[104:107], v[20:23], v[48:51], v[104:107]
    v_and_b32 v30, 15, v1
    v_lshlrev_b32 v30, 2, v30
    v_lshlrev_b32 v16, 4, v1
    v_mov_b32 v7, 0
    v_lshrrev_b32 v124, 4, v1
    v_bfe_u32 v125, v1, 2, 2
    v_lshl_add_u32 v126, v124, 2, v125
    v_lshrrev_b32 v127, 1, v126
    v_and_b32 v127, 3, v127
    v_lshlrev_b32 v126, 7, v126
    v_mfma_f32_16x16x32_bf16 v[108:111], v[64:67], v[20:23], v[108:111]
    s_mul_i32 s57, s86, 7
    s_add_u32 s57, s57, s95
    s_mul_i32 s57, s57, 114688
    s_add_u32 s95, s95, 1
    s_cmp_eq_u32 s95, 7
    s_cselect_b32 s95, 0, s95
    s_add_u32 m0, s56, 147456
    s_lshl_b32 s3, s60, 6
    v_add_u32 v30, s3, v30
    v_and_b32 v125, 3, v1
    v_lshl_add_u32 v126, v125, 3, v126
    v_xor_b32 v125, 0, v127
    v_lshl_add_u32 v8, v125, 5, v126
    v_add_u32 v12, 0x10000, v8
    v_add_u32 v112, 0x20000, v8
    v_xor_b32 v125, 1, v127
    v_mfma_f32_16x16x32_bf16 v[72:75], v[64:67], v[48:51], v[72:75]
    buffer_load_dwordx4 v6, s[36:39], s57 offen  lds
    v_lshrrev_b32 v31, 4, v1
    v_lshlrev_b32 v31, 4, v31
    v_lshl_add_u32 v9, v125, 5, v126
    v_add_u32 v13, 0x10000, v9
    v_add_u32 v113, 0x20000, v9
    v_xor_b32 v125, 2, v127
    v_lshl_add_u32 v10, v125, 5, v126
    v_add_u32 v14, 0x10000, v10
    v_add_u32 v114, 0x20000, v10
    v_mfma_f32_16x16x32_bf16 v[76:79], v[64:67], v[52:55], v[76:79]
    s_and_b32 s27, s60, 3
    s_lshl_b32 s27, s27, 7
    v_xor_b32 v125, 3, v127
    v_lshl_add_u32 v11, v125, 5, v126
    v_add_u32 v15, 0x10000, v11
    v_add_u32 v115, 0x20000, v11
    s_lshl_b32 s48, s101, 2
    s_and_b32 s49, s60, 3
    s_add_u32 s48, s48, s49
    s_mul_i32 s50, s48, 57344
    v_mfma_f32_16x16x32_bf16 v[80:83], v[64:67], v[56:59], v[80:83]
    s_lshr_b32 s3, s60, 2
    s_lshl_b32 s3, s3, 6
    v_add_u32 v2, s50, v16
    s_xor_b32 s50, s48, 4
    s_mul_i32 s50, s50, 57344
    v_add_u32 v3, s50, v16
    s_and_b32 s48, s48, 7
    s_lshl_b32 s48, s48, 12
    s_add_u32 s48, s48, 32768
    v_mfma_f32_16x16x32_bf16 v[84:87], v[64:67], v[60:63], v[84:87]
    s_add_u32 s57, s57, 57344
    s_add_u32 m0, s56, 155648
    s_add_u32 s27, s27, s3
    v_add_u32 v31, s27, v31
    v_add_u32 v238, s48, v16
    v_xor_b32 v239, 16384, v238
    s_lshl_b32 s48, s63, 6
    s_add_u32 s48, s48, s86
    s_and_b32 s49, s60, 1
    s_lshl_b32 s49, s49, 5
    s_add_u32 s49, s49, s48
    v_mfma_f32_16x16x32_bf16 v[88:91], v[68:71], v[48:51], v[88:91]
    buffer_load_dwordx4 v6, s[36:39], s57 offen  lds
    v_xor_b32 v32, 64, v30
    v_xor_b32 v33, 128, v30
    v_lshrrev_b32 v124, 3, v1
    v_lshl_add_u32 v125, v124, 1, s49
    s_bfe_u32 s48, s60, 0x10001
    s_lshl_b32 s49, s48, 11
    s_lshl_b32 s48, s48, 1
    s_sub_u32 s48, 1, s48
    v_mul_i32_i24 v125, s48, v125
    v_add_u32 v125, s49, v125
    v_mfma_f32_16x16x32_bf16 v[92:95], v[68:71], v[52:55], v[92:95]
    v_xor_b32 v34, 192, v30
    v_xor_b32 v35, 64, v31
    s_mul_i32 s48, s48, 14336
    s_lshl_b32 s49, s26, 7
    v_mul_u32_u24 v126, 896, v125
    v_add_u32 v126, s48, v126
    v_lshrrev_b32 v127, 11, v125
    v_lshlrev_b32 v127, 10, v127
    v_sub_u32 v125, v125, v127
    v_mfma_f32_16x16x32_bf16 v[96:99], v[68:71], v[56:59], v[96:99]
    v_mul_u32_u24 v125, 896, v125
    v_and_b32 v127, 7, v1
    v_xor_b32 v127, v127, v124
    v_lshlrev_b32 v127, 4, v127
    v_add_u32 v127, s49, v127
    v_add_u32 v4, v125, v127
    v_add_u32 v5, v126, v127
    v_mfma_f32_16x16x32_bf16 v[100:103], v[68:71], v[60:63], v[100:103]
    ds_write_b32 v30, v104
    ds_write_b128 v31, v[108:111] offset:512
L_p1done:
    s_waitcnt lgkmcnt(0)
    s_barrier
    s_cmp_ge_u32 s60, 4
    s_cbranch_scc1 L_aux
    ds_read_b32 v25, v32
    ds_read_b32 v26, v33
    ds_read_b32 v27, v34
    ds_read_b128 v[28:31], v35 offset:512
    s_lshl_b32 s3, s60, 11
    s_add_u32 m0, s3, 4096
    s_nop 0
    buffer_load_dwordx4 v4, s[28:31], 0 offen lds
    s_add_u32 m0, s3, 5120
    s_nop 0
    buffer_load_dwordx4 v5, s[28:31], 0 offen lds
    s_lshl_b32 s97, s63, 3
    s_mul_i32 s97, s97, 56
    s_lshl_b32 s98, s96, 2
    s_add_u32 s97, s97, s98
    s_and_b32 s27, s60, 3
    s_add_u32 s97, s97, s27
    s_lshl_b32 s97, s97, 10
    s_lshl_b32 s27, s27, 10
    s_add_u32 s27, s27, 32768
    v_add_u32 v34, s27, v16
    s_mov_b32 s3, 991054117
    v_mul_f32 v24, s3, v104
    s_waitcnt lgkmcnt(0)
    v_mul_f32 v25, s3, v25
    v_mul_f32 v26, s3, v26
    v_mul_f32 v27, s3, v27
    v_cvt_pk_bf16_f32 v32, v24, v25
    v_cvt_pk_bf16_f32 v33, v26, v27
    v_lshlrev_b32 v24, 16, v32
    v_and_b32 v25, 0xffff0000, v32
    v_lshlrev_b32 v26, 16, v33
    v_and_b32 v27, 0xffff0000, v33
    v_pk_fma_f32 v[72:73], v[108:109], v[24:25], v[72:73] op_sel_hi:[1,0,1] neg_lo:[1,0,0] neg_hi:[1,0,0]
    v_pk_fma_f32 v[74:75], v[110:111], v[24:25], v[74:75] op_sel_hi:[1,0,1] neg_lo:[1,0,0] neg_hi:[1,0,0]
    v_pk_fma_f32 v[88:89], v[28:29], v[24:25], v[88:89] op_sel_hi:[1,0,1] neg_lo:[1,0,0] neg_hi:[1,0,0]
    v_pk_fma_f32 v[90:91], v[30:31], v[24:25], v[90:91] op_sel_hi:[1,0,1] neg_lo:[1,0,0] neg_hi:[1,0,0]
    v_cvt_pk_bf16_f32 v36, v72, v73
    v_cvt_pk_bf16_f32 v37, v74, v75
    v_cvt_pk_bf16_f32 v38, v88, v89
    v_cvt_pk_bf16_f32 v39, v90, v91
    v_pk_max_i16 v36, v36, 0
    v_pk_max_i16 v37, v37, 0
    v_pk_max_i16 v38, v38, 0
    v_pk_max_i16 v39, v39, 0
    s_xor_b32 s27, s60, 0
    s_mul_i32 s52, s27, 57344
    s_add_u32 s52, s52, s97
    buffer_store_dwordx4 v[36:39], v16, s[40:43], s52 offen sc1
    s_lshl_b32 s27, s27, 12
    v_add_u32 v35, s27, v34
    ds_write_b128 v35, v[36:39]
    v_pk_fma_f32 v[76:77], v[108:109], v[24:25], v[76:77] op_sel:[0,1,0] op_sel_hi:[1,1,1] neg_lo:[1,0,0] neg_hi:[1,0,0]
    v_pk_fma_f32 v[78:79], v[110:111], v[24:25], v[78:79] op_sel:[0,1,0] op_sel_hi:[1,1,1] neg_lo:[1,0,0] neg_hi:[1,0,0]
    v_pk_fma_f32 v[92:93], v[28:29], v[24:25], v[92:93] op_sel:[0,1,0] op_sel_hi:[1,1,1] neg_lo:[1,0,0] neg_hi:[1,0,0]
    v_pk_fma_f32 v[94:95], v[30:31], v[24:25], v[94:95] op_sel:[0,1,0] op_sel_hi:[1,1,1] neg_lo:[1,0,0] neg_hi:[1,0,0]
    v_cvt_pk_bf16_f32 v40, v76, v77
    v_cvt_pk_bf16_f32 v41, v78, v79
    v_cvt_pk_bf16_f32 v42, v92, v93
    v_cvt_pk_bf16_f32 v43, v94, v95
    v_pk_max_i16 v40, v40, 0
    v_pk_max_i16 v41, v41, 0
    v_pk_max_i16 v42, v42, 0
    v_pk_max_i16 v43, v43, 0
    s_xor_b32 s27, s60, 1
    s_mul_i32 s53, s27, 57344
    s_add_u32 s53, s53, s97
    buffer_store_dwordx4 v[40:43], v16, s[40:43], s53 offen sc1
    s_lshl_b32 s27, s27, 12
    v_add_u32 v35, s27, v34
    ds_write_b128 v35, v[40:43]
    v_pk_fma_f32 v[80:81], v[108:109], v[26:27], v[80:81] op_sel_hi:[1,0,1] neg_lo:[1,0,0] neg_hi:[1,0,0]
    v_pk_fma_f32 v[82:83], v[110:111], v[26:27], v[82:83] op_sel_hi:[1,0,1] neg_lo:[1,0,0] neg_hi:[1,0,0]
    v_pk_fma_f32 v[96:97], v[28:29], v[26:27], v[96:97] op_sel_hi:[1,0,1] neg_lo:[1,0,0] neg_hi:[1,0,0]
    v_pk_fma_f32 v[98:99], v[30:31], v[26:27], v[98:99] op_sel_hi:[1,0,1] neg_lo:[1,0,0] neg_hi:[1,0,0]
    v_cvt_pk_bf16_f32 v44, v80, v81
    v_cvt_pk_bf16_f32 v45, v82, v83
    v_cvt_pk_bf16_f32 v46, v96, v97
    v_cvt_pk_bf16_f32 v47, v98, v99
    v_pk_max_i16 v44, v44, 0
    v_pk_max_i16 v45, v45, 0
    v_pk_max_i16 v46, v46, 0
    v_pk_max_i16 v47, v47, 0
    s_xor_b32 s27, s60, 2
    s_mul_i32 s54, s27, 57344
    s_add_u32 s54, s54, s97
    buffer_store_dwordx4 v[44:47], v16, s[40:43], s54 offen sc1
    s_lshl_b32 s27, s27, 12
    v_add_u32 v35, s27, v34
    ds_write_b128 v35, v[44:47]
    v_pk_fma_f32 v[84:85], v[108:109], v[26:27], v[84:85] op_sel:[0,1,0] op_sel_hi:[1,1,1] neg_lo:[1,0,0] neg_hi:[1,0,0]
    v_pk_fma_f32 v[86:87], v[110:111], v[26:27], v[86:87] op_sel:[0,1,0] op_sel_hi:[1,1,1] neg_lo:[1,0,0] neg_hi:[1,0,0]
    v_pk_fma_f32 v[100:101], v[28:29], v[26:27], v[100:101] op_sel:[0,1,0] op_sel_hi:[1,1,1] neg_lo:[1,0,0] neg_hi:[1,0,0]
    v_pk_fma_f32 v[102:103], v[30:31], v[26:27], v[102:103] op_sel:[0,1,0] op_sel_hi:[1,1,1] neg_lo:[1,0,0] neg_hi:[1,0,0]
    v_cvt_pk_bf16_f32 v48, v84, v85
    v_cvt_pk_bf16_f32 v49, v86, v87
    v_cvt_pk_bf16_f32 v50, v100, v101
    v_cvt_pk_bf16_f32 v51, v102, v103
    v_pk_max_i16 v48, v48, 0
    v_pk_max_i16 v49, v49, 0
    v_pk_max_i16 v50, v50, 0
    v_pk_max_i16 v51, v51, 0
    s_xor_b32 s27, s60, 3
    s_mul_i32 s55, s27, 57344
    s_add_u32 s55, s55, s97
    buffer_store_dwordx4 v[48:51], v16, s[40:43], s55 offen sc1
    s_lshl_b32 s27, s27, 12
    v_add_u32 v35, s27, v34
    ds_write_b128 v35, v[48:51]
    s_lshl_b32 s3, s2, 14
    s_lshl_b32 s27, s60, 12
    s_add_u32 s3, s3, s27
    s_add_u32 s99, s3, 9568256
    s_mov_b32 s48, s20
    s_and_b32 s49, s21, 0xffff
    s_mov_b32 s50, 1835008
    s_mov_b32 s51, 0x20000
    v_and_b32 v20, 15, v1
    v_lshrrev_b32 v21, 4, v1
    v_lshrrev_b32 v22, 1, v21
    v_and_b32 v23, 7, v20
    v_xor_b32 v22, v22, v23
    v_lshlrev_b32 v22, 4, v22
    v_lshl_add_u32 v22, v20, 7, v22
    v_and_b32 v21, 1, v21
    v_lshl_add_u32 v22, v21, 3, v22
    s_lshl_b32 s27, s60, 11
    s_add_u32 s27, s27, 4096
    v_add_u32 v232, s27, v22
    v_add_u32 v23, s27, v16
    v_xor_b32 v233, 32, v232
    v_xor_b32 v234, 64, v232
    v_xor_b32 v235, 96, v232
    s_lshl_b32 s27, s60, 6
    s_add_u32 s27, s27, 53248
    v_lshl_add_u32 v20, v20, 2, s27
    s_and_b32 s27, s60, 1
    s_lshl_b32 s27, s27, 12
    s_add_u32 s27, s27, 32768
    v_add_u32 v19, s27, v16
    s_xor_b32 s100, s60, 2
    s_or_b32 s100, s100, s101
    s_sub_u32 s100, s100, 1
    s_lshr_b32 s100, s100, 31
    s_lshl_b32 s100, s100, 14
    v_add_u32 v18, s100, v19
    s_lshl_b32 s27, s60, 30
    s_and_b32 s27, s27, 0x80000000
    s_or_b32 s27, s27, 1.0
    v_mov_b32 v237, s27
    s_xor_b32 s96, s99, 16384
    s_waitcnt vmcnt(0) lgkmcnt(0)
    ds_read_b64 v[224:225], v232
    ds_read_b64 v[226:227], v233
    ds_read_b64 v[228:229], v234
    ds_read_b64 v[230:231], v235
    s_mul_i32 s57, s86, 7
    s_add_u32 s57, s57, s95
    s_mul_i32 s57, s57, 114688
    s_add_u32 s95, s95, 1
    s_cmp_eq_u32 s95, 7
    s_cselect_b32 s95, 0, s95
    s_add_u32 m0, s56, 16384
    s_nop 0
    buffer_load_dwordx4 v6, s[36:39], s57 offen  lds
    s_add_u32 s57, s57, 57344
    s_add_u32 m0, s56, 24576
    s_nop 0
    buffer_load_dwordx4 v6, s[36:39], s57 offen  lds
    s_barrier
    s_cmp_lg_u32 s60, 3
    s_cbranch_scc1 L_nopub
    v_mov_b32 v236, s58
    s_mov_b64 exec, 1
    s_add_u32 s3, s94, 4096
    buffer_store_dword v236, v121, s[40:43], s3 offen offset:16
    buffer_store_dword v236, v121, s[40:43], s94 offen offset:16 sc1
    s_mov_b64 exec, -1
L_nopub:
    s_and_b32 s95, s58, 1
    ds_read_b128 v[128:131], v238 offset:0
    ds_read_b128 v[132:135], v239 offset:0
    ds_read_b128 v[136:139], v238 offset:1024
    ds_read_b128 v[140:143], v239 offset:1024
    ds_read_b128 v[144:147], v238 offset:2048
    ds_read_b128 v[148:151], v239 offset:2048
    ds_read_b128 v[152:155], v238 offset:3072
    ds_read_b128 v[156:159], v239 offset:3072
    s_waitcnt lgkmcnt(0)
    v_lshlrev_b32 v96, 16, v224
    v_and_b32 v97, 0xffff0000, v224
    v_lshlrev_b32 v98, 16, v225
    v_and_b32 v99, 0xffff0000, v225
    v_lshlrev_b32 v100, 16, v226
    v_and_b32 v101, 0xffff0000, v226
    v_lshlrev_b32 v102, 16, v227
    v_and_b32 v103, 0xffff0000, v227
    v_lshlrev_b32 v104, 16, v228
    v_and_b32 v105, 0xffff0000, v228
    v_lshlrev_b32 v106, 16, v229
    v_and_b32 v107, 0xffff0000, v229
    v_lshlrev_b32 v108, 16, v230
    v_and_b32 v109, 0xffff0000, v230
    v_lshlrev_b32 v110, 16, v231
    v_and_b32 v111, 0xffff0000, v231
    s_mul_i32 s98, s86, 7
    s_add_u32 s6, s14, 1
    s_cmp_ge_u32 s6, 7
    s_cselect_b32 s3, 7, 0
    s_sub_u32 s6, s6, s3
    s_add_u32 s6, s6, s98
    s_lshl_b32 s6, s6, 12
    s_add_u32 s7, s14, 2
    s_cmp_ge_u32 s7, 7
    s_cselect_b32 s3, 7, 0
    s_sub_u32 s7, s7, s3
    s_add_u32 s7, s7, s98
    s_lshl_b32 s7, s7, 12
    s_add_u32 s8, s14, 3
    s_cmp_ge_u32 s8, 7
    s_cselect_b32 s3, 7, 0
    s_sub_u32 s8, s8, s3
    s_add_u32 s8, s8, s98
    s_lshl_b32 s8, s8, 12
    s_add_u32 s9, s14, 4
    s_cmp_ge_u32 s9, 7
    s_cselect_b32 s3, 7, 0
    s_sub_u32 s9, s9, s3
    s_add_u32 s9, s9, s98
    s_lshl_b32 s9, s9, 12
    s_add_u32 s10, s14, 5
    s_cmp_ge_u32 s10, 7
    s_cselect_b32 s3, 7, 0
    s_sub_u32 s10, s10, s3
    s_add_u32 s10, s10, s98
    s_lshl_b32 s10, s10, 12
    s_add_u32 s11, s14, 6
    s_cmp_ge_u32 s11, 7
    s_cselect_b32 s3, 7, 0
    s_sub_u32 s11, s11, s3
    s_add_u32 s11, s11, s98
    s_lshl_b32 s11, s11, 12
    s_cmp_lg_u32 s60, 3
    s_cbranch_scc1 L_nopoll
    s_mov_b32 s27, 0x3ffff
L_hpoll:
    s_and_b32 s3, s27, 3
    s_cselect_b32 s3, 4112, 16
    s_add_u32 s3, s3, s94
    buffer_load_dword v236, v123, s[40:43], s3 offen sc1
    s_waitcnt vmcnt(0)
    v_cmp_eq_u32 vcc, s58, v236
    s_nop 1
    s_cmp_eq_u64 vcc, exec
    s_cbranch_scc1 L_nopoll
    s_sub_u32 s27, s27, 1
    s_cbranch_scc0 L_hpoll
L_nopoll:
    s_waitcnt vmcnt(0) lgkmcnt(0)
    s_barrier
    buffer_load_dwordx4 v[160:163], v3, s[40:43], s6 offen offset:0 sc1
    buffer_load_dwordx4 v[164:167], v3, s[40:43], s6 offen offset:1024 sc1
    buffer_load_dwordx4 v[168:171], v3, s[40:43], s6 offen offset:2048 sc1
    buffer_load_dwordx4 v[172:175], v3, s[40:43], s6 offen offset:3072 sc1
    buffer_load_dwordx4 v[176:179], v3, s[40:43], s7 offen offset:0 sc1
    buffer_load_dwordx4 v[180:183], v3, s[40:43], s7 offen offset:1024 sc1
    buffer_load_dwordx4 v[184:187], v3, s[40:43], s7 offen offset:2048 sc1
    buffer_load_dwordx4 v[188:191], v3, s[40:43], s7 offen offset:3072 sc1
    buffer_load_dwordx4 v[192:195], v3, s[40:43], s8 offen offset:0 sc1
    buffer_load_dwordx4 v[196:199], v3, s[40:43], s8 offen offset:1024 sc1
    buffer_load_dwordx4 v[200:203], v3, s[40:43], s8 offen offset:2048 sc1
    buffer_load_dwordx4 v[204:207], v3, s[40:43], s8 offen offset:3072 sc1
    ds_read_b64_tr_b16 v[24:25], v12 offset:0
    ds_read_b64_tr_b16 v[26:27], v12 offset:2048
    ds_read_b64_tr_b16 v[28:29], v13 offset:0
    ds_read_b64_tr_b16 v[30:31], v13 offset:2048
    ds_read_b64_tr_b16 v[32:33], v14 offset:0
    ds_read_b64_tr_b16 v[34:35], v14 offset:2048
    ds_read_b64_tr_b16 v[36:37], v15 offset:0
    ds_read_b64_tr_b16 v[38:39], v15 offset:2048
    s_setprio 1
    s_waitcnt lgkmcnt(4)
    v_mfma_f32_16x16x32_bf16 v[56:59], v[24:27], v[128:131], 0
    ds_read_b64_tr_b16 v[40:41], v12 offset:4096
    v_mfma_f32_16x16x32_bf16 v[72:75], v[24:27], v[132:135], 0
    ds_read_b64_tr_b16 v[42:43], v12 offset:6144
    v_mfma_f32_16x16x32_bf16 v[60:63], v[28:31], v[128:131], 0
    ds_read_b64_tr_b16 v[44:45], v13 offset:4096
    v_mfma_f32_16x16x32_bf16 v[76:79], v[28:31], v[132:135], 0
    ds_read_b64_tr_b16 v[46:47], v13 offset:6144
    s_waitcnt lgkmcnt(4)
    v_mfma_f32_16x16x32_bf16 v[64:67], v[32:35], v[128:131], 0
    ds_read_b64_tr_b16 v[48:49], v14 offset:4096
    v_mfma_f32_16x16x32_bf16 v[80:83], v[32:35], v[132:135], 0
    ds_read_b64_tr_b16 v[50:51], v14 offset:6144
    v_mfma_f32_16x16x32_bf16 v[68:71], v[36:39], v[128:131], 0
    ds_read_b64_tr_b16 v[52:53], v15 offset:4096
    v_mfma_f32_16x16x32_bf16 v[84:87], v[36:39], v[132:135], 0
    ds_read_b64_tr_b16 v[54:55], v15 offset:6144
    s_waitcnt lgkmcnt(4)
    v_mfma_f32_16x16x32_bf16 v[56:59], v[40:43], v[136:139], v[56:59]
    ds_read_b64_tr_b16 v[24:25], v12 offset:8192
    v_mfma_f32_16x16x32_bf16 v[72:75], v[40:43], v[140:143], v[72:75]
    ds_read_b64_tr_b16 v[26:27], v12 offset:10240
    buffer_load_dwordx4 v[128:131], v3, s[40:43], s9 offen offset:0 sc1
    v_mfma_f32_16x16x32_bf16 v[60:63], v[44:47], v[136:139], v[60:63]
    ds_read_b64_tr_b16 v[28:29], v13 offset:8192
    v_mfma_f32_16x16x32_bf16 v[76:79], v[44:47], v[140:143], v[76:79]
    ds_read_b64_tr_b16 v[30:31], v13 offset:10240
    s_waitcnt lgkmcnt(4)
    v_mfma_f32_16x16x32_bf16 v[64:67], v[48:51], v[136:139], v[64:67]
    ds_read_b64_tr_b16 v[32:33], v14 offset:8192
    v_mfma_f32_16x16x32_bf16 v[80:83], v[48:51], v[140:143], v[80:83]
    ds_read_b64_tr_b16 v[34:35], v14 offset:10240
    buffer_load_dwordx4 v[132:135], v3, s[40:43], s9 offen offset:1024 sc1
    v_mfma_f32_16x16x32_bf16 v[68:71], v[52:55], v[136:139], v[68:71]
    ds_read_b64_tr_b16 v[36:37], v15 offset:8192
    v_mfma_f32_16x16x32_bf16 v[84:87], v[52:55], v[140:143], v[84:87]
    ds_read_b64_tr_b16 v[38:39], v15 offset:10240
    s_waitcnt lgkmcnt(4)
    v_mfma_f32_16x16x32_bf16 v[56:59], v[24:27], v[144:147], v[56:59]
    ds_read_b64_tr_b16 v[40:41], v12 offset:12288
    v_mfma_f32_16x16x32_bf16 v[72:75], v[24:27], v[148:151], v[72:75]
    ds_read_b64_tr_b16 v[42:43], v12 offset:14336
    buffer_load_dwordx4 v[136:139], v3, s[40:43], s9 offen offset:2048 sc1
    v_mfma_f32_16x16x32_bf16 v[60:63], v[28:31], v[144:147], v[60:63]
    ds_read_b64_tr_b16 v[44:45], v13 offset:12288
    v_mfma_f32_16x16x32_bf16 v[76:79], v[28:31], v[148:151], v[76:79]
    ds_read_b64_tr_b16 v[46:47], v13 offset:14336
    s_waitcnt lgkmcnt(4)
    v_mfma_f32_16x16x32_bf16 v[64:67], v[32:35], v[144:147], v[64:67]
    ds_read_b64_tr_b16 v[48:49], v14 offset:12288
    v_mfma_f32_16x16x32_bf16 v[80:83], v[32:35], v[148:151], v[80:83]
    ds_read_b64_tr_b16 v[50:51], v14 offset:14336
    buffer_load_dwordx4 v[140:143], v3, s[40:43], s9 offen offset:3072 sc1
    v_mfma_f32_16x16x32_bf16 v[68:71], v[36:39], v[144:147], v[68:71]
    ds_read_b64_tr_b16 v[52:53], v15 offset:12288
    v_mfma_f32_16x16x32_bf16 v[84:87], v[36:39], v[148:151], v[84:87]
    ds_read_b64_tr_b16 v[54:55], v15 offset:14336
    s_waitcnt lgkmcnt(4)
    v_mfma_f32_16x16x32_bf16 v[56:59], v[40:43], v[152:155], v[56:59]
    ds_read_b64_tr_b16 v[24:25], v12 offset:16384
    v_mfma_f32_16x16x32_bf16 v[72:75], v[40:43], v[156:159], v[72:75]
    ds_read_b64_tr_b16 v[26:27], v12 offset:18432
    buffer_load_dwordx4 v[144:147], v3, s[40:43], s10 offen offset:0 sc1
    v_mfma_f32_16x16x32_bf16 v[60:63], v[44:47], v[152:155], v[60:63]
    ds_read_b64_tr_b16 v[28:29], v13 offset:16384
    v_mfma_f32_16x16x32_bf16 v[76:79], v[44:47], v[156:159], v[76:79]
    ds_read_b64_tr_b16 v[30:31], v13 offset:18432
    s_waitcnt lgkmcnt(4)
    v_mfma_f32_16x16x32_bf16 v[64:67], v[48:51], v[152:155], v[64:67]
    ds_read_b64_tr_b16 v[32:33], v14 offset:16384
    v_mfma_f32_16x16x32_bf16 v[80:83], v[48:51], v[156:159], v[80:83]
    ds_read_b64_tr_b16 v[34:35], v14 offset:18432
    buffer_load_dwordx4 v[148:151], v3, s[40:43], s10 offen offset:1024 sc1
    v_mfma_f32_16x16x32_bf16 v[68:71], v[52:55], v[152:155], v[68:71]
    ds_read_b64_tr_b16 v[36:37], v15 offset:16384
    v_mfma_f32_16x16x32_bf16 v[84:87], v[52:55], v[156:159], v[84:87]
    ds_read_b64_tr_b16 v[38:39], v15 offset:18432
    s_waitcnt vmcnt(17) lgkmcnt(4)
    v_mfma_f32_16x16x32_bf16 v[72:75], v[24:27], v[160:163], v[72:75]
    ds_read_b64_tr_b16 v[40:41], v12 offset:20480
    ds_read_b64_tr_b16 v[42:43], v12 offset:22528
    v_mfma_f32_16x16x32_bf16 v[76:79], v[28:31], v[160:163], v[76:79]
    ds_read_b64_tr_b16 v[44:45], v13 offset:20480
    ds_read_b64_tr_b16 v[46:47], v13 offset:22528
    buffer_load_dwordx4 v[152:155], v3, s[40:43], s10 offen offset:2048 sc1
    s_waitcnt lgkmcnt(4)
    v_mfma_f32_16x16x32_bf16 v[80:83], v[32:35], v[160:163], v[80:83]
    ds_read_b64_tr_b16 v[48:49], v14 offset:20480
    ds_read_b64_tr_b16 v[50:51], v14 offset:22528
    v_mfma_f32_16x16x32_bf16 v[84:87], v[36:39], v[160:163], v[84:87]
    ds_read_b64_tr_b16 v[52:53], v15 offset:20480
    ds_read_b64_tr_b16 v[54:55], v15 offset:22528
    buffer_load_dwordx4 v[156:159], v3, s[40:43], s10 offen offset:3072 sc1
    s_waitcnt vmcnt(18) lgkmcnt(4)
    v_mfma_f32_16x16x32_bf16 v[72:75], v[40:43], v[164:167], v[72:75]
    ds_read_b64_tr_b16 v[24:25], v12 offset:24576
    ds_read_b64_tr_b16 v[26:27], v12 offset:26624
    v_mfma_f32_16x16x32_bf16 v[76:79], v[44:47], v[164:167], v[76:79]
    ds_read_b64_tr_b16 v[28:29], v13 offset:24576
    ds_read_b64_tr_b16 v[30:31], v13 offset:26624
    buffer_load_dwordx4 v[160:163], v2, s[40:43], s11 offen offset:0 sc1
    s_waitcnt lgkmcnt(4)
    v_mfma_f32_16x16x32_bf16 v[80:83], v[48:51], v[164:167], v[80:83]
    ds_read_b64_tr_b16 v[32:33], v14 offset:24576
    ds_read_b64_tr_b16 v[34:35], v14 offset:26624
    v_mfma_f32_16x16x32_bf16 v[84:87], v[52:55], v[164:167], v[84:87]
    ds_read_b64_tr_b16 v[36:37], v15 offset:24576
    ds_read_b64_tr_b16 v[38:39], v15 offset:26624
    s_waitcnt vmcnt(18) lgkmcnt(4)
    v_mfma_f32_16x16x32_bf16 v[72:75], v[24:27], v[168:171], v[72:75]
    ds_read_b64_tr_b16 v[40:41], v12 offset:28672
    ds_read_b64_tr_b16 v[42:43], v12 offset:30720
    v_mfma_f32_16x16x32_bf16 v[76:79], v[28:31], v[168:171], v[76:79]
    ds_read_b64_tr_b16 v[44:45], v13 offset:28672
    ds_read_b64_tr_b16 v[46:47], v13 offset:30720
    buffer_load_dwordx4 v[164:167], v3, s[40:43], s11 offen offset:0 sc1
    s_waitcnt lgkmcnt(4)
    v_mfma_f32_16x16x32_bf16 v[80:83], v[32:35], v[168:171], v[80:83]
    ds_read_b64_tr_b16 v[48:49], v14 offset:28672
    ds_read_b64_tr_b16 v[50:51], v14 offset:30720
    v_mfma_f32_16x16x32_bf16 v[84:87], v[36:39], v[168:171], v[84:87]
    ds_read_b64_tr_b16 v[52:53], v15 offset:28672
    ds_read_b64_tr_b16 v[54:55], v15 offset:30720
    s_waitcnt vmcnt(18) lgkmcnt(4)
    v_mfma_f32_16x16x32_bf16 v[72:75], v[40:43], v[172:175], v[72:75]
    ds_read_b64_tr_b16 v[24:25], v12 offset:32768
    ds_read_b64_tr_b16 v[26:27], v12 offset:34816
    v_mfma_f32_16x16x32_bf16 v[76:79], v[44:47], v[172:175], v[76:79]
    ds_read_b64_tr_b16 v[28:29], v13 offset:32768
    ds_read_b64_tr_b16 v[30:31], v13 offset:34816
    buffer_load_dwordx4 v[168:171], v2, s[40:43], s11 offen offset:1024 sc1
    s_waitcnt lgkmcnt(4)
    v_mfma_f32_16x16x32_bf16 v[80:83], v[48:51], v[172:175], v[80:83]
    ds_read_b64_tr_b16 v[32:33], v14 offset:32768
    ds_read_b64_tr_b16 v[34:35], v14 offset:34816
    v_mfma_f32_16x16x32_bf16 v[84:87], v[52:55], v[172:175], v[84:87]
    ds_read_b64_tr_b16 v[36:37], v15 offset:32768
    ds_read_b64_tr_b16 v[38:39], v15 offset:34816
    s_waitcnt vmcnt(18) lgkmcnt(4)
    v_mfma_f32_16x16x32_bf16 v[72:75], v[24:27], v[176:179], v[72:75]
    ds_read_b64_tr_b16 v[40:41], v12 offset:36864
    ds_read_b64_tr_b16 v[42:43], v12 offset:38912
    v_mfma_f32_16x16x32_bf16 v[76:79], v[28:31], v[176:179], v[76:79]
    ds_read_b64_tr_b16 v[44:45], v13 offset:36864
    ds_read_b64_tr_b16 v[46:47], v13 offset:38912
    buffer_load_dwordx4 v[172:175], v3, s[40:43], s11 offen offset:1024 sc1
    s_waitcnt lgkmcnt(4)
    v_mfma_f32_16x16x32_bf16 v[80:83], v[32:35], v[176:179], v[80:83]
    ds_read_b64_tr_b16 v[48:49], v14 offset:36864
    ds_read_b64_tr_b16 v[50:51], v14 offset:38912
    v_mfma_f32_16x16x32_bf16 v[84:87], v[36:39], v[176:179], v[84:87]
    ds_read_b64_tr_b16 v[52:53], v15 offset:36864
    ds_read_b64_tr_b16 v[54:55], v15 offset:38912
    s_waitcnt vmcnt(18) lgkmcnt(4)
    v_mfma_f32_16x16x32_bf16 v[72:75], v[40:43], v[180:183], v[72:75]
    ds_read_b64_tr_b16 v[24:25], v12 offset:40960
    ds_read_b64_tr_b16 v[26:27], v12 offset:43008
    v_mfma_f32_16x16x32_bf16 v[76:79], v[44:47], v[180:183], v[76:79]
    ds_read_b64_tr_b16 v[28:29], v13 offset:40960
    ds_read_b64_tr_b16 v[30:31], v13 offset:43008
    buffer_load_dwordx4 v[176:179], v2, s[40:43], s11 offen offset:2048 sc1
    s_waitcnt lgkmcnt(4)
    v_mfma_f32_16x16x32_bf16 v[80:83], v[48:51], v[180:183], v[80:83]
    ds_read_b64_tr_b16 v[32:33], v14 offset:40960
    ds_read_b64_tr_b16 v[34:35], v14 offset:43008
    v_mfma_f32_16x16x32_bf16 v[84:87], v[52:55], v[180:183], v[84:87]
    ds_read_b64_tr_b16 v[36:37], v15 offset:40960
    ds_read_b64_tr_b16 v[38:39], v15 offset:43008
    s_waitcnt vmcnt(18) lgkmcnt(4)
    v_mfma_f32_16x16x32_bf16 v[72:75], v[24:27], v[184:187], v[72:75]
    ds_read_b64_tr_b16 v[40:41], v12 offset:45056
    ds_read_b64_tr_b16 v[42:43], v12 offset:47104
    v_mfma_f32_16x16x32_bf16 v[76:79], v[28:31], v[184:187], v[76:79]
    ds_read_b64_tr_b16 v[44:45], v13 offset:45056
    ds_read_b64_tr_b16 v[46:47], v13 offset:47104
    buffer_load_dwordx4 v[180:183], v3, s[40:43], s11 offen offset:2048 sc1
    s_waitcnt lgkmcnt(4)
    v_mfma_f32_16x16x32_bf16 v[80:83], v[32:35], v[184:187], v[80:83]
    ds_read_b64_tr_b16 v[48:49], v14 offset:45056
    ds_read_b64_tr_b16 v[50:51], v14 offset:47104
    v_mfma_f32_16x16x32_bf16 v[84:87], v[36:39], v[184:187], v[84:87]
    ds_read_b64_tr_b16 v[52:53], v15 offset:45056
    ds_read_b64_tr_b16 v[54:55], v15 offset:47104
    s_waitcnt vmcnt(18) lgkmcnt(4)
    v_mfma_f32_16x16x32_bf16 v[72:75], v[40:43], v[188:191], v[72:75]
    ds_read_b64_tr_b16 v[24:25], v12 offset:49152
    ds_read_b64_tr_b16 v[26:27], v12 offset:51200
    v_mfma_f32_16x16x32_bf16 v[76:79], v[44:47], v[188:191], v[76:79]
    ds_read_b64_tr_b16 v[28:29], v13 offset:49152
    ds_read_b64_tr_b16 v[30:31], v13 offset:51200
    buffer_load_dwordx4 v[184:187], v2, s[40:43], s11 offen offset:3072 sc1
    s_waitcnt lgkmcnt(4)
    v_mfma_f32_16x16x32_bf16 v[80:83], v[48:51], v[188:191], v[80:83]
    ds_read_b64_tr_b16 v[32:33], v14 offset:49152
    ds_read_b64_tr_b16 v[34:35], v14 offset:51200
    v_mfma_f32_16x16x32_bf16 v[84:87], v[52:55], v[188:191], v[84:87]
    ds_read_b64_tr_b16 v[36:37], v15 offset:49152
    ds_read_b64_tr_b16 v[38:39], v15 offset:51200
    s_waitcnt vmcnt(18) lgkmcnt(4)
    v_mfma_f32_16x16x32_bf16 v[72:75], v[24:27], v[192:195], v[72:75]
    ds_read_b64_tr_b16 v[40:41], v12 offset:53248
    ds_read_b64_tr_b16 v[42:43], v12 offset:55296
    v_mfma_f32_16x16x32_bf16 v[76:79], v[28:31], v[192:195], v[76:79]
    ds_read_b64_tr_b16 v[44:45], v13 offset:53248
    ds_read_b64_tr_b16 v[46:47], v13 offset:55296
    buffer_load_dwordx4 v[188:191], v3, s[40:43], s11 offen offset:3072 sc1
    s_waitcnt lgkmcnt(4)
    v_mfma_f32_16x16x32_bf16 v[80:83], v[32:35], v[192:195], v[80:83]
    ds_read_b64_tr_b16 v[48:49], v14 offset:53248
    ds_read_b64_tr_b16 v[50:51], v14 offset:55296
    v_mfma_f32_16x16x32_bf16 v[84:87], v[36:39], v[192:195], v[84:87]
    ds_read_b64_tr_b16 v[52:53], v15 offset:53248
    ds_read_b64_tr_b16 v[54:55], v15 offset:55296
    s_waitcnt vmcnt(18) lgkmcnt(4)
    v_mfma_f32_16x16x32_bf16 v[72:75], v[40:43], v[196:199], v[72:75]
    ds_read_b64_tr_b16 v[24:25], v12 offset:57344
    ds_read_b64_tr_b16 v[26:27], v12 offset:59392
    v_mfma_f32_16x16x32_bf16 v[76:79], v[44:47], v[196:199], v[76:79]
    ds_read_b64_tr_b16 v[28:29], v13 offset:57344
    ds_read_b64_tr_b16 v[30:31], v13 offset:59392
    buffer_load_dwordx4 v[192:195], v2, s[40:43], s6 offen offset:0 sc1
    s_waitcnt lgkmcnt(4)
    v_mfma_f32_16x16x32_bf16 v[80:83], v[48:51], v[196:199], v[80:83]
    ds_read_b64_tr_b16 v[32:33], v14 offset:57344
    ds_read_b64_tr_b16 v[34:35], v14 offset:59392
    v_mfma_f32_16x16x32_bf16 v[84:87], v[52:55], v[196:199], v[84:87]
    ds_read_b64_tr_b16 v[36:37], v15 offset:57344
    ds_read_b64_tr_b16 v[38:39], v15 offset:59392
    s_waitcnt vmcnt(18) lgkmcnt(4)
    v_mfma_f32_16x16x32_bf16 v[72:75], v[24:27], v[200:203], v[72:75]
    ds_read_b64_tr_b16 v[40:41], v12 offset:61440
    ds_read_b64_tr_b16 v[42:43], v12 offset:63488
    v_mfma_f32_16x16x32_bf16 v[76:79], v[28:31], v[200:203], v[76:79]
    ds_read_b64_tr_b16 v[44:45], v13 offset:61440
    ds_read_b64_tr_b16 v[46:47], v13 offset:63488
    buffer_load_dwordx4 v[196:199], v2, s[40:43], s6 offen offset:1024 sc1
    s_waitcnt lgkmcnt(4)
    v_mfma_f32_16x16x32_bf16 v[80:83], v[32:35], v[200:203], v[80:83]
    ds_read_b64_tr_b16 v[48:49], v14 offset:61440
    ds_read_b64_tr_b16 v[50:51], v14 offset:63488
    v_mfma_f32_16x16x32_bf16 v[84:87], v[36:39], v[200:203], v[84:87]
    ds_read_b64_tr_b16 v[52:53], v15 offset:61440
    ds_read_b64_tr_b16 v[54:55], v15 offset:63488
    s_waitcnt vmcnt(18) lgkmcnt(4)
    v_mfma_f32_16x16x32_bf16 v[72:75], v[40:43], v[204:207], v[72:75]
    ds_read_b64_tr_b16 v[24:25], v112 offset:0
    ds_read_b64_tr_b16 v[26:27], v112 offset:2048
    v_mfma_f32_16x16x32_bf16 v[76:79], v[44:47], v[204:207], v[76:79]
    ds_read_b64_tr_b16 v[28:29], v113 offset:0
    ds_read_b64_tr_b16 v[30:31], v113 offset:2048
    buffer_load_dwordx4 v[200:203], v2, s[40:43], s6 offen offset:2048 sc1
    s_waitcnt lgkmcnt(4)
    v_mfma_f32_16x16x32_bf16 v[80:83], v[48:51], v[204:207], v[80:83]
    ds_read_b64_tr_b16 v[32:33], v114 offset:0
    ds_read_b64_tr_b16 v[34:35], v114 offset:2048
    v_mfma_f32_16x16x32_bf16 v[84:87], v[52:55], v[204:207], v[84:87]
    ds_read_b64_tr_b16 v[36:37], v115 offset:0
    ds_read_b64_tr_b16 v[38:39], v115 offset:2048
    s_waitcnt vmcnt(18) lgkmcnt(4)
    v_mfma_f32_16x16x32_bf16 v[72:75], v[24:27], v[128:131], v[72:75]
    ds_read_b64_tr_b16 v[40:41], v112 offset:4096
    ds_read_b64_tr_b16 v[42:43], v112 offset:6144
    v_mfma_f32_16x16x32_bf16 v[76:79], v[28:31], v[128:131], v[76:79]
    ds_read_b64_tr_b16 v[44:45], v113 offset:4096
    ds_read_b64_tr_b16 v[46:47], v113 offset:6144
    buffer_load_dwordx4 v[204:207], v2, s[40:43], s6 offen offset:3072 sc1
    s_waitcnt lgkmcnt(4)
    v_mfma_f32_16x16x32_bf16 v[80:83], v[32:35], v[128:131], v[80:83]
    ds_read_b64_tr_b16 v[48:49], v114 offset:4096
    ds_read_b64_tr_b16 v[50:51], v114 offset:6144
    v_mfma_f32_16x16x32_bf16 v[84:87], v[36:39], v[128:131], v[84:87]
    ds_read_b64_tr_b16 v[52:53], v115 offset:4096
    ds_read_b64_tr_b16 v[54:55], v115 offset:6144
    s_waitcnt vmcnt(18) lgkmcnt(4)
    v_mfma_f32_16x16x32_bf16 v[72:75], v[40:43], v[132:135], v[72:75]
    ds_read_b64_tr_b16 v[24:25], v112 offset:8192
    ds_read_b64_tr_b16 v[26:27], v112 offset:10240
    v_mfma_f32_16x16x32_bf16 v[76:79], v[44:47], v[132:135], v[76:79]
    ds_read_b64_tr_b16 v[28:29], v113 offset:8192
    ds_read_b64_tr_b16 v[30:31], v113 offset:10240
    buffer_load_dwordx4 v[128:131], v2, s[40:43], s7 offen offset:0 sc1
    s_waitcnt lgkmcnt(4)
    v_mfma_f32_16x16x32_bf16 v[80:83], v[48:51], v[132:135], v[80:83]
    ds_read_b64_tr_b16 v[32:33], v114 offset:8192
    ds_read_b64_tr_b16 v[34:35], v114 offset:10240
    v_mfma_f32_16x16x32_bf16 v[84:87], v[52:55], v[132:135], v[84:87]
    ds_read_b64_tr_b16 v[36:37], v115 offset:8192
    ds_read_b64_tr_b16 v[38:39], v115 offset:10240
    s_waitcnt vmcnt(18) lgkmcnt(4)
    v_mfma_f32_16x16x32_bf16 v[72:75], v[24:27], v[136:139], v[72:75]
    ds_read_b64_tr_b16 v[40:41], v112 offset:12288
    ds_read_b64_tr_b16 v[42:43], v112 offset:14336
    v_mfma_f32_16x16x32_bf16 v[76:79], v[28:31], v[136:139], v[76:79]
    ds_read_b64_tr_b16 v[44:45], v113 offset:12288
    ds_read_b64_tr_b16 v[46:47], v113 offset:14336
    buffer_load_dwordx4 v[132:135], v2, s[40:43], s7 offen offset:1024 sc1
    s_waitcnt lgkmcnt(4)
    v_mfma_f32_16x16x32_bf16 v[80:83], v[32:35], v[136:139], v[80:83]
    ds_read_b64_tr_b16 v[48:49], v114 offset:12288
    ds_read_b64_tr_b16 v[50:51], v114 offset:14336
    v_mfma_f32_16x16x32_bf16 v[84:87], v[36:39], v[136:139], v[84:87]
    ds_read_b64_tr_b16 v[52:53], v115 offset:12288
    ds_read_b64_tr_b16 v[54:55], v115 offset:14336
    s_waitcnt vmcnt(18) lgkmcnt(4)
    v_mfma_f32_16x16x32_bf16 v[72:75], v[40:43], v[140:143], v[72:75]
    ds_read_b64_tr_b16 v[24:25], v112 offset:16384
    ds_read_b64_tr_b16 v[26:27], v112 offset:18432
    v_mfma_f32_16x16x32_bf16 v[76:79], v[44:47], v[140:143], v[76:79]
    ds_read_b64_tr_b16 v[28:29], v113 offset:16384
    ds_read_b64_tr_b16 v[30:31], v113 offset:18432
    buffer_load_dwordx4 v[136:139], v2, s[40:43], s7 offen offset:2048 sc1
    s_waitcnt lgkmcnt(4)
    v_mfma_f32_16x16x32_bf16 v[80:83], v[48:51], v[140:143], v[80:83]
    ds_read_b64_tr_b16 v[32:33], v114 offset:16384
    ds_read_b64_tr_b16 v[34:35], v114 offset:18432
    v_mfma_f32_16x16x32_bf16 v[84:87], v[52:55], v[140:143], v[84:87]
    ds_read_b64_tr_b16 v[36:37], v115 offset:16384
    ds_read_b64_tr_b16 v[38:39], v115 offset:18432
    s_waitcnt vmcnt(18) lgkmcnt(4)
    v_mfma_f32_16x16x32_bf16 v[72:75], v[24:27], v[144:147], v[72:75]
    ds_read_b64_tr_b16 v[40:41], v112 offset:20480
    ds_read_b64_tr_b16 v[42:43], v112 offset:22528
    v_mfma_f32_16x16x32_bf16 v[76:79], v[28:31], v[144:147], v[76:79]
    ds_read_b64_tr_b16 v[44:45], v113 offset:20480
    ds_read_b64_tr_b16 v[46:47], v113 offset:22528
    buffer_load_dwordx4 v[140:143], v2, s[40:43], s7 offen offset:3072 sc1
    s_waitcnt lgkmcnt(4)
    v_mfma_f32_16x16x32_bf16 v[80:83], v[32:35], v[144:147], v[80:83]
    ds_read_b64_tr_b16 v[48:49], v114 offset:20480
    ds_read_b64_tr_b16 v[50:51], v114 offset:22528
    v_mfma_f32_16x16x32_bf16 v[84:87], v[36:39], v[144:147], v[84:87]
    ds_read_b64_tr_b16 v[52:53], v115 offset:20480
    ds_read_b64_tr_b16 v[54:55], v115 offset:22528
    s_waitcnt vmcnt(18) lgkmcnt(4)
    v_mfma_f32_16x16x32_bf16 v[72:75], v[40:43], v[148:151], v[72:75]
    ds_read_b64_tr_b16 v[24:25], v112 offset:24576
    ds_read_b64_tr_b16 v[26:27], v112 offset:26624
    v_mfma_f32_16x16x32_bf16 v[76:79], v[44:47], v[148:151], v[76:79]
    ds_read_b64_tr_b16 v[28:29], v113 offset:24576
    ds_read_b64_tr_b16 v[30:31], v113 offset:26624
    buffer_load_dwordx4 v[144:147], v2, s[40:43], s8 offen offset:0 sc1
    s_waitcnt lgkmcnt(4)
    v_mfma_f32_16x16x32_bf16 v[80:83], v[48:51], v[148:151], v[80:83]
    ds_read_b64_tr_b16 v[32:33], v114 offset:24576
    ds_read_b64_tr_b16 v[34:35], v114 offset:26624
    v_mfma_f32_16x16x32_bf16 v[84:87], v[52:55], v[148:151], v[84:87]
    ds_read_b64_tr_b16 v[36:37], v115 offset:24576
    ds_read_b64_tr_b16 v[38:39], v115 offset:26624
    s_waitcnt vmcnt(18) lgkmcnt(4)
    v_mfma_f32_16x16x32_bf16 v[72:75], v[24:27], v[152:155], v[72:75]
    ds_read_b64_tr_b16 v[40:41], v112 offset:28672
    ds_read_b64_tr_b16 v[42:43], v112 offset:30720
    v_mfma_f32_16x16x32_bf16 v[76:79], v[28:31], v[152:155], v[76:79]
    ds_read_b64_tr_b16 v[44:45], v113 offset:28672
    ds_read_b64_tr_b16 v[46:47], v113 offset:30720
    buffer_load_dwordx4 v[148:151], v2, s[40:43], s8 offen offset:1024 sc1
    s_waitcnt lgkmcnt(4)
    v_mfma_f32_16x16x32_bf16 v[80:83], v[32:35], v[152:155], v[80:83]
    ds_read_b64_tr_b16 v[48:49], v114 offset:28672
    ds_read_b64_tr_b16 v[50:51], v114 offset:30720
    v_mfma_f32_16x16x32_bf16 v[84:87], v[36:39], v[152:155], v[84:87]
    ds_read_b64_tr_b16 v[52:53], v115 offset:28672
    ds_read_b64_tr_b16 v[54:55], v115 offset:30720
    s_waitcnt vmcnt(18) lgkmcnt(4)
    v_mfma_f32_16x16x32_bf16 v[72:75], v[40:43], v[156:159], v[72:75]
    ds_read_b64_tr_b16 v[24:25], v8 offset:16384
    ds_read_b64_tr_b16 v[26:27], v8 offset:18432
    v_mfma_f32_16x16x32_bf16 v[76:79], v[44:47], v[156:159], v[76:79]
    ds_read_b64_tr_b16 v[28:29], v9 offset:16384
    ds_read_b64_tr_b16 v[30:31], v9 offset:18432
    buffer_load_dwordx4 v[152:155], v2, s[40:43], s8 offen offset:2048 sc1
    s_waitcnt lgkmcnt(4)
    v_mfma_f32_16x16x32_bf16 v[80:83], v[48:51], v[156:159], v[80:83]
    ds_read_b64_tr_b16 v[32:33], v10 offset:16384
    ds_read_b64_tr_b16 v[34:35], v10 offset:18432
    v_mfma_f32_16x16x32_bf16 v[84:87], v[52:55], v[156:159], v[84:87]
    ds_read_b64_tr_b16 v[36:37], v11 offset:16384
    ds_read_b64_tr_b16 v[38:39], v11 offset:18432
    s_waitcnt vmcnt(17) lgkmcnt(4)
    v_mfma_f32_16x16x32_bf16 v[56:59], v[24:27], v[160:163], v[56:59]
    ds_read_b64_tr_b16 v[40:41], v8 offset:20480
    v_mfma_f32_16x16x32_bf16 v[72:75], v[24:27], v[164:167], v[72:75]
    ds_read_b64_tr_b16 v[42:43], v8 offset:22528
    buffer_load_dwordx4 v[156:159], v2, s[40:43], s8 offen offset:3072 sc1
    v_mfma_f32_16x16x32_bf16 v[60:63], v[28:31], v[160:163], v[60:63]
    ds_read_b64_tr_b16 v[44:45], v9 offset:20480
    v_mfma_f32_16x16x32_bf16 v[76:79], v[28:31], v[164:167], v[76:79]
    ds_read_b64_tr_b16 v[46:47], v9 offset:22528
    s_waitcnt lgkmcnt(4)
    v_mfma_f32_16x16x32_bf16 v[64:67], v[32:35], v[160:163], v[64:67]
    ds_read_b64_tr_b16 v[48:49], v10 offset:20480
    v_mfma_f32_16x16x32_bf16 v[80:83], v[32:35], v[164:167], v[80:83]
    ds_read_b64_tr_b16 v[50:51], v10 offset:22528
    v_mfma_f32_16x16x32_bf16 v[68:71], v[36:39], v[160:163], v[68:71]
    ds_read_b64_tr_b16 v[52:53], v11 offset:20480
    v_mfma_f32_16x16x32_bf16 v[84:87], v[36:39], v[164:167], v[84:87]
    ds_read_b64_tr_b16 v[54:55], v11 offset:22528
    s_waitcnt vmcnt(16) lgkmcnt(4)
    v_mfma_f32_16x16x32_bf16 v[56:59], v[40:43], v[168:171], v[56:59]
    ds_read_b64_tr_b16 v[24:25], v8 offset:24576
    v_mfma_f32_16x16x32_bf16 v[72:75], v[40:43], v[172:175], v[72:75]
    ds_read_b64_tr_b16 v[26:27], v8 offset:26624
    buffer_load_dwordx4 v[160:163], v2, s[40:43], s9 offen offset:0 sc1
    v_mfma_f32_16x16x32_bf16 v[60:63], v[44:47], v[168:171], v[60:63]
    ds_read_b64_tr_b16 v[28:29], v9 offset:24576
    v_mfma_f32_16x16x32_bf16 v[76:79], v[44:47], v[172:175], v[76:79]
    ds_read_b64_tr_b16 v[30:31], v9 offset:26624
    s_waitcnt lgkmcnt(4)
    v_mfma_f32_16x16x32_bf16 v[64:67], v[48:51], v[168:171], v[64:67]
    ds_read_b64_tr_b16 v[32:33], v10 offset:24576
    v_mfma_f32_16x16x32_bf16 v[80:83], v[48:51], v[172:175], v[80:83]
    ds_read_b64_tr_b16 v[34:35], v10 offset:26624
    buffer_load_dwordx4 v[164:167], v2, s[40:43], s9 offen offset:1024 sc1
    v_mfma_f32_16x16x32_bf16 v[68:71], v[52:55], v[168:171], v[68:71]
    ds_read_b64_tr_b16 v[36:37], v11 offset:24576
    v_mfma_f32_16x16x32_bf16 v[84:87], v[52:55], v[172:175], v[84:87]
    ds_read_b64_tr_b16 v[38:39], v11 offset:26624
    s_waitcnt vmcnt(16) lgkmcnt(4)
    v_mfma_f32_16x16x32_bf16 v[56:59], v[24:27], v[176:179], v[56:59]
    ds_read_b64_tr_b16 v[40:41], v8 offset:28672
    v_mfma_f32_16x16x32_bf16 v[72:75], v[24:27], v[180:183], v[72:75]
    ds_read_b64_tr_b16 v[42:43], v8 offset:30720
    buffer_load_dwordx4 v[168:171], v2, s[40:43], s9 offen offset:2048 sc1
    v_mfma_f32_16x16x32_bf16 v[60:63], v[28:31], v[176:179], v[60:63]
    ds_read_b64_tr_b16 v[44:45], v9 offset:28672
    v_mfma_f32_16x16x32_bf16 v[76:79], v[28:31], v[180:183], v[76:79]
    ds_read_b64_tr_b16 v[46:47], v9 offset:30720
    s_waitcnt lgkmcnt(4)
    v_mfma_f32_16x16x32_bf16 v[64:67], v[32:35], v[176:179], v[64:67]
    ds_read_b64_tr_b16 v[48:49], v10 offset:28672
    v_mfma_f32_16x16x32_bf16 v[80:83], v[32:35], v[180:183], v[80:83]
    ds_read_b64_tr_b16 v[50:51], v10 offset:30720
    buffer_load_dwordx4 v[172:175], v2, s[40:43], s9 offen offset:3072 sc1
    v_mfma_f32_16x16x32_bf16 v[68:71], v[36:39], v[176:179], v[68:71]
    ds_read_b64_tr_b16 v[52:53], v11 offset:28672
    v_mfma_f32_16x16x32_bf16 v[84:87], v[36:39], v[180:183], v[84:87]
    ds_read_b64_tr_b16 v[54:55], v11 offset:30720
    s_waitcnt vmcnt(16) lgkmcnt(4)
    v_mfma_f32_16x16x32_bf16 v[56:59], v[40:43], v[184:187], v[56:59]
    ds_read_b64_tr_b16 v[24:25], v12 offset:16384
    v_mfma_f32_16x16x32_bf16 v[72:75], v[40:43], v[188:191], v[72:75]
    ds_read_b64_tr_b16 v[26:27], v12 offset:18432
    buffer_load_dwordx4 v[176:179], v2, s[40:43], s10 offen offset:0 sc1
    v_mfma_f32_16x16x32_bf16 v[60:63], v[44:47], v[184:187], v[60:63]
    ds_read_b64_tr_b16 v[28:29], v13 offset:16384
    v_mfma_f32_16x16x32_bf16 v[76:79], v[44:47], v[188:191], v[76:79]
    ds_read_b64_tr_b16 v[30:31], v13 offset:18432
    s_waitcnt lgkmcnt(4)
    v_mfma_f32_16x16x32_bf16 v[64:67], v[48:51], v[184:187], v[64:67]
    ds_read_b64_tr_b16 v[32:33], v14 offset:16384
    v_mfma_f32_16x16x32_bf16 v[80:83], v[48:51], v[188:191], v[80:83]
    ds_read_b64_tr_b16 v[34:35], v14 offset:18432
    buffer_load_dwordx4 v[180:183], v2, s[40:43], s10 offen offset:1024 sc1
    v_mfma_f32_16x16x32_bf16 v[68:71], v[52:55], v[184:187], v[68:71]
    ds_read_b64_tr_b16 v[36:37], v15 offset:16384
    v_mfma_f32_16x16x32_bf16 v[84:87], v[52:55], v[188:191], v[84:87]
    ds_read_b64_tr_b16 v[38:39], v15 offset:18432
    v_mov_b32 v236, s95
    s_movk_i32 s27, 1
    s_nop 5
    v_cvt_pk_bf16_f32 v72, v72, v73
    v_cvt_pk_bf16_f32 v73, v74, v75
    v_cvt_pk_bf16_f32 v74, v76, v77
    v_cvt_pk_bf16_f32 v75, v78, v79
    v_bfi_b32 v72, s27, v236, v72
    v_bfi_b32 v73, s27, v236, v73
    v_bfi_b32 v74, s27, v236, v74
    v_bfi_b32 v75, s27, v236, v75
    buffer_store_dwordx4 v[72:75], v16, s[40:43], s99 offen offset:0 sc1
    v_cvt_pk_bf16_f32 v76, v80, v81
    v_cvt_pk_bf16_f32 v77, v82, v83
    v_cvt_pk_bf16_f32 v78, v84, v85
    v_cvt_pk_bf16_f32 v79, v86, v87
    v_bfi_b32 v76, s27, v236, v76
    v_bfi_b32 v77, s27, v236, v77
    v_bfi_b32 v78, s27, v236, v78
    v_bfi_b32 v79, s27, v236, v79
    buffer_store_dwordx4 v[76:79], v16, s[40:43], s99 offen offset:1024 sc1
    s_waitcnt vmcnt(17) lgkmcnt(4)
    v_mfma_f32_16x16x32_bf16 v[56:59], v[24:27], v[192:195], v[56:59]
    ds_read_b64_tr_b16 v[40:41], v12 offset:20480
    ds_read_b64_tr_b16 v[42:43], v12 offset:22528
    v_mfma_f32_16x16x32_bf16 v[60:63], v[28:31], v[192:195], v[60:63]
    ds_read_b64_tr_b16 v[44:45], v13 offset:20480
    ds_read_b64_tr_b16 v[46:47], v13 offset:22528
    buffer_load_dwordx4 v[184:187], v2, s[40:43], s10 offen offset:2048 sc1
    s_waitcnt lgkmcnt(4)
    v_mfma_f32_16x16x32_bf16 v[64:67], v[32:35], v[192:195], v[64:67]
    ds_read_b64_tr_b16 v[48:49], v14 offset:20480
    ds_read_b64_tr_b16 v[50:51], v14 offset:22528
    v_mfma_f32_16x16x32_bf16 v[68:71], v[36:39], v[192:195], v[68:71]
    ds_read_b64_tr_b16 v[52:53], v15 offset:20480
    ds_read_b64_tr_b16 v[54:55], v15 offset:22528
    buffer_load_dwordx4 v[188:191], v2, s[40:43], s10 offen offset:3072 sc1
    s_waitcnt vmcnt(18) lgkmcnt(4)
    v_mfma_f32_16x16x32_bf16 v[56:59], v[40:43], v[196:199], v[56:59]
    ds_read_b64_tr_b16 v[24:25], v12 offset:24576
    ds_read_b64_tr_b16 v[26:27], v12 offset:26624
    v_mfma_f32_16x16x32_bf16 v[60:63], v[44:47], v[196:199], v[60:63]
    ds_read_b64_tr_b16 v[28:29], v13 offset:24576
    ds_read_b64_tr_b16 v[30:31], v13 offset:26624
    s_waitcnt lgkmcnt(4)
    v_mfma_f32_16x16x32_bf16 v[64:67], v[48:51], v[196:199], v[64:67]
    ds_read_b64_tr_b16 v[32:33], v14 offset:24576
    ds_read_b64_tr_b16 v[34:35], v14 offset:26624
    v_mfma_f32_16x16x32_bf16 v[68:71], v[52:55], v[196:199], v[68:71]
    ds_read_b64_tr_b16 v[36:37], v15 offset:24576
    ds_read_b64_tr_b16 v[38:39], v15 offset:26624
    s_waitcnt vmcnt(17) lgkmcnt(4)
    v_mfma_f32_16x16x32_bf16 v[56:59], v[24:27], v[200:203], v[56:59]
    ds_read_b64_tr_b16 v[40:41], v12 offset:28672
    ds_read_b64_tr_b16 v[42:43], v12 offset:30720
    v_mfma_f32_16x16x32_bf16 v[60:63], v[28:31], v[200:203], v[60:63]
    ds_read_b64_tr_b16 v[44:45], v13 offset:28672
    ds_read_b64_tr_b16 v[46:47], v13 offset:30720
    s_waitcnt lgkmcnt(4)
    v_mfma_f32_16x16x32_bf16 v[64:67], v[32:35], v[200:203], v[64:67]
    ds_read_b64_tr_b16 v[48:49], v14 offset:28672
    ds_read_b64_tr_b16 v[50:51], v14 offset:30720
    v_mfma_f32_16x16x32_bf16 v[68:71], v[36:39], v[200:203], v[68:71]
    ds_read_b64_tr_b16 v[52:53], v15 offset:28672
    ds_read_b64_tr_b16 v[54:55], v15 offset:30720
    s_waitcnt vmcnt(16) lgkmcnt(4)
    v_mfma_f32_16x16x32_bf16 v[56:59], v[40:43], v[204:207], v[56:59]
    ds_read_b64_tr_b16 v[24:25], v12 offset:32768
    ds_read_b64_tr_b16 v[26:27], v12 offset:34816
    v_mfma_f32_16x16x32_bf16 v[60:63], v[44:47], v[204:207], v[60:63]
    ds_read_b64_tr_b16 v[28:29], v13 offset:32768
    ds_read_b64_tr_b16 v[30:31], v13 offset:34816
    s_waitcnt lgkmcnt(4)
    v_mfma_f32_16x16x32_bf16 v[64:67], v[48:51], v[204:207], v[64:67]
    ds_read_b64_tr_b16 v[32:33], v14 offset:32768
    ds_read_b64_tr_b16 v[34:35], v14 offset:34816
    v_mfma_f32_16x16x32_bf16 v[68:71], v[52:55], v[204:207], v[68:71]
    ds_read_b64_tr_b16 v[36:37], v15 offset:32768
    ds_read_b64_tr_b16 v[38:39], v15 offset:34816
    s_waitcnt vmcnt(15) lgkmcnt(4)
    v_mfma_f32_16x16x32_bf16 v[56:59], v[24:27], v[128:131], v[56:59]
    ds_read_b64_tr_b16 v[40:41], v12 offset:36864
    ds_read_b64_tr_b16 v[42:43], v12 offset:38912
    v_mfma_f32_16x16x32_bf16 v[60:63], v[28:31], v[128:131], v[60:63]
    ds_read_b64_tr_b16 v[44:45], v13 offset:36864
    ds_read_b64_tr_b16 v[46:47], v13 offset:38912
    s_waitcnt lgkmcnt(4)
    v_mfma_f32_16x16x32_bf16 v[64:67], v[32:35], v[128:131], v[64:67]
    ds_read_b64_tr_b16 v[48:49], v14 offset:36864
    ds_read_b64_tr_b16 v[50:51], v14 offset:38912
    v_mfma_f32_16x16x32_bf16 v[68:71], v[36:39], v[128:131], v[68:71]
    ds_read_b64_tr_b16 v[52:53], v15 offset:36864
    ds_read_b64_tr_b16 v[54:55], v15 offset:38912
    s_waitcnt vmcnt(14) lgkmcnt(4)
    v_mfma_f32_16x16x32_bf16 v[56:59], v[40:43], v[132:135], v[56:59]
    ds_read_b64_tr_b16 v[24:25], v12 offset:40960
    ds_read_b64_tr_b16 v[26:27], v12 offset:43008
    v_mfma_f32_16x16x32_bf16 v[60:63], v[44:47], v[132:135], v[60:63]
    ds_read_b64_tr_b16 v[28:29], v13 offset:40960
    ds_read_b64_tr_b16 v[30:31], v13 offset:43008
    s_waitcnt lgkmcnt(4)
    v_mfma_f32_16x16x32_bf16 v[64:67], v[48:51], v[132:135], v[64:67]
    ds_read_b64_tr_b16 v[32:33], v14 offset:40960
    ds_read_b64_tr_b16 v[34:35], v14 offset:43008
    v_mfma_f32_16x16x32_bf16 v[68:71], v[52:55], v[132:135], v[68:71]
    ds_read_b64_tr_b16 v[36:37], v15 offset:40960
    ds_read_b64_tr_b16 v[38:39], v15 offset:43008
    s_waitcnt vmcnt(13) lgkmcnt(4)
    v_mfma_f32_16x16x32_bf16 v[56:59], v[24:27], v[136:139], v[56:59]
    ds_read_b64_tr_b16 v[40:41], v12 offset:45056
    ds_read_b64_tr_b16 v[42:43], v12 offset:47104
    v_mfma_f32_16x16x32_bf16 v[60:63], v[28:31], v[136:139], v[60:63]
    ds_read_b64_tr_b16 v[44:45], v13 offset:45056
    ds_read_b64_tr_b16 v[46:47], v13 offset:47104
    s_waitcnt lgkmcnt(4)
    v_mfma_f32_16x16x32_bf16 v[64:67], v[32:35], v[136:139], v[64:67]
    ds_read_b64_tr_b16 v[48:49], v14 offset:45056
    ds_read_b64_tr_b16 v[50:51], v14 offset:47104
    v_mfma_f32_16x16x32_bf16 v[68:71], v[36:39], v[136:139], v[68:71]
    ds_read_b64_tr_b16 v[52:53], v15 offset:45056
    ds_read_b64_tr_b16 v[54:55], v15 offset:47104
    s_waitcnt vmcnt(12) lgkmcnt(4)
    v_mfma_f32_16x16x32_bf16 v[56:59], v[40:43], v[140:143], v[56:59]
    ds_read_b64_tr_b16 v[24:25], v12 offset:49152
    ds_read_b64_tr_b16 v[26:27], v12 offset:51200
    v_mfma_f32_16x16x32_bf16 v[60:63], v[44:47], v[140:143], v[60:63]
    ds_read_b64_tr_b16 v[28:29], v13 offset:49152
    ds_read_b64_tr_b16 v[30:31], v13 offset:51200
    s_waitcnt lgkmcnt(4)
    v_mfma_f32_16x16x32_bf16 v[64:67], v[48:51], v[140:143], v[64:67]
    ds_read_b64_tr_b16 v[32:33], v14 offset:49152
    ds_read_b64_tr_b16 v[34:35], v14 offset:51200
    v_mfma_f32_16x16x32_bf16 v[68:71], v[52:55], v[140:143], v[68:71]
    ds_read_b64_tr_b16 v[36:37], v15 offset:49152
    ds_read_b64_tr_b16 v[38:39], v15 offset:51200
    s_waitcnt vmcnt(11) lgkmcnt(4)
    v_mfma_f32_16x16x32_bf16 v[56:59], v[24:27], v[144:147], v[56:59]
    ds_read_b64_tr_b16 v[40:41], v12 offset:53248
    ds_read_b64_tr_b16 v[42:43], v12 offset:55296
    v_mfma_f32_16x16x32_bf16 v[60:63], v[28:31], v[144:147], v[60:63]
    ds_read_b64_tr_b16 v[44:45], v13 offset:53248
    ds_read_b64_tr_b16 v[46:47], v13 offset:55296
    s_waitcnt lgkmcnt(4)
    v_mfma_f32_16x16x32_bf16 v[64:67], v[32:35], v[144:147], v[64:67]
    ds_read_b64_tr_b16 v[48:49], v14 offset:53248
    ds_read_b64_tr_b16 v[50:51], v14 offset:55296
    v_mfma_f32_16x16x32_bf16 v[68:71], v[36:39], v[144:147], v[68:71]
    ds_read_b64_tr_b16 v[52:53], v15 offset:53248
    ds_read_b64_tr_b16 v[54:55], v15 offset:55296
    s_waitcnt vmcnt(10) lgkmcnt(4)
    v_mfma_f32_16x16x32_bf16 v[56:59], v[40:43], v[148:151], v[56:59]
    ds_read_b64_tr_b16 v[24:25], v12 offset:57344
    ds_read_b64_tr_b16 v[26:27], v12 offset:59392
    v_mfma_f32_16x16x32_bf16 v[60:63], v[44:47], v[148:151], v[60:63]
    ds_read_b64_tr_b16 v[28:29], v13 offset:57344
    ds_read_b64_tr_b16 v[30:31], v13 offset:59392
    s_waitcnt lgkmcnt(4)
    v_mfma_f32_16x16x32_bf16 v[64:67], v[48:51], v[148:151], v[64:67]
    ds_read_b64_tr_b16 v[32:33], v14 offset:57344
    ds_read_b64_tr_b16 v[34:35], v14 offset:59392
    v_mfma_f32_16x16x32_bf16 v[68:71], v[52:55], v[148:151], v[68:71]
    ds_read_b64_tr_b16 v[36:37], v15 offset:57344
    ds_read_b64_tr_b16 v[38:39], v15 offset:59392
    s_waitcnt vmcnt(9) lgkmcnt(4)
    v_mfma_f32_16x16x32_bf16 v[56:59], v[24:27], v[152:155], v[56:59]
    ds_read_b64_tr_b16 v[40:41], v12 offset:61440
    ds_read_b64_tr_b16 v[42:43], v12 offset:63488
    v_mfma_f32_16x16x32_bf16 v[60:63], v[28:31], v[152:155], v[60:63]
    ds_read_b64_tr_b16 v[44:45], v13 offset:61440
    ds_read_b64_tr_b16 v[46:47], v13 offset:63488
    s_waitcnt lgkmcnt(4)
    v_mfma_f32_16x16x32_bf16 v[64:67], v[32:35], v[152:155], v[64:67]
    ds_read_b64_tr_b16 v[48:49], v14 offset:61440
    ds_read_b64_tr_b16 v[50:51], v14 offset:63488
    v_mfma_f32_16x16x32_bf16 v[68:71], v[36:39], v[152:155], v[68:71]
    ds_read_b64_tr_b16 v[52:53], v15 offset:61440
    ds_read_b64_tr_b16 v[54:55], v15 offset:63488
    s_waitcnt vmcnt(8) lgkmcnt(4)
    v_mfma_f32_16x16x32_bf16 v[56:59], v[40:43], v[156:159], v[56:59]
    ds_read_b64_tr_b16 v[24:25], v112 offset:0
    ds_read_b64_tr_b16 v[26:27], v112 offset:2048
    v_mfma_f32_16x16x32_bf16 v[60:63], v[44:47], v[156:159], v[60:63]
    ds_read_b64_tr_b16 v[28:29], v113 offset:0
    ds_read_b64_tr_b16 v[30:31], v113 offset:2048
    s_waitcnt lgkmcnt(4)
    v_mfma_f32_16x16x32_bf16 v[64:67], v[48:51], v[156:159], v[64:67]
    ds_read_b64_tr_b16 v[32:33], v114 offset:0
    ds_read_b64_tr_b16 v[34:35], v114 offset:2048
    v_mfma_f32_16x16x32_bf16 v[68:71], v[52:55], v[156:159], v[68:71]
    ds_read_b64_tr_b16 v[36:37], v115 offset:0
    ds_read_b64_tr_b16 v[38:39], v115 offset:2048
    s_waitcnt vmcnt(7) lgkmcnt(4)
    v_mfma_f32_16x16x32_bf16 v[56:59], v[24:27], v[160:163], v[56:59]
    ds_read_b64_tr_b16 v[40:41], v112 offset:4096
    ds_read_b64_tr_b16 v[42:43], v112 offset:6144
    v_mfma_f32_16x16x32_bf16 v[60:63], v[28:31], v[160:163], v[60:63]
    ds_read_b64_tr_b16 v[44:45], v113 offset:4096
    ds_read_b64_tr_b16 v[46:47], v113 offset:6144
    s_waitcnt lgkmcnt(4)
    v_mfma_f32_16x16x32_bf16 v[64:67], v[32:35], v[160:163], v[64:67]
    ds_read_b64_tr_b16 v[48:49], v114 offset:4096
    ds_read_b64_tr_b16 v[50:51], v114 offset:6144
    v_mfma_f32_16x16x32_bf16 v[68:71], v[36:39], v[160:163], v[68:71]
    ds_read_b64_tr_b16 v[52:53], v115 offset:4096
    ds_read_b64_tr_b16 v[54:55], v115 offset:6144
    s_waitcnt vmcnt(6) lgkmcnt(4)
    v_mfma_f32_16x16x32_bf16 v[56:59], v[40:43], v[164:167], v[56:59]
    ds_read_b64_tr_b16 v[24:25], v112 offset:8192
    ds_read_b64_tr_b16 v[26:27], v112 offset:10240
    v_mfma_f32_16x16x32_bf16 v[60:63], v[44:47], v[164:167], v[60:63]
    ds_read_b64_tr_b16 v[28:29], v113 offset:8192
    ds_read_b64_tr_b16 v[30:31], v113 offset:10240
    s_waitcnt lgkmcnt(4)
    v_mfma_f32_16x16x32_bf16 v[64:67], v[48:51], v[164:167], v[64:67]
    ds_read_b64_tr_b16 v[32:33], v114 offset:8192
    ds_read_b64_tr_b16 v[34:35], v114 offset:10240
    v_mfma_f32_16x16x32_bf16 v[68:71], v[52:55], v[164:167], v[68:71]
    ds_read_b64_tr_b16 v[36:37], v115 offset:8192
    ds_read_b64_tr_b16 v[38:39], v115 offset:10240
    s_waitcnt vmcnt(5) lgkmcnt(4)
    v_mfma_f32_16x16x32_bf16 v[56:59], v[24:27], v[168:171], v[56:59]
    ds_read_b64_tr_b16 v[40:41], v112 offset:12288
    ds_read_b64_tr_b16 v[42:43], v112 offset:14336
    v_mfma_f32_16x16x32_bf16 v[60:63], v[28:31], v[168:171], v[60:63]
    ds_read_b64_tr_b16 v[44:45], v113 offset:12288
    ds_read_b64_tr_b16 v[46:47], v113 offset:14336
    s_waitcnt lgkmcnt(4)
    v_mfma_f32_16x16x32_bf16 v[64:67], v[32:35], v[168:171], v[64:67]
    ds_read_b64_tr_b16 v[48:49], v114 offset:12288
    ds_read_b64_tr_b16 v[50:51], v114 offset:14336
    v_mfma_f32_16x16x32_bf16 v[68:71], v[36:39], v[168:171], v[68:71]
    buffer_load_dwordx4 v[88:91], v16, s[40:43], s96 offen offset:0 sc1
    buffer_load_dwordx4 v[92:95], v16, s[40:43], s96 offen offset:1024 sc1
    ds_read_b64_tr_b16 v[52:53], v115 offset:12288
    ds_read_b64_tr_b16 v[54:55], v115 offset:14336
    s_waitcnt vmcnt(6) lgkmcnt(4)
    v_mfma_f32_16x16x32_bf16 v[56:59], v[40:43], v[172:175], v[56:59]
    ds_read_b64_tr_b16 v[24:25], v112 offset:16384
    ds_read_b64_tr_b16 v[26:27], v112 offset:18432
    v_mfma_f32_16x16x32_bf16 v[60:63], v[44:47], v[172:175], v[60:63]
    ds_read_b64_tr_b16 v[28:29], v113 offset:16384
    ds_read_b64_tr_b16 v[30:31], v113 offset:18432
    s_waitcnt lgkmcnt(4)
    v_mfma_f32_16x16x32_bf16 v[64:67], v[48:51], v[172:175], v[64:67]
    ds_read_b64_tr_b16 v[32:33], v114 offset:16384
    ds_read_b64_tr_b16 v[34:35], v114 offset:18432
    v_mfma_f32_16x16x32_bf16 v[68:71], v[52:55], v[172:175], v[68:71]
    ds_read_b64_tr_b16 v[36:37], v115 offset:16384
    ds_read_b64_tr_b16 v[38:39], v115 offset:18432
    s_waitcnt vmcnt(5) lgkmcnt(4)
    v_mfma_f32_16x16x32_bf16 v[56:59], v[24:27], v[176:179], v[56:59]
    ds_read_b64_tr_b16 v[40:41], v112 offset:20480
    ds_read_b64_tr_b16 v[42:43], v112 offset:22528
    v_mfma_f32_16x16x32_bf16 v[60:63], v[28:31], v[176:179], v[60:63]
    ds_read_b64_tr_b16 v[44:45], v113 offset:20480
    ds_read_b64_tr_b16 v[46:47], v113 offset:22528
    s_waitcnt lgkmcnt(4)
    v_mfma_f32_16x16x32_bf16 v[64:67], v[32:35], v[176:179], v[64:67]
    ds_read_b64_tr_b16 v[48:49], v114 offset:20480
    ds_read_b64_tr_b16 v[50:51], v114 offset:22528
    v_mfma_f32_16x16x32_bf16 v[68:71], v[36:39], v[176:179], v[68:71]
    ds_read_b64_tr_b16 v[52:53], v115 offset:20480
    ds_read_b64_tr_b16 v[54:55], v115 offset:22528
    s_waitcnt vmcnt(4) lgkmcnt(4)
    v_mfma_f32_16x16x32_bf16 v[56:59], v[40:43], v[180:183], v[56:59]
    ds_read_b64_tr_b16 v[24:25], v112 offset:24576
    ds_read_b64_tr_b16 v[26:27], v112 offset:26624
    v_mfma_f32_16x16x32_bf16 v[60:63], v[44:47], v[180:183], v[60:63]
    ds_read_b64_tr_b16 v[28:29], v113 offset:24576
    ds_read_b64_tr_b16 v[30:31], v113 offset:26624
    s_waitcnt lgkmcnt(4)
    v_mfma_f32_16x16x32_bf16 v[64:67], v[48:51], v[180:183], v[64:67]
    ds_read_b64_tr_b16 v[32:33], v114 offset:24576
    ds_read_b64_tr_b16 v[34:35], v114 offset:26624
    v_mfma_f32_16x16x32_bf16 v[68:71], v[52:55], v[180:183], v[68:71]
    ds_read_b64_tr_b16 v[36:37], v115 offset:24576
    ds_read_b64_tr_b16 v[38:39], v115 offset:26624
    s_waitcnt vmcnt(3) lgkmcnt(4)
    v_mfma_f32_16x16x32_bf16 v[56:59], v[24:27], v[184:187], v[56:59]
    ds_read_b64_tr_b16 v[40:41], v112 offset:28672
    ds_read_b64_tr_b16 v[42:43], v112 offset:30720
    v_mfma_f32_16x16x32_bf16 v[60:63], v[28:31], v[184:187], v[60:63]
    ds_read_b64_tr_b16 v[44:45], v113 offset:28672
    ds_read_b64_tr_b16 v[46:47], v113 offset:30720
    s_waitcnt lgkmcnt(4)
    v_mfma_f32_16x16x32_bf16 v[64:67], v[32:35], v[184:187], v[64:67]
    ds_read_b64_tr_b16 v[48:49], v114 offset:28672
    ds_read_b64_tr_b16 v[50:51], v114 offset:30720
    v_mfma_f32_16x16x32_bf16 v[68:71], v[36:39], v[184:187], v[68:71]
    ds_read_b64_tr_b16 v[52:53], v115 offset:28672
    ds_read_b64_tr_b16 v[54:55], v115 offset:30720
    s_waitcnt vmcnt(2) lgkmcnt(4)
    v_mfma_f32_16x16x32_bf16 v[56:59], v[40:43], v[188:191], v[56:59]
    v_mfma_f32_16x16x32_bf16 v[60:63], v[44:47], v[188:191], v[60:63]
    s_waitcnt lgkmcnt(0)
    v_mfma_f32_16x16x32_bf16 v[64:67], v[48:51], v[188:191], v[64:67]
    v_mfma_f32_16x16x32_bf16 v[68:71], v[52:55], v[188:191], v[68:71]
    s_mov_b32 s97, 0x40000
L_pchk:
    s_waitcnt vmcnt(0)
    v_xor_b32 v88, s95, v88
    v_xor_b32 v89, s95, v89
    v_xor_b32 v90, s95, v90
    v_xor_b32 v91, s95, v91
    v_xor_b32 v92, s95, v92
    v_xor_b32 v93, s95, v93
    v_xor_b32 v94, s95, v94
    v_xor_b32 v95, s95, v95
    v_or3_b32 v24, v88, v89, v90
    v_or3_b32 v24, v24, v91, v92
    v_or3_b32 v24, v24, v93, v94
    v_or_b32 v24, v24, v95
    v_and_b32 v24, 1, v24
    v_cmp_eq_u32 vcc, 0, v24
    s_nop 1
    s_cmp_eq_u64 vcc, exec
    s_cbranch_scc1 L_pok
    buffer_load_dwordx4 v[88:91], v16, s[40:43], s96 offen offset:0 sc1
    buffer_load_dwordx4 v[92:95], v16, s[40:43], s96 offen offset:1024 sc1
    s_sub_u32 s97, s97, 1
    s_cbranch_scc0 L_pchk
L_pok:
    v_and_b32 v32, 0xffff0000, v88
    v_lshlrev_b32 v88, 16, v88
    v_and_b32 v33, 0xffff0000, v89
    v_lshlrev_b32 v89, 16, v89
    v_and_b32 v34, 0xffff0000, v90
    v_lshlrev_b32 v90, 16, v90
    v_and_b32 v35, 0xffff0000, v91
    v_lshlrev_b32 v91, 16, v91
    v_and_b32 v36, 0xffff0000, v92
    v_lshlrev_b32 v92, 16, v92
    v_and_b32 v37, 0xffff0000, v93
    v_lshlrev_b32 v93, 16, v93
    v_and_b32 v38, 0xffff0000, v94
    v_lshlrev_b32 v94, 16, v94
    v_and_b32 v39, 0xffff0000, v95
    v_lshlrev_b32 v95, 16, v95
    v_add_f32 v56, v56, v88
    v_add_f32 v57, v57, v32
    v_add_f32 v58, v58, v89
    v_add_f32 v59, v59, v33
    v_add_f32 v60, v60, v90
    v_add_f32 v61, v61, v34
    v_add_f32 v62, v62, v91
    v_add_f32 v63, v63, v35
    v_add_f32 v64, v64, v92
    v_add_f32 v65, v65, v36
    v_add_f32 v66, v66, v93
    v_add_f32 v67, v67, v37
    v_add_f32 v68, v68, v94
    v_add_f32 v69, v69, v38
    v_add_f32 v70, v70, v95
    v_add_f32 v71, v71, v39
    s_barrier
    ds_read_b32 v236, v20
    ds_read_b128 v[128:131], v18 offset:0
    ds_read_b128 v[132:135], v18 offset:1024
    ds_read_b128 v[136:139], v18 offset:2048
    ds_read_b128 v[140:143], v18 offset:3072
    ds_read_b128 v[144:147], v19 offset:8192
    ds_read_b128 v[148:151], v19 offset:9216
    ds_read_b128 v[152:155], v19 offset:10240
    ds_read_b128 v[156:159], v19 offset:11264
    s_waitcnt lgkmcnt(8)
    v_pk_fma_f32 v[96:97], v[56:57], v[236:237], v[96:97] op_sel_hi:[1,0,1]
    v_pk_fma_f32 v[98:99], v[58:59], v[236:237], v[98:99] op_sel_hi:[1,0,1]
    v_pk_fma_f32 v[100:101], v[60:61], v[236:237], v[100:101] op_sel_hi:[1,0,1]
    v_pk_fma_f32 v[102:103], v[62:63], v[236:237], v[102:103] op_sel_hi:[1,0,1]
    v_pk_fma_f32 v[104:105], v[64:65], v[236:237], v[104:105] op_sel_hi:[1,0,1]
    v_pk_fma_f32 v[106:107], v[66:67], v[236:237], v[106:107] op_sel_hi:[1,0,1]
    v_pk_fma_f32 v[108:109], v[68:69], v[236:237], v[108:109] op_sel_hi:[1,0,1]
    v_pk_fma_f32 v[110:111], v[70:71], v[236:237], v[110:111] op_sel_hi:[1,0,1]
    s_waitcnt lgkmcnt(4)
    v_pk_add_f32 v[96:97], v[96:97], v[128:129]
    v_pk_add_f32 v[98:99], v[98:99], v[130:131]
    v_pk_add_f32 v[100:101], v[100:101], v[132:133]
    v_pk_add_f32 v[102:103], v[102:103], v[134:135]
    v_pk_add_f32 v[104:105], v[104:105], v[136:137]
    v_pk_add_f32 v[106:107], v[106:107], v[138:139]
    v_pk_add_f32 v[108:109], v[108:109], v[140:141]
    v_pk_add_f32 v[110:111], v[110:111], v[142:143]
    s_waitcnt lgkmcnt(0)
    v_pk_fma_f32 v[96:97], v[144:145], v[236:237], v[96:97] op_sel:[0,1,0] op_sel_hi:[1,1,1]
    v_pk_fma_f32 v[98:99], v[146:147], v[236:237], v[98:99] op_sel:[0,1,0] op_sel_hi:[1,1,1]
    v_cvt_pk_bf16_f32 v28, v96, v97
    v_cvt_pk_bf16_f32 v29, v98, v99
    ds_write_b64 v232, v[28:29]
    v_pk_fma_f32 v[100:101], v[148:149], v[236:237], v[100:101] op_sel:[0,1,0] op_sel_hi:[1,1,1]
    v_pk_fma_f32 v[102:103], v[150:151], v[236:237], v[102:103] op_sel:[0,1,0] op_sel_hi:[1,1,1]
    v_cvt_pk_bf16_f32 v30, v100, v101
    v_cvt_pk_bf16_f32 v31, v102, v103
    ds_write_b64 v233, v[30:31]
    v_pk_fma_f32 v[104:105], v[152:153], v[236:237], v[104:105] op_sel:[0,1,0] op_sel_hi:[1,1,1]
    v_pk_fma_f32 v[106:107], v[154:155], v[236:237], v[106:107] op_sel:[0,1,0] op_sel_hi:[1,1,1]
    v_cvt_pk_bf16_f32 v32, v104, v105
    v_cvt_pk_bf16_f32 v33, v106, v107
    ds_write_b64 v234, v[32:33]
    v_pk_fma_f32 v[108:109], v[156:157], v[236:237], v[108:109] op_sel:[0,1,0] op_sel_hi:[1,1,1]
    v_pk_fma_f32 v[110:111], v[158:159], v[236:237], v[110:111] op_sel:[0,1,0] op_sel_hi:[1,1,1]
    v_cvt_pk_bf16_f32 v34, v108, v109
    v_cvt_pk_bf16_f32 v35, v110, v111
    ds_write_b64 v235, v[34:35]
    s_waitcnt lgkmcnt(0)
    ds_read_b128 v[36:39], v23
    ds_read_b128 v[40:43], v23 offset:1024
    s_waitcnt lgkmcnt(1)
    buffer_store_dwordx4 v[36:39], v4, s[48:51], 0 offen
    s_waitcnt lgkmcnt(0)
    buffer_store_dwordx4 v[40:43], v5, s[48:51], 0 offen
    s_endpgm
L_aux:
    ds_read_b32 v25, v32
    ds_read_b32 v26, v33
    ds_read_b32 v27, v34
    ds_read_b128 v[28:31], v35 offset:512
    s_lshl_b32 s97, s63, 3
    s_mul_i32 s97, s97, 56
    s_lshl_b32 s98, s96, 2
    s_add_u32 s97, s97, s98
    s_and_b32 s27, s60, 3
    s_add_u32 s97, s97, s27
    s_lshl_b32 s97, s97, 10
    s_lshl_b32 s27, s27, 10
    s_add_u32 s27, s27, 32768
    v_add_u32 v34, s27, v16
    s_mov_b32 s3, 991054117
    v_mul_f32 v24, s3, v104
    s_waitcnt lgkmcnt(0)
    v_mul_f32 v25, s3, v25
    v_mul_f32 v26, s3, v26
    v_mul_f32 v27, s3, v27
    v_cvt_pk_bf16_f32 v32, v24, v25
    v_cvt_pk_bf16_f32 v33, v26, v27
    v_lshlrev_b32 v24, 16, v32
    v_and_b32 v25, 0xffff0000, v32
    v_lshlrev_b32 v26, 16, v33
    v_and_b32 v27, 0xffff0000, v33
    v_pk_fma_f32 v[72:73], v[108:109], v[24:25], v[72:73] op_sel_hi:[1,0,1] neg_lo:[1,0,0] neg_hi:[1,0,0]
    v_pk_fma_f32 v[74:75], v[110:111], v[24:25], v[74:75] op_sel_hi:[1,0,1] neg_lo:[1,0,0] neg_hi:[1,0,0]
    v_pk_fma_f32 v[88:89], v[28:29], v[24:25], v[88:89] op_sel_hi:[1,0,1] neg_lo:[1,0,0] neg_hi:[1,0,0]
    v_pk_fma_f32 v[90:91], v[30:31], v[24:25], v[90:91] op_sel_hi:[1,0,1] neg_lo:[1,0,0] neg_hi:[1,0,0]
    v_cvt_pk_bf16_f32 v38, v72, v73
    v_cvt_pk_bf16_f32 v39, v74, v75
    v_cvt_pk_bf16_f32 v36, v88, v89
    v_cvt_pk_bf16_f32 v37, v90, v91
    v_pk_max_i16 v36, v36, 0
    v_pk_max_i16 v37, v37, 0
    v_pk_max_i16 v38, v38, 0
    v_pk_max_i16 v39, v39, 0
    s_xor_b32 s27, s60, 0
    s_mul_i32 s52, s27, 57344
    s_add_u32 s52, s52, s97
    buffer_store_dwordx4 v[36:39], v16, s[40:43], s52 offen sc1
    s_lshl_b32 s27, s27, 12
    v_add_u32 v35, s27, v34
    ds_write_b128 v35, v[36:39]
    v_pk_fma_f32 v[76:77], v[108:109], v[24:25], v[76:77] op_sel:[0,1,0] op_sel_hi:[1,1,1] neg_lo:[1,0,0] neg_hi:[1,0,0]
    v_pk_fma_f32 v[78:79], v[110:111], v[24:25], v[78:79] op_sel:[0,1,0] op_sel_hi:[1,1,1] neg_lo:[1,0,0] neg_hi:[1,0,0]
    v_pk_fma_f32 v[92:93], v[28:29], v[24:25], v[92:93] op_sel:[0,1,0] op_sel_hi:[1,1,1] neg_lo:[1,0,0] neg_hi:[1,0,0]
    v_pk_fma_f32 v[94:95], v[30:31], v[24:25], v[94:95] op_sel:[0,1,0] op_sel_hi:[1,1,1] neg_lo:[1,0,0] neg_hi:[1,0,0]
    v_cvt_pk_bf16_f32 v42, v76, v77
    v_cvt_pk_bf16_f32 v43, v78, v79
    v_cvt_pk_bf16_f32 v40, v92, v93
    v_cvt_pk_bf16_f32 v41, v94, v95
    v_pk_max_i16 v40, v40, 0
    v_pk_max_i16 v41, v41, 0
    v_pk_max_i16 v42, v42, 0
    v_pk_max_i16 v43, v43, 0
    s_xor_b32 s27, s60, 1
    s_mul_i32 s53, s27, 57344
    s_add_u32 s53, s53, s97
    buffer_store_dwordx4 v[40:43], v16, s[40:43], s53 offen sc1
    s_lshl_b32 s27, s27, 12
    v_add_u32 v35, s27, v34
    ds_write_b128 v35, v[40:43]
    v_pk_fma_f32 v[80:81], v[108:109], v[26:27], v[80:81] op_sel_hi:[1,0,1] neg_lo:[1,0,0] neg_hi:[1,0,0]
    v_pk_fma_f32 v[82:83], v[110:111], v[26:27], v[82:83] op_sel_hi:[1,0,1] neg_lo:[1,0,0] neg_hi:[1,0,0]
    v_pk_fma_f32 v[96:97], v[28:29], v[26:27], v[96:97] op_sel_hi:[1,0,1] neg_lo:[1,0,0] neg_hi:[1,0,0]
    v_pk_fma_f32 v[98:99], v[30:31], v[26:27], v[98:99] op_sel_hi:[1,0,1] neg_lo:[1,0,0] neg_hi:[1,0,0]
    v_cvt_pk_bf16_f32 v46, v80, v81
    v_cvt_pk_bf16_f32 v47, v82, v83
    v_cvt_pk_bf16_f32 v44, v96, v97
    v_cvt_pk_bf16_f32 v45, v98, v99
    v_pk_max_i16 v44, v44, 0
    v_pk_max_i16 v45, v45, 0
    v_pk_max_i16 v46, v46, 0
    v_pk_max_i16 v47, v47, 0
    s_xor_b32 s27, s60, 2
    s_mul_i32 s54, s27, 57344
    s_add_u32 s54, s54, s97
    buffer_store_dwordx4 v[44:47], v16, s[40:43], s54 offen sc1
    s_lshl_b32 s27, s27, 12
    v_add_u32 v35, s27, v34
    ds_write_b128 v35, v[44:47]
    v_pk_fma_f32 v[84:85], v[108:109], v[26:27], v[84:85] op_sel:[0,1,0] op_sel_hi:[1,1,1] neg_lo:[1,0,0] neg_hi:[1,0,0]
    v_pk_fma_f32 v[86:87], v[110:111], v[26:27], v[86:87] op_sel:[0,1,0] op_sel_hi:[1,1,1] neg_lo:[1,0,0] neg_hi:[1,0,0]
    v_pk_fma_f32 v[100:101], v[28:29], v[26:27], v[100:101] op_sel:[0,1,0] op_sel_hi:[1,1,1] neg_lo:[1,0,0] neg_hi:[1,0,0]
    v_pk_fma_f32 v[102:103], v[30:31], v[26:27], v[102:103] op_sel:[0,1,0] op_sel_hi:[1,1,1] neg_lo:[1,0,0] neg_hi:[1,0,0]
    v_cvt_pk_bf16_f32 v50, v84, v85
    v_cvt_pk_bf16_f32 v51, v86, v87
    v_cvt_pk_bf16_f32 v48, v100, v101
    v_cvt_pk_bf16_f32 v49, v102, v103
    v_pk_max_i16 v48, v48, 0
    v_pk_max_i16 v49, v49, 0
    v_pk_max_i16 v50, v50, 0
    v_pk_max_i16 v51, v51, 0
    s_xor_b32 s27, s60, 3
    s_mul_i32 s55, s27, 57344
    s_add_u32 s55, s55, s97
    buffer_store_dwordx4 v[48:51], v16, s[40:43], s55 offen sc1
    s_lshl_b32 s27, s27, 12
    v_add_u32 v35, s27, v34
    ds_write_b128 v35, v[48:51]
    s_and_b32 s98, s60, 3
    v_and_b32 v14, 15, v1
    s_lshl_b32 s3, s26, 6
    v_add_u32 v8, s3, v14
    v_cvt_f32_u32 v8, v8
    v_lshrrev_b32 v15, 4, v1
    v_lshlrev_b32 v24, 2, v15
    v_cvt_f32_u32 v24, v24
    s_mov_b32 s3, 0x41800000
    v_add_f32 v9, s3, v8
    v_add_f32 v10, s3, v9
    v_add_f32 v11, s3, v10
    v_add_f32 v25, 1.0, v24
    v_add_f32 v26, 2.0, v24
    v_add_f32 v27, 2.0, v25
    v_add_f32 v28, s3, v24
    v_add_f32 v29, s3, v25
    v_add_f32 v30, s3, v26
    v_add_f32 v31, s3, v27
    s_mov_b32 s3, 991054117
    v_mul_f32 v8, s3, v8
    v_mul_f32 v9, s3, v9
    v_mul_f32 v10, s3, v10
    v_mul_f32 v11, s3, v11
    s_bitcmp1_b32 s60, 1
    s_cselect_b32 s3, 0x3e800000, 0
    v_mov_b32 v12, s3
    v_mov_b32 v13, 0x42000000
    v_mul_f32 v80, v13, v8
    v_pk_fma_f32 v[64:65], v[24:25], v[8:9], v[12:13] op_sel_hi:[1,0,0]
    v_pk_fma_f32 v[66:67], v[26:27], v[8:9], v[12:13] op_sel_hi:[1,0,0]
    v_pk_fma_f32 v[68:69], v[28:29], v[8:9], v[12:13] op_sel_hi:[1,0,0]
    v_pk_fma_f32 v[70:71], v[30:31], v[8:9], v[12:13] op_sel_hi:[1,0,0]
    v_pk_add_f32 v[72:73], v[64:65], v[80:81] op_sel_hi:[1,0]
    v_pk_add_f32 v[74:75], v[66:67], v[80:81] op_sel_hi:[1,0]
    v_pk_add_f32 v[76:77], v[68:69], v[80:81] op_sel_hi:[1,0]
    v_pk_add_f32 v[78:79], v[70:71], v[80:81] op_sel_hi:[1,0]
    v_cos_f32 v80, v80
    v_cos_f32 v64, v64
    v_cos_f32 v65, v65
    v_cos_f32 v66, v66
    v_cos_f32 v67, v67
    v_cos_f32 v68, v68
    v_cos_f32 v69, v69
    v_cos_f32 v70, v70
    v_cos_f32 v71, v71
    v_cos_f32 v72, v72
    v_cos_f32 v73, v73
    v_cos_f32 v74, v74
    v_cos_f32 v75, v75
    v_cos_f32 v76, v76
    v_cos_f32 v77, v77
    v_cos_f32 v78, v78
    v_cos_f32 v79, v79
    v_add_f32 v80, v80, v80
    v_cvt_pk_bf16_f32 v128, v64, v65
    v_cvt_pk_bf16_f32 v129, v66, v67
    v_cvt_pk_bf16_f32 v130, v68, v69
    v_cvt_pk_bf16_f32 v131, v70, v71
    v_cvt_pk_bf16_f32 v144, v72, v73
    v_cvt_pk_bf16_f32 v145, v74, v75
    v_cvt_pk_bf16_f32 v146, v76, v77
    v_cvt_pk_bf16_f32 v147, v78, v79
    v_pk_fma_f32 v[64:65], v[72:73], v[80:81], v[64:65] op_sel_hi:[1,0,1] neg_lo:[0,0,1] neg_hi:[0,0,1]
    v_pk_fma_f32 v[66:67], v[74:75], v[80:81], v[66:67] op_sel_hi:[1,0,1] neg_lo:[0,0,1] neg_hi:[0,0,1]
    v_pk_fma_f32 v[68:69], v[76:77], v[80:81], v[68:69] op_sel_hi:[1,0,1] neg_lo:[0,0,1] neg_hi:[0,0,1]
    v_pk_fma_f32 v[70:71], v[78:79], v[80:81], v[70:71] op_sel_hi:[1,0,1] neg_lo:[0,0,1] neg_hi:[0,0,1]
    v_cvt_pk_bf16_f32 v160, v64, v65
    v_cvt_pk_bf16_f32 v161, v66, v67
    v_cvt_pk_bf16_f32 v162, v68, v69
    v_cvt_pk_bf16_f32 v163, v70, v71
    v_pk_fma_f32 v[72:73], v[64:65], v[80:81], v[72:73] op_sel_hi:[1,0,1] neg_lo:[0,0,1] neg_hi:[0,0,1]
    v_pk_fma_f32 v[74:75], v[66:67], v[80:81], v[74:75] op_sel_hi:[1,0,1] neg_lo:[0,0,1] neg_hi:[0,0,1]
    v_pk_fma_f32 v[76:77], v[68:69], v[80:81], v[76:77] op_sel_hi:[1,0,1] neg_lo:[0,0,1] neg_hi:[0,0,1]
    v_pk_fma_f32 v[78:79], v[70:71], v[80:81], v[78:79] op_sel_hi:[1,0,1] neg_lo:[0,0,1] neg_hi:[0,0,1]
    v_cvt_pk_bf16_f32 v176, v72, v73
    v_cvt_pk_bf16_f32 v177, v74, v75
    v_cvt_pk_bf16_f32 v178, v76, v77
    v_cvt_pk_bf16_f32 v179, v78, v79
    v_pk_fma_f32 v[64:65], v[72:73], v[80:81], v[64:65] op_sel_hi:[1,0,1] neg_lo:[0,0,1] neg_hi:[0,0,1]
    v_pk_fma_f32 v[66:67], v[74:75], v[80:81], v[66:67] op_sel_hi:[1,0,1] neg_lo:[0,0,1] neg_hi:[0,0,1]
    v_pk_fma_f32 v[68:69], v[76:77], v[80:81], v[68:69] op_sel_hi:[1,0,1] neg_lo:[0,0,1] neg_hi:[0,0,1]
    v_pk_fma_f32 v[70:71], v[78:79], v[80:81], v[70:71] op_sel_hi:[1,0,1] neg_lo:[0,0,1] neg_hi:[0,0,1]
    v_cvt_pk_bf16_f32 v192, v64, v65
    v_cvt_pk_bf16_f32 v193, v66, v67
    v_cvt_pk_bf16_f32 v194, v68, v69
    v_cvt_pk_bf16_f32 v195, v70, v71
    v_pk_fma_f32 v[72:73], v[64:65], v[80:81], v[72:73] op_sel_hi:[1,0,1] neg_lo:[0,0,1] neg_hi:[0,0,1]
    v_pk_fma_f32 v[74:75], v[66:67], v[80:81], v[74:75] op_sel_hi:[1,0,1] neg_lo:[0,0,1] neg_hi:[0,0,1]
    v_pk_fma_f32 v[76:77], v[68:69], v[80:81], v[76:77] op_sel_hi:[1,0,1] neg_lo:[0,0,1] neg_hi:[0,0,1]
    v_pk_fma_f32 v[78:79], v[70:71], v[80:81], v[78:79] op_sel_hi:[1,0,1] neg_lo:[0,0,1] neg_hi:[0,0,1]
    v_cvt_pk_bf16_f32 v208, v72, v73
    v_cvt_pk_bf16_f32 v209, v74, v75
    v_cvt_pk_bf16_f32 v210, v76, v77
    v_cvt_pk_bf16_f32 v211, v78, v79
    v_pk_fma_f32 v[64:65], v[72:73], v[80:81], v[64:65] op_sel_hi:[1,0,1] neg_lo:[0,0,1] neg_hi:[0,0,1]
    v_pk_fma_f32 v[66:67], v[74:75], v[80:81], v[66:67] op_sel_hi:[1,0,1] neg_lo:[0,0,1] neg_hi:[0,0,1]
    v_pk_fma_f32 v[68:69], v[76:77], v[80:81], v[68:69] op_sel_hi:[1,0,1] neg_lo:[0,0,1] neg_hi:[0,0,1]
    v_pk_fma_f32 v[70:71], v[78:79], v[80:81], v[70:71] op_sel_hi:[1,0,1] neg_lo:[0,0,1] neg_hi:[0,0,1]
    v_cvt_pk_bf16_f32 v224, v64, v65
    v_cvt_pk_bf16_f32 v225, v66, v67
    v_cvt_pk_bf16_f32 v226, v68, v69
    v_cvt_pk_bf16_f32 v227, v70, v71
    v_pk_fma_f32 v[72:73], v[64:65], v[80:81], v[72:73] op_sel_hi:[1,0,1] neg_lo:[0,0,1] neg_hi:[0,0,1]
    v_pk_fma_f32 v[74:75], v[66:67], v[80:81], v[74:75] op_sel_hi:[1,0,1] neg_lo:[0,0,1] neg_hi:[0,0,1]
    v_pk_fma_f32 v[76:77], v[68:69], v[80:81], v[76:77] op_sel_hi:[1,0,1] neg_lo:[0,0,1] neg_hi:[0,0,1]
    v_pk_fma_f32 v[78:79], v[70:71], v[80:81], v[78:79] op_sel_hi:[1,0,1] neg_lo:[0,0,1] neg_hi:[0,0,1]
    v_cvt_pk_bf16_f32 v240, v72, v73
    v_cvt_pk_bf16_f32 v241, v74, v75
    v_cvt_pk_bf16_f32 v242, v76, v77
    v_cvt_pk_bf16_f32 v243, v78, v79
    v_mul_f32 v80, v13, v9
    v_pk_fma_f32 v[64:65], v[24:25], v[8:9], v[12:13] op_sel:[0,1,0] op_sel_hi:[1,1,0]
    v_pk_fma_f32 v[66:67], v[26:27], v[8:9], v[12:13] op_sel:[0,1,0] op_sel_hi:[1,1,0]
    v_pk_fma_f32 v[68:69], v[28:29], v[8:9], v[12:13] op_sel:[0,1,0] op_sel_hi:[1,1,0]
    v_pk_fma_f32 v[70:71], v[30:31], v[8:9], v[12:13] op_sel:[0,1,0] op_sel_hi:[1,1,0]
    v_pk_add_f32 v[72:73], v[64:65], v[80:81] op_sel_hi:[1,0]
    v_pk_add_f32 v[74:75], v[66:67], v[80:81] op_sel_hi:[1,0]
    v_pk_add_f32 v[76:77], v[68:69], v[80:81] op_sel_hi:[1,0]
    v_pk_add_f32 v[78:79], v[70:71], v[80:81] op_sel_hi:[1,0]
    v_cos_f32 v80, v80
    v_cos_f32 v64, v64
    v_cos_f32 v65, v65
    v_cos_f32 v66, v66
    v_cos_f32 v67, v67
    v_cos_f32 v68, v68
    v_cos_f32 v69, v69
    v_cos_f32 v70, v70
    v_cos_f32 v71, v71
    v_cos_f32 v72, v72
    v_cos_f32 v73, v73
    v_cos_f32 v74, v74
    v_cos_f32 v75, v75
    v_cos_f32 v76, v76
    v_cos_f32 v77, v77
    v_cos_f32 v78, v78
    v_cos_f32 v79, v79
    v_add_f32 v80, v80, v80
    v_cvt_pk_bf16_f32 v132, v64, v65
    v_cvt_pk_bf16_f32 v133, v66, v67
    v_cvt_pk_bf16_f32 v134, v68, v69
    v_cvt_pk_bf16_f32 v135, v70, v71
    v_cvt_pk_bf16_f32 v148, v72, v73
    v_cvt_pk_bf16_f32 v149, v74, v75
    v_cvt_pk_bf16_f32 v150, v76, v77
    v_cvt_pk_bf16_f32 v151, v78, v79
    v_pk_fma_f32 v[64:65], v[72:73], v[80:81], v[64:65] op_sel_hi:[1,0,1] neg_lo:[0,0,1] neg_hi:[0,0,1]
    v_pk_fma_f32 v[66:67], v[74:75], v[80:81], v[66:67] op_sel_hi:[1,0,1] neg_lo:[0,0,1] neg_hi:[0,0,1]
    v_pk_fma_f32 v[68:69], v[76:77], v[80:81], v[68:69] op_sel_hi:[1,0,1] neg_lo:[0,0,1] neg_hi:[0,0,1]
    v_pk_fma_f32 v[70:71], v[78:79], v[80:81], v[70:71] op_sel_hi:[1,0,1] neg_lo:[0,0,1] neg_hi:[0,0,1]
    v_cvt_pk_bf16_f32 v164, v64, v65
    v_cvt_pk_bf16_f32 v165, v66, v67
    v_cvt_pk_bf16_f32 v166, v68, v69
    v_cvt_pk_bf16_f32 v167, v70, v71
    v_pk_fma_f32 v[72:73], v[64:65], v[80:81], v[72:73] op_sel_hi:[1,0,1] neg_lo:[0,0,1] neg_hi:[0,0,1]
    v_pk_fma_f32 v[74:75], v[66:67], v[80:81], v[74:75] op_sel_hi:[1,0,1] neg_lo:[0,0,1] neg_hi:[0,0,1]
    v_pk_fma_f32 v[76:77], v[68:69], v[80:81], v[76:77] op_sel_hi:[1,0,1] neg_lo:[0,0,1] neg_hi:[0,0,1]
    v_pk_fma_f32 v[78:79], v[70:71], v[80:81], v[78:79] op_sel_hi:[1,0,1] neg_lo:[0,0,1] neg_hi:[0,0,1]
    v_cvt_pk_bf16_f32 v180, v72, v73
    v_cvt_pk_bf16_f32 v181, v74, v75
    v_cvt_pk_bf16_f32 v182, v76, v77
    v_cvt_pk_bf16_f32 v183, v78, v79
    v_pk_fma_f32 v[64:65], v[72:73], v[80:81], v[64:65] op_sel_hi:[1,0,1] neg_lo:[0,0,1] neg_hi:[0,0,1]
    v_pk_fma_f32 v[66:67], v[74:75], v[80:81], v[66:67] op_sel_hi:[1,0,1] neg_lo:[0,0,1] neg_hi:[0,0,1]
    v_pk_fma_f32 v[68:69], v[76:77], v[80:81], v[68:69] op_sel_hi:[1,0,1] neg_lo:[0,0,1] neg_hi:[0,0,1]
    v_pk_fma_f32 v[70:71], v[78:79], v[80:81], v[70:71] op_sel_hi:[1,0,1] neg_lo:[0,0,1] neg_hi:[0,0,1]
    v_cvt_pk_bf16_f32 v196, v64, v65
    v_cvt_pk_bf16_f32 v197, v66, v67
    v_cvt_pk_bf16_f32 v198, v68, v69
    v_cvt_pk_bf16_f32 v199, v70, v71
    v_pk_fma_f32 v[72:73], v[64:65], v[80:81], v[72:73] op_sel_hi:[1,0,1] neg_lo:[0,0,1] neg_hi:[0,0,1]
    v_pk_fma_f32 v[74:75], v[66:67], v[80:81], v[74:75] op_sel_hi:[1,0,1] neg_lo:[0,0,1] neg_hi:[0,0,1]
    v_pk_fma_f32 v[76:77], v[68:69], v[80:81], v[76:77] op_sel_hi:[1,0,1] neg_lo:[0,0,1] neg_hi:[0,0,1]
    v_pk_fma_f32 v[78:79], v[70:71], v[80:81], v[78:79] op_sel_hi:[1,0,1] neg_lo:[0,0,1] neg_hi:[0,0,1]
    v_cvt_pk_bf16_f32 v212, v72, v73
    v_cvt_pk_bf16_f32 v213, v74, v75
    v_cvt_pk_bf16_f32 v214, v76, v77
    v_cvt_pk_bf16_f32 v215, v78, v79
    v_pk_fma_f32 v[64:65], v[72:73], v[80:81], v[64:65] op_sel_hi:[1,0,1] neg_lo:[0,0,1] neg_hi:[0,0,1]
    v_pk_fma_f32 v[66:67], v[74:75], v[80:81], v[66:67] op_sel_hi:[1,0,1] neg_lo:[0,0,1] neg_hi:[0,0,1]
    v_pk_fma_f32 v[68:69], v[76:77], v[80:81], v[68:69] op_sel_hi:[1,0,1] neg_lo:[0,0,1] neg_hi:[0,0,1]
    v_pk_fma_f32 v[70:71], v[78:79], v[80:81], v[70:71] op_sel_hi:[1,0,1] neg_lo:[0,0,1] neg_hi:[0,0,1]
    v_cvt_pk_bf16_f32 v228, v64, v65
    v_cvt_pk_bf16_f32 v229, v66, v67
    v_cvt_pk_bf16_f32 v230, v68, v69
    v_cvt_pk_bf16_f32 v231, v70, v71
    v_pk_fma_f32 v[72:73], v[64:65], v[80:81], v[72:73] op_sel_hi:[1,0,1] neg_lo:[0,0,1] neg_hi:[0,0,1]
    v_pk_fma_f32 v[74:75], v[66:67], v[80:81], v[74:75] op_sel_hi:[1,0,1] neg_lo:[0,0,1] neg_hi:[0,0,1]
    v_pk_fma_f32 v[76:77], v[68:69], v[80:81], v[76:77] op_sel_hi:[1,0,1] neg_lo:[0,0,1] neg_hi:[0,0,1]
    v_pk_fma_f32 v[78:79], v[70:71], v[80:81], v[78:79] op_sel_hi:[1,0,1] neg_lo:[0,0,1] neg_hi:[0,0,1]
    v_cvt_pk_bf16_f32 v244, v72, v73
    v_cvt_pk_bf16_f32 v245, v74, v75
    v_cvt_pk_bf16_f32 v246, v76, v77
    v_cvt_pk_bf16_f32 v247, v78, v79
    v_mul_f32 v80, v13, v10
    v_pk_fma_f32 v[64:65], v[24:25], v[10:11], v[12:13] op_sel_hi:[1,0,0]
    v_pk_fma_f32 v[66:67], v[26:27], v[10:11], v[12:13] op_sel_hi:[1,0,0]
    v_pk_fma_f32 v[68:69], v[28:29], v[10:11], v[12:13] op_sel_hi:[1,0,0]
    v_pk_fma_f32 v[70:71], v[30:31], v[10:11], v[12:13] op_sel_hi:[1,0,0]
    v_pk_add_f32 v[72:73], v[64:65], v[80:81] op_sel_hi:[1,0]
    v_pk_add_f32 v[74:75], v[66:67], v[80:81] op_sel_hi:[1,0]
    v_pk_add_f32 v[76:77], v[68:69], v[80:81] op_sel_hi:[1,0]
    v_pk_add_f32 v[78:79], v[70:71], v[80:81] op_sel_hi:[1,0]
    v_cos_f32 v80, v80
    v_cos_f32 v64, v64
    v_cos_f32 v65, v65
    v_cos_f32 v66, v66
    v_cos_f32 v67, v67
    v_cos_f32 v68, v68
    v_cos_f32 v69, v69
    v_cos_f32 v70, v70
    v_cos_f32 v71, v71
    v_cos_f32 v72, v72
    v_cos_f32 v73, v73
    v_cos_f32 v74, v74
    v_cos_f32 v75, v75
    v_cos_f32 v76, v76
    v_cos_f32 v77, v77
    v_cos_f32 v78, v78
    v_cos_f32 v79, v79
    s_waitcnt vmcnt(0) lgkmcnt(0)
    s_mul_i32 s57, s86, 7
    s_add_u32 s57, s57, s95
    s_mul_i32 s57, s57, 114688
    s_add_u32 s95, s95, 1
    s_cmp_eq_u32 s95, 7
    s_cselect_b32 s95, 0, s95
    s_add_u32 m0, s56, 16384
    s_nop 0
    buffer_load_dwordx4 v6, s[36:39], s57 offen  lds
    s_add_u32 s57, s57, 57344
    s_add_u32 m0, s56, 24576
    s_nop 0
    buffer_load_dwordx4 v6, s[36:39], s57 offen  lds
    s_barrier
    v_add_f32 v80, v80, v80
    v_cvt_pk_bf16_f32 v136, v64, v65
    v_cvt_pk_bf16_f32 v137, v66, v67
    v_cvt_pk_bf16_f32 v138, v68, v69
    v_cvt_pk_bf16_f32 v139, v70, v71
    v_cvt_pk_bf16_f32 v152, v72, v73
    v_cvt_pk_bf16_f32 v153, v74, v75
    v_cvt_pk_bf16_f32 v154, v76, v77
    v_cvt_pk_bf16_f32 v155, v78, v79
    v_pk_fma_f32 v[64:65], v[72:73], v[80:81], v[64:65] op_sel_hi:[1,0,1] neg_lo:[0,0,1] neg_hi:[0,0,1]
    v_pk_fma_f32 v[66:67], v[74:75], v[80:81], v[66:67] op_sel_hi:[1,0,1] neg_lo:[0,0,1] neg_hi:[0,0,1]
    v_pk_fma_f32 v[68:69], v[76:77], v[80:81], v[68:69] op_sel_hi:[1,0,1] neg_lo:[0,0,1] neg_hi:[0,0,1]
    v_pk_fma_f32 v[70:71], v[78:79], v[80:81], v[70:71] op_sel_hi:[1,0,1] neg_lo:[0,0,1] neg_hi:[0,0,1]
    v_cvt_pk_bf16_f32 v168, v64, v65
    v_cvt_pk_bf16_f32 v169, v66, v67
    v_cvt_pk_bf16_f32 v170, v68, v69
    v_cvt_pk_bf16_f32 v171, v70, v71
    v_pk_fma_f32 v[72:73], v[64:65], v[80:81], v[72:73] op_sel_hi:[1,0,1] neg_lo:[0,0,1] neg_hi:[0,0,1]
    v_pk_fma_f32 v[74:75], v[66:67], v[80:81], v[74:75] op_sel_hi:[1,0,1] neg_lo:[0,0,1] neg_hi:[0,0,1]
    v_pk_fma_f32 v[76:77], v[68:69], v[80:81], v[76:77] op_sel_hi:[1,0,1] neg_lo:[0,0,1] neg_hi:[0,0,1]
    v_pk_fma_f32 v[78:79], v[70:71], v[80:81], v[78:79] op_sel_hi:[1,0,1] neg_lo:[0,0,1] neg_hi:[0,0,1]
    v_cvt_pk_bf16_f32 v184, v72, v73
    v_cvt_pk_bf16_f32 v185, v74, v75
    v_cvt_pk_bf16_f32 v186, v76, v77
    v_cvt_pk_bf16_f32 v187, v78, v79
    v_pk_fma_f32 v[64:65], v[72:73], v[80:81], v[64:65] op_sel_hi:[1,0,1] neg_lo:[0,0,1] neg_hi:[0,0,1]
    v_pk_fma_f32 v[66:67], v[74:75], v[80:81], v[66:67] op_sel_hi:[1,0,1] neg_lo:[0,0,1] neg_hi:[0,0,1]
    v_pk_fma_f32 v[68:69], v[76:77], v[80:81], v[68:69] op_sel_hi:[1,0,1] neg_lo:[0,0,1] neg_hi:[0,0,1]
    v_pk_fma_f32 v[70:71], v[78:79], v[80:81], v[70:71] op_sel_hi:[1,0,1] neg_lo:[0,0,1] neg_hi:[0,0,1]
    v_cvt_pk_bf16_f32 v200, v64, v65
    v_cvt_pk_bf16_f32 v201, v66, v67
    v_cvt_pk_bf16_f32 v202, v68, v69
    v_cvt_pk_bf16_f32 v203, v70, v71
    v_pk_fma_f32 v[72:73], v[64:65], v[80:81], v[72:73] op_sel_hi:[1,0,1] neg_lo:[0,0,1] neg_hi:[0,0,1]
    v_pk_fma_f32 v[74:75], v[66:67], v[80:81], v[74:75] op_sel_hi:[1,0,1] neg_lo:[0,0,1] neg_hi:[0,0,1]
    v_pk_fma_f32 v[76:77], v[68:69], v[80:81], v[76:77] op_sel_hi:[1,0,1] neg_lo:[0,0,1] neg_hi:[0,0,1]
    v_pk_fma_f32 v[78:79], v[70:71], v[80:81], v[78:79] op_sel_hi:[1,0,1] neg_lo:[0,0,1] neg_hi:[0,0,1]
    v_cvt_pk_bf16_f32 v216, v72, v73
    v_cvt_pk_bf16_f32 v217, v74, v75
    v_cvt_pk_bf16_f32 v218, v76, v77
    v_cvt_pk_bf16_f32 v219, v78, v79
    v_pk_fma_f32 v[64:65], v[72:73], v[80:81], v[64:65] op_sel_hi:[1,0,1] neg_lo:[0,0,1] neg_hi:[0,0,1]
    v_pk_fma_f32 v[66:67], v[74:75], v[80:81], v[66:67] op_sel_hi:[1,0,1] neg_lo:[0,0,1] neg_hi:[0,0,1]
    v_pk_fma_f32 v[68:69], v[76:77], v[80:81], v[68:69] op_sel_hi:[1,0,1] neg_lo:[0,0,1] neg_hi:[0,0,1]
    v_pk_fma_f32 v[70:71], v[78:79], v[80:81], v[70:71] op_sel_hi:[1,0,1] neg_lo:[0,0,1] neg_hi:[0,0,1]
    v_cvt_pk_bf16_f32 v232, v64, v65
    v_cvt_pk_bf16_f32 v233, v66, v67
    v_cvt_pk_bf16_f32 v234, v68, v69
    v_cvt_pk_bf16_f32 v235, v70, v71
    v_pk_fma_f32 v[72:73], v[64:65], v[80:81], v[72:73] op_sel_hi:[1,0,1] neg_lo:[0,0,1] neg_hi:[0,0,1]
    v_pk_fma_f32 v[74:75], v[66:67], v[80:81], v[74:75] op_sel_hi:[1,0,1] neg_lo:[0,0,1] neg_hi:[0,0,1]
    v_pk_fma_f32 v[76:77], v[68:69], v[80:81], v[76:77] op_sel_hi:[1,0,1] neg_lo:[0,0,1] neg_hi:[0,0,1]
    v_pk_fma_f32 v[78:79], v[70:71], v[80:81], v[78:79] op_sel_hi:[1,0,1] neg_lo:[0,0,1] neg_hi:[0,0,1]
    v_cvt_pk_bf16_f32 v248, v72, v73
    v_cvt_pk_bf16_f32 v249, v74, v75
    v_cvt_pk_bf16_f32 v250, v76, v77
    v_cvt_pk_bf16_f32 v251, v78, v79
    v_mul_f32 v80, v13, v11
    v_pk_fma_f32 v[64:65], v[24:25], v[10:11], v[12:13] op_sel:[0,1,0] op_sel_hi:[1,1,0]
    v_pk_fma_f32 v[66:67], v[26:27], v[10:11], v[12:13] op_sel:[0,1,0] op_sel_hi:[1,1,0]
    v_pk_fma_f32 v[68:69], v[28:29], v[10:11], v[12:13] op_sel:[0,1,0] op_sel_hi:[1,1,0]
    v_pk_fma_f32 v[70:71], v[30:31], v[10:11], v[12:13] op_sel:[0,1,0] op_sel_hi:[1,1,0]
    v_pk_add_f32 v[72:73], v[64:65], v[80:81] op_sel_hi:[1,0]
    v_pk_add_f32 v[74:75], v[66:67], v[80:81] op_sel_hi:[1,0]
    v_pk_add_f32 v[76:77], v[68:69], v[80:81] op_sel_hi:[1,0]
    v_pk_add_f32 v[78:79], v[70:71], v[80:81] op_sel_hi:[1,0]
    v_cos_f32 v80, v80
    v_cos_f32 v64, v64
    v_cos_f32 v65, v65
    v_cos_f32 v66, v66
    v_cos_f32 v67, v67
    v_cos_f32 v68, v68
    v_cos_f32 v69, v69
    v_cos_f32 v70, v70
    v_cos_f32 v71, v71
    v_cos_f32 v72, v72
    v_cos_f32 v73, v73
    v_cos_f32 v74, v74
    v_cos_f32 v75, v75
    v_cos_f32 v76, v76
    v_cos_f32 v77, v77
    v_cos_f32 v78, v78
    v_cos_f32 v79, v79
    v_add_f32 v80, v80, v80
    v_cvt_pk_bf16_f32 v140, v64, v65
    v_cvt_pk_bf16_f32 v141, v66, v67
    v_cvt_pk_bf16_f32 v142, v68, v69
    v_cvt_pk_bf16_f32 v143, v70, v71
    v_cvt_pk_bf16_f32 v156, v72, v73
    v_cvt_pk_bf16_f32 v157, v74, v75
    v_cvt_pk_bf16_f32 v158, v76, v77
    v_cvt_pk_bf16_f32 v159, v78, v79
    v_pk_fma_f32 v[64:65], v[72:73], v[80:81], v[64:65] op_sel_hi:[1,0,1] neg_lo:[0,0,1] neg_hi:[0,0,1]
    v_pk_fma_f32 v[66:67], v[74:75], v[80:81], v[66:67] op_sel_hi:[1,0,1] neg_lo:[0,0,1] neg_hi:[0,0,1]
    v_pk_fma_f32 v[68:69], v[76:77], v[80:81], v[68:69] op_sel_hi:[1,0,1] neg_lo:[0,0,1] neg_hi:[0,0,1]
    v_pk_fma_f32 v[70:71], v[78:79], v[80:81], v[70:71] op_sel_hi:[1,0,1] neg_lo:[0,0,1] neg_hi:[0,0,1]
    v_cvt_pk_bf16_f32 v172, v64, v65
    v_cvt_pk_bf16_f32 v173, v66, v67
    v_cvt_pk_bf16_f32 v174, v68, v69
    v_cvt_pk_bf16_f32 v175, v70, v71
    v_pk_fma_f32 v[72:73], v[64:65], v[80:81], v[72:73] op_sel_hi:[1,0,1] neg_lo:[0,0,1] neg_hi:[0,0,1]
    v_pk_fma_f32 v[74:75], v[66:67], v[80:81], v[74:75] op_sel_hi:[1,0,1] neg_lo:[0,0,1] neg_hi:[0,0,1]
    v_pk_fma_f32 v[76:77], v[68:69], v[80:81], v[76:77] op_sel_hi:[1,0,1] neg_lo:[0,0,1] neg_hi:[0,0,1]
    v_pk_fma_f32 v[78:79], v[70:71], v[80:81], v[78:79] op_sel_hi:[1,0,1] neg_lo:[0,0,1] neg_hi:[0,0,1]
    v_cvt_pk_bf16_f32 v188, v72, v73
    v_cvt_pk_bf16_f32 v189, v74, v75
    v_cvt_pk_bf16_f32 v190, v76, v77
    v_cvt_pk_bf16_f32 v191, v78, v79
    v_pk_fma_f32 v[64:65], v[72:73], v[80:81], v[64:65] op_sel_hi:[1,0,1] neg_lo:[0,0,1] neg_hi:[0,0,1]
    v_pk_fma_f32 v[66:67], v[74:75], v[80:81], v[66:67] op_sel_hi:[1,0,1] neg_lo:[0,0,1] neg_hi:[0,0,1]
    v_pk_fma_f32 v[68:69], v[76:77], v[80:81], v[68:69] op_sel_hi:[1,0,1] neg_lo:[0,0,1] neg_hi:[0,0,1]
    v_pk_fma_f32 v[70:71], v[78:79], v[80:81], v[70:71] op_sel_hi:[1,0,1] neg_lo:[0,0,1] neg_hi:[0,0,1]
    v_cvt_pk_bf16_f32 v204, v64, v65
    v_cvt_pk_bf16_f32 v205, v66, v67
    v_cvt_pk_bf16_f32 v206, v68, v69
    v_cvt_pk_bf16_f32 v207, v70, v71
    v_pk_fma_f32 v[72:73], v[64:65], v[80:81], v[72:73] op_sel_hi:[1,0,1] neg_lo:[0,0,1] neg_hi:[0,0,1]
    v_pk_fma_f32 v[74:75], v[66:67], v[80:81], v[74:75] op_sel_hi:[1,0,1] neg_lo:[0,0,1] neg_hi:[0,0,1]
    v_pk_fma_f32 v[76:77], v[68:69], v[80:81], v[76:77] op_sel_hi:[1,0,1] neg_lo:[0,0,1] neg_hi:[0,0,1]
    v_pk_fma_f32 v[78:79], v[70:71], v[80:81], v[78:79] op_sel_hi:[1,0,1] neg_lo:[0,0,1] neg_hi:[0,0,1]
    v_cvt_pk_bf16_f32 v220, v72, v73
    v_cvt_pk_bf16_f32 v221, v74, v75
    v_cvt_pk_bf16_f32 v222, v76, v77
    v_cvt_pk_bf16_f32 v223, v78, v79
    v_pk_fma_f32 v[64:65], v[72:73], v[80:81], v[64:65] op_sel_hi:[1,0,1] neg_lo:[0,0,1] neg_hi:[0,0,1]
    v_pk_fma_f32 v[66:67], v[74:75], v[80:81], v[66:67] op_sel_hi:[1,0,1] neg_lo:[0,0,1] neg_hi:[0,0,1]
    v_pk_fma_f32 v[68:69], v[76:77], v[80:81], v[68:69] op_sel_hi:[1,0,1] neg_lo:[0,0,1] neg_hi:[0,0,1]
    v_pk_fma_f32 v[70:71], v[78:79], v[80:81], v[70:71] op_sel_hi:[1,0,1] neg_lo:[0,0,1] neg_hi:[0,0,1]
    v_cvt_pk_bf16_f32 v236, v64, v65
    v_cvt_pk_bf16_f32 v237, v66, v67
    v_cvt_pk_bf16_f32 v238, v68, v69
    v_cvt_pk_bf16_f32 v239, v70, v71
    v_pk_fma_f32 v[72:73], v[64:65], v[80:81], v[72:73] op_sel_hi:[1,0,1] neg_lo:[0,0,1] neg_hi:[0,0,1]
    v_pk_fma_f32 v[74:75], v[66:67], v[80:81], v[74:75] op_sel_hi:[1,0,1] neg_lo:[0,0,1] neg_hi:[0,0,1]
    v_pk_fma_f32 v[76:77], v[68:69], v[80:81], v[76:77] op_sel_hi:[1,0,1] neg_lo:[0,0,1] neg_hi:[0,0,1]
    v_pk_fma_f32 v[78:79], v[70:71], v[80:81], v[78:79] op_sel_hi:[1,0,1] neg_lo:[0,0,1] neg_hi:[0,0,1]
    v_cvt_pk_bf16_f32 v252, v72, v73
    v_cvt_pk_bf16_f32 v253, v74, v75
    v_cvt_pk_bf16_f32 v254, v76, v77
    v_cvt_pk_bf16_f32 v255, v78, v79
    s_waitcnt vmcnt(0)
    s_barrier
    s_lshl_b32 s3, s63, 6
    s_add_u32 s3, s3, s86
    s_and_b32 s27, s60, 1
    s_lshl_b32 s27, s27, 5
    s_add_u32 s27, s27, s3
    v_lshl_add_u32 v21, v14, 1, s27
    s_bitcmp1_b32 s60, 1
    s_cselect_b32 s3, -1, 1
    s_cselect_b32 s27, 2048, 0
    v_mul_i32_i24 v21, s3, v21
    v_add_u32 v21, s27, v21
    v_lshrrev_b32 v20, 11, v21
    v_lshlrev_b32 v20, 10, v20
    v_sub_u32 v21, v21, v20
    v_lshlrev_b32 v21, 2, v21
    v_add_u32 v21, 9506816, v21
    s_lshl_b32 s3, s101, 1
    s_and_b32 s27, s60, 1
    s_add_u32 s3, s3, s27
    s_lshl_b32 s96, s3, 14
    s_lshr_b32 s27, s98, 1
    s_lshl_b32 s3, s27, 13
    s_add_u32 s96, s96, s3
    s_add_u32 s96, s96, 7340032
    s_cmp_eq_u32 s98, 0
    s_cselect_b32 s100, 8388608, s96
    s_lshl_b32 s3, s98, 12
    s_add_u32 s27, s3, 32768
    v_add_u32 v17, s27, v16
    s_lshl_b32 s3, s98, 6
    s_add_u32 s3, s3, 53248
    v_lshl_add_u32 v18, v14, 2, s3
    v_and_b32 v23, 1, v1
    v_lshlrev_b32 v23, 2, v23
    s_mov_b64 exec, -1
    s_mov_b32 s27, 0x40000
L_poll_1:
    buffer_load_dword v22, v23, s[40:43], s59 offen sc1
    s_waitcnt vmcnt(0)
    v_cmp_eq_u32 vcc, s58, v22
    s_nop 1
    s_cmp_eq_u64 vcc, exec
    s_cbranch_scc1 L_polld_2
    s_sleep 8
    s_sub_u32 s27, s27, 1
    s_cbranch_scc0 L_poll_1
L_polld_2:
    s_mov_b64 exec, -1
    buffer_load_dword v20, v21, s[40:43], 0 offen sc1
    s_add_u32 s27, s96, 0
    buffer_load_dwordx4 v[96:99], v16, s[40:43], s27 offen offset:0 sc1
    buffer_load_dwordx4 v[100:103], v16, s[40:43], s27 offen offset:1024 sc1
    buffer_load_dwordx4 v[104:107], v16, s[40:43], s27 offen offset:2048 sc1
    buffer_load_dwordx4 v[108:111], v16, s[40:43], s27 offen offset:3072 sc1
    s_add_u32 s27, s96, 4096
    buffer_load_dwordx4 v[112:115], v16, s[40:43], s27 offen offset:0 sc1
    buffer_load_dwordx4 v[116:119], v16, s[40:43], s27 offen offset:1024 sc1
    buffer_load_dwordx4 v[120:123], v16, s[40:43], s27 offen offset:2048 sc1
    buffer_load_dwordx4 v[124:127], v16, s[40:43], s27 offen offset:3072 sc1
    s_or_b32 s3, s101, s98
    s_cbranch_scc0 L_vspecial
    s_waitcnt vmcnt(7)
    v_mfma_f32_16x16x32_bf16 v[48:51], v[128:131], v[96:99], 0
    v_mfma_f32_16x16x32_bf16 v[52:55], v[132:135], v[96:99], 0
    v_mfma_f32_16x16x32_bf16 v[56:59], v[136:139], v[96:99], 0
    v_mfma_f32_16x16x32_bf16 v[60:63], v[140:143], v[96:99], 0
    s_waitcnt vmcnt(6)
    v_mfma_f32_16x16x32_bf16 v[48:51], v[144:147], v[100:103], v[48:51]
    v_mfma_f32_16x16x32_bf16 v[52:55], v[148:151], v[100:103], v[52:55]
    v_mfma_f32_16x16x32_bf16 v[56:59], v[152:155], v[100:103], v[56:59]
    v_mfma_f32_16x16x32_bf16 v[60:63], v[156:159], v[100:103], v[60:63]
    s_waitcnt vmcnt(5)
    v_mfma_f32_16x16x32_bf16 v[48:51], v[160:163], v[104:107], v[48:51]
    v_mfma_f32_16x16x32_bf16 v[52:55], v[164:167], v[104:107], v[52:55]
    v_mfma_f32_16x16x32_bf16 v[56:59], v[168:171], v[104:107], v[56:59]
    v_mfma_f32_16x16x32_bf16 v[60:63], v[172:175], v[104:107], v[60:63]
    s_waitcnt vmcnt(4)
    v_mfma_f32_16x16x32_bf16 v[48:51], v[176:179], v[108:111], v[48:51]
    v_mfma_f32_16x16x32_bf16 v[52:55], v[180:183], v[108:111], v[52:55]
    v_mfma_f32_16x16x32_bf16 v[56:59], v[184:187], v[108:111], v[56:59]
    v_mfma_f32_16x16x32_bf16 v[60:63], v[188:191], v[108:111], v[60:63]
    s_waitcnt vmcnt(3)
    v_mfma_f32_16x16x32_bf16 v[48:51], v[192:195], v[112:115], v[48:51]
    v_mfma_f32_16x16x32_bf16 v[52:55], v[196:199], v[112:115], v[52:55]
    v_mfma_f32_16x16x32_bf16 v[56:59], v[200:203], v[112:115], v[56:59]
    v_mfma_f32_16x16x32_bf16 v[60:63], v[204:207], v[112:115], v[60:63]
    s_waitcnt vmcnt(2)
    v_mfma_f32_16x16x32_bf16 v[48:51], v[208:211], v[116:119], v[48:51]
    v_mfma_f32_16x16x32_bf16 v[52:55], v[212:215], v[116:119], v[52:55]
    v_mfma_f32_16x16x32_bf16 v[56:59], v[216:219], v[116:119], v[56:59]
    v_mfma_f32_16x16x32_bf16 v[60:63], v[220:223], v[116:119], v[60:63]
    s_waitcnt vmcnt(1)
    v_mfma_f32_16x16x32_bf16 v[48:51], v[224:227], v[120:123], v[48:51]
    v_mfma_f32_16x16x32_bf16 v[52:55], v[228:231], v[120:123], v[52:55]
    v_mfma_f32_16x16x32_bf16 v[56:59], v[232:235], v[120:123], v[56:59]
    v_mfma_f32_16x16x32_bf16 v[60:63], v[236:239], v[120:123], v[60:63]
    s_waitcnt vmcnt(0)
    v_mfma_f32_16x16x32_bf16 v[48:51], v[240:243], v[124:127], v[48:51]
    v_mfma_f32_16x16x32_bf16 v[52:55], v[244:247], v[124:127], v[52:55]
    v_mfma_f32_16x16x32_bf16 v[56:59], v[248:251], v[124:127], v[56:59]
    v_mfma_f32_16x16x32_bf16 v[60:63], v[252:255], v[124:127], v[60:63]
    ds_write_b32 v18, v20
    s_nop 6
    ds_write_b128 v17, v[48:51] offset:0
    ds_write_b128 v17, v[52:55] offset:1024
    ds_write_b128 v17, v[56:59] offset:2048
    ds_write_b128 v17, v[60:63] offset:3072
    s_branch L_vdone
L_vspecial:
    s_add_u32 s27, s100, 0
    buffer_load_dwordx4 v[64:67], v16, s[40:43], s27 offen offset:0 sc1
    buffer_load_dwordx4 v[68:71], v16, s[40:43], s27 offen offset:1024 sc1
    buffer_load_dwordx4 v[72:75], v16, s[40:43], s27 offen offset:2048 sc1
    buffer_load_dwordx4 v[76:79], v16, s[40:43], s27 offen offset:3072 sc1
    s_add_u32 s27, s100, 4096
    buffer_load_dwordx4 v[80:83], v16, s[40:43], s27 offen offset:0 sc1
    buffer_load_dwordx4 v[84:87], v16, s[40:43], s27 offen offset:1024 sc1
    buffer_load_dwordx4 v[88:91], v16, s[40:43], s27 offen offset:2048 sc1
    buffer_load_dwordx4 v[92:95], v16, s[40:43], s27 offen offset:3072 sc1
    s_waitcnt vmcnt(7)
    v_mfma_f32_16x16x32_bf16 v[48:51], v[128:131], v[96:99], 0
    v_mfma_f32_16x16x32_bf16 v[32:35], v[128:131], v[64:67], 0
    v_mfma_f32_16x16x32_bf16 v[52:55], v[132:135], v[96:99], 0
    v_mfma_f32_16x16x32_bf16 v[36:39], v[132:135], v[64:67], 0
    v_mfma_f32_16x16x32_bf16 v[56:59], v[136:139], v[96:99], 0
    v_mfma_f32_16x16x32_bf16 v[40:43], v[136:139], v[64:67], 0
    v_mfma_f32_16x16x32_bf16 v[60:63], v[140:143], v[96:99], 0
    v_mfma_f32_16x16x32_bf16 v[44:47], v[140:143], v[64:67], 0
    s_waitcnt vmcnt(6)
    v_mfma_f32_16x16x32_bf16 v[48:51], v[144:147], v[100:103], v[48:51]
    v_mfma_f32_16x16x32_bf16 v[32:35], v[144:147], v[68:71], v[32:35]
    v_mfma_f32_16x16x32_bf16 v[52:55], v[148:151], v[100:103], v[52:55]
    v_mfma_f32_16x16x32_bf16 v[36:39], v[148:151], v[68:71], v[36:39]
    v_mfma_f32_16x16x32_bf16 v[56:59], v[152:155], v[100:103], v[56:59]
    v_mfma_f32_16x16x32_bf16 v[40:43], v[152:155], v[68:71], v[40:43]
    v_mfma_f32_16x16x32_bf16 v[60:63], v[156:159], v[100:103], v[60:63]
    v_mfma_f32_16x16x32_bf16 v[44:47], v[156:159], v[68:71], v[44:47]
    s_waitcnt vmcnt(5)
    v_mfma_f32_16x16x32_bf16 v[48:51], v[160:163], v[104:107], v[48:51]
    v_mfma_f32_16x16x32_bf16 v[32:35], v[160:163], v[72:75], v[32:35]
    v_mfma_f32_16x16x32_bf16 v[52:55], v[164:167], v[104:107], v[52:55]
    v_mfma_f32_16x16x32_bf16 v[36:39], v[164:167], v[72:75], v[36:39]
    v_mfma_f32_16x16x32_bf16 v[56:59], v[168:171], v[104:107], v[56:59]
    v_mfma_f32_16x16x32_bf16 v[40:43], v[168:171], v[72:75], v[40:43]
    v_mfma_f32_16x16x32_bf16 v[60:63], v[172:175], v[104:107], v[60:63]
    v_mfma_f32_16x16x32_bf16 v[44:47], v[172:175], v[72:75], v[44:47]
    s_waitcnt vmcnt(4)
    v_mfma_f32_16x16x32_bf16 v[48:51], v[176:179], v[108:111], v[48:51]
    v_mfma_f32_16x16x32_bf16 v[32:35], v[176:179], v[76:79], v[32:35]
    v_mfma_f32_16x16x32_bf16 v[52:55], v[180:183], v[108:111], v[52:55]
    v_mfma_f32_16x16x32_bf16 v[36:39], v[180:183], v[76:79], v[36:39]
    v_mfma_f32_16x16x32_bf16 v[56:59], v[184:187], v[108:111], v[56:59]
    v_mfma_f32_16x16x32_bf16 v[40:43], v[184:187], v[76:79], v[40:43]
    v_mfma_f32_16x16x32_bf16 v[60:63], v[188:191], v[108:111], v[60:63]
    v_mfma_f32_16x16x32_bf16 v[44:47], v[188:191], v[76:79], v[44:47]
    s_waitcnt vmcnt(3)
    v_mfma_f32_16x16x32_bf16 v[48:51], v[192:195], v[112:115], v[48:51]
    v_mfma_f32_16x16x32_bf16 v[32:35], v[192:195], v[80:83], v[32:35]
    v_mfma_f32_16x16x32_bf16 v[52:55], v[196:199], v[112:115], v[52:55]
    v_mfma_f32_16x16x32_bf16 v[36:39], v[196:199], v[80:83], v[36:39]
    v_mfma_f32_16x16x32_bf16 v[56:59], v[200:203], v[112:115], v[56:59]
    v_mfma_f32_16x16x32_bf16 v[40:43], v[200:203], v[80:83], v[40:43]
    v_mfma_f32_16x16x32_bf16 v[60:63], v[204:207], v[112:115], v[60:63]
    v_mfma_f32_16x16x32_bf16 v[44:47], v[204:207], v[80:83], v[44:47]
    s_waitcnt vmcnt(2)
    v_mfma_f32_16x16x32_bf16 v[48:51], v[208:211], v[116:119], v[48:51]
    v_mfma_f32_16x16x32_bf16 v[32:35], v[208:211], v[84:87], v[32:35]
    v_mfma_f32_16x16x32_bf16 v[52:55], v[212:215], v[116:119], v[52:55]
    v_mfma_f32_16x16x32_bf16 v[36:39], v[212:215], v[84:87], v[36:39]
    v_mfma_f32_16x16x32_bf16 v[56:59], v[216:219], v[116:119], v[56:59]
    v_mfma_f32_16x16x32_bf16 v[40:43], v[216:219], v[84:87], v[40:43]
    v_mfma_f32_16x16x32_bf16 v[60:63], v[220:223], v[116:119], v[60:63]
    v_mfma_f32_16x16x32_bf16 v[44:47], v[220:223], v[84:87], v[44:47]
    s_waitcnt vmcnt(1)
    v_mfma_f32_16x16x32_bf16 v[48:51], v[224:227], v[120:123], v[48:51]
    v_mfma_f32_16x16x32_bf16 v[32:35], v[224:227], v[88:91], v[32:35]
    v_mfma_f32_16x16x32_bf16 v[52:55], v[228:231], v[120:123], v[52:55]
    v_mfma_f32_16x16x32_bf16 v[36:39], v[228:231], v[88:91], v[36:39]
    v_mfma_f32_16x16x32_bf16 v[56:59], v[232:235], v[120:123], v[56:59]
    v_mfma_f32_16x16x32_bf16 v[40:43], v[232:235], v[88:91], v[40:43]
    v_mfma_f32_16x16x32_bf16 v[60:63], v[236:239], v[120:123], v[60:63]
    v_mfma_f32_16x16x32_bf16 v[44:47], v[236:239], v[88:91], v[44:47]
    s_waitcnt vmcnt(0)
    v_mfma_f32_16x16x32_bf16 v[48:51], v[240:243], v[124:127], v[48:51]
    v_mfma_f32_16x16x32_bf16 v[32:35], v[240:243], v[92:95], v[32:35]
    v_mfma_f32_16x16x32_bf16 v[52:55], v[244:247], v[124:127], v[52:55]
    v_mfma_f32_16x16x32_bf16 v[36:39], v[244:247], v[92:95], v[36:39]
    v_mfma_f32_16x16x32_bf16 v[56:59], v[248:251], v[124:127], v[56:59]
    v_mfma_f32_16x16x32_bf16 v[40:43], v[248:251], v[92:95], v[40:43]
    v_mfma_f32_16x16x32_bf16 v[60:63], v[252:255], v[124:127], v[60:63]
    v_mfma_f32_16x16x32_bf16 v[44:47], v[252:255], v[92:95], v[44:47]
    ds_write_b32 v18, v20
    s_nop 6
    ds_write_b128 v17, v[48:51] offset:0
    ds_write_b128 v17, v[52:55] offset:1024
    ds_write_b128 v17, v[56:59] offset:2048
    ds_write_b128 v17, v[60:63] offset:3072
    s_mov_b32 s26, 0x00010001
    s_mov_b32 s27, 0x00010001
    v_cndmask_b32 v32, v48, v32, s[26:27]
    v_cndmask_b32 v33, v49, v33, s[26:27]
    v_cndmask_b32 v34, v50, v34, s[26:27]
    v_cndmask_b32 v35, v51, v35, s[26:27]
    v_cndmask_b32 v36, v52, v36, s[26:27]
    v_cndmask_b32 v37, v53, v37, s[26:27]
    v_cndmask_b32 v38, v54, v38, s[26:27]
    v_cndmask_b32 v39, v55, v39, s[26:27]
    v_cndmask_b32 v40, v56, v40, s[26:27]
    v_cndmask_b32 v41, v57, v41, s[26:27]
    v_cndmask_b32 v42, v58, v42, s[26:27]
    v_cndmask_b32 v43, v59, v43, s[26:27]
    v_cndmask_b32 v44, v60, v44, s[26:27]
    v_cndmask_b32 v45, v61, v45, s[26:27]
    v_cndmask_b32 v46, v62, v46, s[26:27]
    v_cndmask_b32 v47, v63, v47, s[26:27]
    ds_write_b128 v17, v[32:35] offset:16384
    ds_write_b128 v17, v[36:39] offset:17408
    ds_write_b128 v17, v[40:43] offset:18432
    ds_write_b128 v17, v[44:47] offset:19456
L_vdone:
    s_waitcnt lgkmcnt(0)
    s_barrier
    s_endpgm
L_dft:
    s_mov_b32 s32, s16
    s_and_b32 s33, s17, 0xffff
    s_mov_b32 s34, 1605632
    s_mov_b32 s35, 0x20000
    v_lshlrev_b32 v210, 7, v1
    s_lshl_b32 s3, s63, 13
    s_add_u32 s27, s60, -1
    s_lshl_b32 s27, s27, 18
    s_add_u32 s3, s3, s27
    s_cmp_ge_u32 s60, 4
    s_cselect_b32 s3, s3, 2147417856
    v_add_u32 v210, s3, v210
    buffer_load_dword v211, v210, s[32:35], 0 offen
    s_cmp_lg_u32 s60, 7
    s_cbranch_scc1 L_dnotouch
L_dnotouch:
    s_lshl_b32 s3, s97, 7
    s_lshl_b32 s27, s60, 4
    s_add_u32 s3, s3, s27
    s_lshl_b32 s3, s3, 1
    s_add_u32 s3, s3, s99
    v_and_b32 v13, 15, v1
    v_lshl_add_u32 v13, v13, 1, s3
    v_cvt_f32_u32 v13, v13
    v_mul_f32 v13, 0x3a000000, v13
    v_lshrrev_b32 v14, 4, v1
    v_lshlrev_b32 v14, 3, v14
    v_cvt_f32_u32 v14, v14
    s_cmp_ge_u32 s96, 2
    s_cselect_b32 s3, 0x3e800000, 0
    v_fma_f32 v160, v13, v14, s3
    v_mul_f32 v14, 0x42000000, v13
    v_lshlrev_b32 v16, 4, v1
    s_lshl_b32 s3, s60, 10
    v_add_u32 v16, s3, v16
    v_add_u32 v17, 0x10000, v16
    v_add_f32 v161, v13, v160
    v_add_f32 v162, v13, v161
    v_add_f32 v163, v13, v162
    v_add_f32 v164, v13, v163
    v_add_f32 v165, v13, v164
    v_add_f32 v166, v13, v165
    v_add_f32 v167, v13, v166
    v_add_f32 v168, v14, v160
    v_add_f32 v169, v14, v161
    v_add_f32 v170, v14, v162
    v_add_f32 v171, v14, v163
    v_add_f32 v172, v14, v164
    v_add_f32 v173, v14, v165
    v_add_f32 v174, v14, v166
    v_add_f32 v175, v14, v167
    v_cos_f32 v14, v14
    v_cos_f32 v160, v160
    v_cos_f32 v161, v161
    v_cos_f32 v162, v162
    v_cos_f32 v163, v163
    v_cos_f32 v164, v164
    v_cos_f32 v165, v165
    v_cos_f32 v166, v166
    v_cos_f32 v167, v167
    v_cos_f32 v168, v168
    v_cos_f32 v169, v169
    v_cos_f32 v170, v170
    v_cos_f32 v171, v171
    v_cos_f32 v172, v172
    v_cos_f32 v173, v173
    v_cos_f32 v174, v174
    v_cos_f32 v175, v175
    v_add_f32 v14, v14, v14
    v_mov_b32 v184, v14
    v_mov_b32 v186, v16
    v_mov_b32 v187, v17
    v_cvt_pk_bf16_f32 v176, v160, v161
    v_cvt_pk_bf16_f32 v177, v162, v163
    v_cvt_pk_bf16_f32 v178, v164, v165
    v_cvt_pk_bf16_f32 v179, v166, v167
    ds_write_b128 v186, v[176:179] offset:0
    v_cvt_pk_bf16_f32 v180, v168, v169
    v_cvt_pk_bf16_f32 v181, v170, v171
    v_cvt_pk_bf16_f32 v182, v172, v173
    v_cvt_pk_bf16_f32 v183, v174, v175
    ds_write_b128 v186, v[180:183] offset:8192
    v_pk_fma_f32 v[160:161], v[168:169], v[184:185], v[160:161] op_sel_hi:[1,0,1] neg_lo:[0,0,1] neg_hi:[0,0,1]
    v_pk_fma_f32 v[162:163], v[170:171], v[184:185], v[162:163] op_sel_hi:[1,0,1] neg_lo:[0,0,1] neg_hi:[0,0,1]
    v_pk_fma_f32 v[164:165], v[172:173], v[184:185], v[164:165] op_sel_hi:[1,0,1] neg_lo:[0,0,1] neg_hi:[0,0,1]
    v_pk_fma_f32 v[166:167], v[174:175], v[184:185], v[166:167] op_sel_hi:[1,0,1] neg_lo:[0,0,1] neg_hi:[0,0,1]
    v_cvt_pk_bf16_f32 v176, v160, v161
    v_cvt_pk_bf16_f32 v177, v162, v163
    v_cvt_pk_bf16_f32 v178, v164, v165
    v_cvt_pk_bf16_f32 v179, v166, v167
    ds_write_b128 v186, v[176:179] offset:16384
    v_pk_fma_f32 v[168:169], v[160:161], v[184:185], v[168:169] op_sel_hi:[1,0,1] neg_lo:[0,0,1] neg_hi:[0,0,1]
    v_pk_fma_f32 v[170:171], v[162:163], v[184:185], v[170:171] op_sel_hi:[1,0,1] neg_lo:[0,0,1] neg_hi:[0,0,1]
    v_pk_fma_f32 v[172:173], v[164:165], v[184:185], v[172:173] op_sel_hi:[1,0,1] neg_lo:[0,0,1] neg_hi:[0,0,1]
    v_pk_fma_f32 v[174:175], v[166:167], v[184:185], v[174:175] op_sel_hi:[1,0,1] neg_lo:[0,0,1] neg_hi:[0,0,1]
    v_cvt_pk_bf16_f32 v180, v168, v169
    v_cvt_pk_bf16_f32 v181, v170, v171
    v_cvt_pk_bf16_f32 v182, v172, v173
    v_cvt_pk_bf16_f32 v183, v174, v175
    ds_write_b128 v186, v[180:183] offset:24576
    v_cmp_eq_u32 s[26:27], 0, v3
    v_cndmask_b32 v21, 0, 2.0, vcc
    v_cmp_eq_u32 vcc, 28, v3
    v_mov_b32 v24, 0
    v_cndmask_b32 v20, v21, 1.0, s[26:27]
    v_mov_b32 v25, 0
    v_cndmask_b32 v20, v20, 1.0, vcc
    v_mov_b32 v26, 0
    v_mov_b32 v27, 0
    s_waitcnt vmcnt(7)
    v_mov_b32_dpp v24, v36 row_bcast:15 row_mask:0xa bank_mask:0xf
    v_lshlrev_b32 v128, 16, v32
    v_and_b32 v129, 0xffff0000, v32
    v_lshlrev_b32 v130, 16, v33
    v_and_b32 v131, 0xffff0000, v33
    v_lshlrev_b32 v132, 16, v34
    v_and_b32 v133, 0xffff0000, v34
    v_lshlrev_b32 v134, 16, v35
    v_and_b32 v135, 0xffff0000, v35
    v_mov_b32_dpp v24, v36 row_shr:1 row_mask:0xf bank_mask:0xf
    v_and_b32 v137, 0xffff0000, v39
    v_lshlrev_b32 v138, 16, v39
    v_and_b32 v139, 0xffff0000, v38
    v_lshlrev_b32 v140, 16, v38
    v_and_b32 v141, 0xffff0000, v37
    v_lshlrev_b32 v142, 16, v37
    v_and_b32 v143, 0xffff0000, v36
    v_lshlrev_b32 v136, 16, v24
    v_pk_add_f32 v[64:65], v[128:129], v[136:137]
    v_pk_add_f32 v[72:73], v[128:129], v[136:137] neg_lo:[0,1] neg_hi:[0,1]
    v_pk_add_f32 v[66:67], v[130:131], v[138:139]
    v_pk_add_f32 v[74:75], v[130:131], v[138:139] neg_lo:[0,1] neg_hi:[0,1]
    v_pk_add_f32 v[68:69], v[132:133], v[140:141]
    v_pk_add_f32 v[76:77], v[132:133], v[140:141] neg_lo:[0,1] neg_hi:[0,1]
    v_pk_add_f32 v[70:71], v[134:135], v[142:143]
    v_pk_add_f32 v[78:79], v[134:135], v[142:143] neg_lo:[0,1] neg_hi:[0,1]
    v_pk_add_f32 v[144:145], v[64:65], v[66:67]
    v_pk_mul_f32 v[146:147], v[64:65], v[64:65]
    v_pk_fma_f32 v[146:147], v[72:73], v[72:73], v[146:147]
    v_pk_fma_f32 v[146:147], v[66:67], v[66:67], v[146:147]
    v_pk_fma_f32 v[146:147], v[74:75], v[74:75], v[146:147]
    v_pk_add_f32 v[144:145], v[144:145], v[68:69]
    v_pk_fma_f32 v[146:147], v[68:69], v[68:69], v[146:147]
    v_pk_fma_f32 v[146:147], v[76:77], v[76:77], v[146:147]
    v_pk_add_f32 v[144:145], v[144:145], v[70:71]
    v_pk_fma_f32 v[146:147], v[70:71], v[70:71], v[146:147]
    v_pk_fma_f32 v[146:147], v[78:79], v[78:79], v[146:147]
    s_waitcnt vmcnt(5)
    v_mov_b32_dpp v25, v44 row_bcast:15 row_mask:0xa bank_mask:0xf
    v_lshlrev_b32 v128, 16, v40
    v_and_b32 v129, 0xffff0000, v40
    v_lshlrev_b32 v130, 16, v41
    v_and_b32 v131, 0xffff0000, v41
    v_lshlrev_b32 v132, 16, v42
    v_and_b32 v133, 0xffff0000, v42
    v_lshlrev_b32 v134, 16, v43
    v_and_b32 v135, 0xffff0000, v43
    v_mov_b32_dpp v25, v44 row_shr:1 row_mask:0xf bank_mask:0xf
    v_and_b32 v137, 0xffff0000, v47
    v_lshlrev_b32 v138, 16, v47
    v_and_b32 v139, 0xffff0000, v46
    v_lshlrev_b32 v140, 16, v46
    v_and_b32 v141, 0xffff0000, v45
    v_lshlrev_b32 v142, 16, v45
    v_and_b32 v143, 0xffff0000, v44
    v_lshlrev_b32 v136, 16, v25
    v_pk_add_f32 v[80:81], v[128:129], v[136:137]
    v_pk_add_f32 v[88:89], v[128:129], v[136:137] neg_lo:[0,1] neg_hi:[0,1]
    v_pk_add_f32 v[82:83], v[130:131], v[138:139]
    v_pk_add_f32 v[90:91], v[130:131], v[138:139] neg_lo:[0,1] neg_hi:[0,1]
    v_pk_add_f32 v[84:85], v[132:133], v[140:141]
    v_pk_add_f32 v[92:93], v[132:133], v[140:141] neg_lo:[0,1] neg_hi:[0,1]
    v_pk_add_f32 v[86:87], v[134:135], v[142:143]
    v_pk_add_f32 v[94:95], v[134:135], v[142:143] neg_lo:[0,1] neg_hi:[0,1]
    v_pk_add_f32 v[148:149], v[80:81], v[82:83]
    v_pk_mul_f32 v[150:151], v[80:81], v[80:81]
    v_pk_fma_f32 v[150:151], v[88:89], v[88:89], v[150:151]
    v_pk_fma_f32 v[150:151], v[82:83], v[82:83], v[150:151]
    v_pk_fma_f32 v[150:151], v[90:91], v[90:91], v[150:151]
    v_pk_add_f32 v[148:149], v[148:149], v[84:85]
    v_pk_fma_f32 v[150:151], v[84:85], v[84:85], v[150:151]
    v_pk_fma_f32 v[150:151], v[92:93], v[92:93], v[150:151]
    v_pk_add_f32 v[148:149], v[148:149], v[86:87]
    v_pk_fma_f32 v[150:151], v[86:87], v[86:87], v[150:151]
    v_pk_fma_f32 v[150:151], v[94:95], v[94:95], v[150:151]
    s_waitcnt vmcnt(3)
    v_mov_b32_dpp v26, v52 row_bcast:15 row_mask:0xa bank_mask:0xf
    v_lshlrev_b32 v128, 16, v48
    v_and_b32 v129, 0xffff0000, v48
    v_lshlrev_b32 v130, 16, v49
    v_and_b32 v131, 0xffff0000, v49
    v_lshlrev_b32 v132, 16, v50
    v_and_b32 v133, 0xffff0000, v50
    v_lshlrev_b32 v134, 16, v51
    v_and_b32 v135, 0xffff0000, v51
    v_mov_b32_dpp v26, v52 row_shr:1 row_mask:0xf bank_mask:0xf
    v_and_b32 v137, 0xffff0000, v55
    v_lshlrev_b32 v138, 16, v55
    v_and_b32 v139, 0xffff0000, v54
    v_lshlrev_b32 v140, 16, v54
    v_and_b32 v141, 0xffff0000, v53
    v_lshlrev_b32 v142, 16, v53
    v_and_b32 v143, 0xffff0000, v52
    v_lshlrev_b32 v136, 16, v26
    v_pk_add_f32 v[96:97], v[128:129], v[136:137]
    v_pk_add_f32 v[104:105], v[128:129], v[136:137] neg_lo:[0,1] neg_hi:[0,1]
    v_pk_add_f32 v[98:99], v[130:131], v[138:139]
    v_pk_add_f32 v[106:107], v[130:131], v[138:139] neg_lo:[0,1] neg_hi:[0,1]
    v_pk_add_f32 v[100:101], v[132:133], v[140:141]
    v_pk_add_f32 v[108:109], v[132:133], v[140:141] neg_lo:[0,1] neg_hi:[0,1]
    v_pk_add_f32 v[102:103], v[134:135], v[142:143]
    v_pk_add_f32 v[110:111], v[134:135], v[142:143] neg_lo:[0,1] neg_hi:[0,1]
    v_pk_add_f32 v[152:153], v[96:97], v[98:99]
    v_pk_mul_f32 v[154:155], v[96:97], v[96:97]
    v_pk_fma_f32 v[154:155], v[104:105], v[104:105], v[154:155]
    v_pk_fma_f32 v[154:155], v[98:99], v[98:99], v[154:155]
    v_pk_fma_f32 v[154:155], v[106:107], v[106:107], v[154:155]
    v_pk_add_f32 v[152:153], v[152:153], v[100:101]
    v_pk_fma_f32 v[154:155], v[100:101], v[100:101], v[154:155]
    v_pk_fma_f32 v[154:155], v[108:109], v[108:109], v[154:155]
    v_pk_add_f32 v[152:153], v[152:153], v[102:103]
    v_pk_fma_f32 v[154:155], v[102:103], v[102:103], v[154:155]
    v_pk_fma_f32 v[154:155], v[110:111], v[110:111], v[154:155]
    s_waitcnt vmcnt(1)
    v_mov_b32_dpp v27, v60 row_bcast:15 row_mask:0xa bank_mask:0xf
    v_lshlrev_b32 v128, 16, v56
    v_and_b32 v129, 0xffff0000, v56
    v_lshlrev_b32 v130, 16, v57
    v_and_b32 v131, 0xffff0000, v57
    v_lshlrev_b32 v132, 16, v58
    v_and_b32 v133, 0xffff0000, v58
    v_lshlrev_b32 v134, 16, v59
    v_and_b32 v135, 0xffff0000, v59
    v_mov_b32_dpp v27, v60 row_shr:1 row_mask:0xf bank_mask:0xf
    v_and_b32 v137, 0xffff0000, v63
    v_lshlrev_b32 v138, 16, v63
    v_and_b32 v139, 0xffff0000, v62
    v_lshlrev_b32 v140, 16, v62
    v_and_b32 v141, 0xffff0000, v61
    v_lshlrev_b32 v142, 16, v61
    v_and_b32 v143, 0xffff0000, v60
    v_lshlrev_b32 v136, 16, v27
    v_pk_add_f32 v[112:113], v[128:129], v[136:137]
    v_pk_add_f32 v[120:121], v[128:129], v[136:137] neg_lo:[0,1] neg_hi:[0,1]
    v_pk_add_f32 v[114:115], v[130:131], v[138:139]
    v_pk_add_f32 v[122:123], v[130:131], v[138:139] neg_lo:[0,1] neg_hi:[0,1]
    v_pk_add_f32 v[116:117], v[132:133], v[140:141]
    v_pk_add_f32 v[124:125], v[132:133], v[140:141] neg_lo:[0,1] neg_hi:[0,1]
    v_pk_add_f32 v[118:119], v[134:135], v[142:143]
    v_pk_add_f32 v[126:127], v[134:135], v[142:143] neg_lo:[0,1] neg_hi:[0,1]
    v_pk_add_f32 v[156:157], v[112:113], v[114:115]
    v_pk_mul_f32 v[158:159], v[112:113], v[112:113]
    v_pk_fma_f32 v[158:159], v[120:121], v[120:121], v[158:159]
    v_pk_fma_f32 v[158:159], v[114:115], v[114:115], v[158:159]
    v_pk_fma_f32 v[158:159], v[122:123], v[122:123], v[158:159]
    v_pk_add_f32 v[156:157], v[156:157], v[116:117]
    v_pk_fma_f32 v[158:159], v[116:117], v[116:117], v[158:159]
    v_pk_fma_f32 v[158:159], v[124:125], v[124:125], v[158:159]
    v_pk_add_f32 v[156:157], v[156:157], v[118:119]
    v_pk_fma_f32 v[158:159], v[118:119], v[118:119], v[158:159]
    v_pk_fma_f32 v[158:159], v[126:127], v[126:127], v[158:159]
    v_add_f32 v144, v144, v145
    v_add_f32 v146, v146, v147
    v_add_f32 v148, v148, v149
    v_add_f32 v150, v150, v151
    v_add_f32 v152, v152, v153
    v_add_f32 v154, v154, v155
    v_add_f32 v156, v156, v157
    v_add_f32 v158, v158, v159
    v_permlane16_swap_b32 v144, v152
    v_permlane16_swap_b32 v146, v154
    v_permlane16_swap_b32 v148, v156
    v_permlane16_swap_b32 v150, v158
    v_add_f32 v144, v144, v152
    v_add_f32 v146, v146, v154
    v_add_f32 v148, v148, v156
    v_add_f32 v150, v150, v158
    v_add_f32_dpp v144, v144, v144 row_ror:8 row_mask:0xf bank_mask:0xf
    v_add_f32_dpp v146, v146, v146 row_ror:8 row_mask:0xf bank_mask:0xf
    v_add_f32_dpp v148, v148, v148 row_ror:8 row_mask:0xf bank_mask:0xf
    v_add_f32_dpp v150, v150, v150 row_ror:8 row_mask:0xf bank_mask:0xf
    v_add_f32_dpp v144, v144, v144 row_ror:4 row_mask:0xf bank_mask:0xf
    v_add_f32_dpp v146, v146, v146 row_ror:4 row_mask:0xf bank_mask:0xf
    v_add_f32_dpp v148, v148, v148 row_ror:4 row_mask:0xf bank_mask:0xf
    v_add_f32_dpp v150, v150, v150 row_ror:4 row_mask:0xf bank_mask:0xf
    v_add_f32_dpp v144, v144, v144 row_ror:2 row_mask:0xf bank_mask:0xf
    v_add_f32_dpp v146, v146, v146 row_ror:2 row_mask:0xf bank_mask:0xf
    v_add_f32_dpp v148, v148, v148 row_ror:2 row_mask:0xf bank_mask:0xf
    v_add_f32_dpp v150, v150, v150 row_ror:2 row_mask:0xf bank_mask:0xf
    v_add_f32_dpp v144, v144, v144 row_ror:1 row_mask:0xf bank_mask:0xf
    v_add_f32_dpp v146, v146, v146 row_ror:1 row_mask:0xf bank_mask:0xf
    v_add_f32_dpp v148, v148, v148 row_ror:1 row_mask:0xf bank_mask:0xf
    v_add_f32_dpp v150, v150, v150 row_ror:1 row_mask:0xf bank_mask:0xf
    s_mov_b32 s3, 991054117
    s_mov_b32 s26, 982665509
    s_mov_b32 s27, 925353388
    v_mul_f32 v144, s3, v144
    v_mul_f32 v146, s26, v146
    v_mul_f32 v148, s3, v148
    v_mul_f32 v150, s26, v150
    v_fma_f32 v146, -v144, v144, v146
    v_fma_f32 v150, -v148, v148, v150
    v_max_f32 v146, 0, v146
    v_max_f32 v150, 0, v150
    v_cvt_pk_bf16_f32 v145, v144, v146
    v_cvt_pk_bf16_f32 v149, v148, v150
    v_lshlrev_b32 v144, 16, v145
    v_and_b32 v146, 0xffff0000, v145
    v_lshlrev_b32 v148, 16, v149
    v_and_b32 v150, 0xffff0000, v149
    v_add_f32 v146, s27, v146
    v_add_f32 v150, s27, v150
    v_cvt_pk_bf16_f32 v146, v146, v146
    v_cvt_pk_bf16_f32 v150, v150, v150
    v_and_b32 v146, 0xffff0000, v146
    v_and_b32 v150, 0xffff0000, v150
    v_sqrt_f32 v146, v146
    v_sqrt_f32 v150, v150
    s_nop 0
    v_cvt_pk_bf16_f32 v146, v146, v146
    s_nop 0
    v_cvt_pk_bf16_f32 v150, v150, v150
    v_and_b32 v146, 0xffff0000, v146
    v_and_b32 v150, 0xffff0000, v150
    v_rcp_f32 v24, v146
    v_rcp_f32 v25, v150
    s_nop 0
    v_mul_f32 v28, v144, v24
    v_mul_f32 v29, v148, v25
    v_mov_b32 v26, v24
    v_mov_b32 v27, v25
    v_mov_b32 v30, v28
    v_mov_b32 v31, v29
    s_nop 0
    v_permlane16_swap_b32 v24, v26
    v_permlane16_swap_b32 v25, v27
    v_permlane16_swap_b32 v28, v30
    v_permlane16_swap_b32 v29, v31
    v_cmp_eq_u32 vcc, 1, v3
    v_cmp_eq_u32 s[26:27], 2, v3
    v_mov_b32 v8, v4
    v_mov_b32 v9, v24
    v_cndmask_b32 v8, v8, v5, vcc
    v_cndmask_b32 v9, v9, v25, vcc
    v_cmp_eq_u32 vcc, 3, v3
    v_cndmask_b32 v8, v8, v6, s[26:27]
    v_cndmask_b32 v9, v9, v26, s[26:27]
    v_cndmask_b32 v8, v8, v7, vcc
    v_cndmask_b32 v9, v9, v27, vcc
    v_cmp_gt_u32 vcc, 4, v3
    v_lshlrev_b32 v8, 2, v8
    v_add_u32 v8, 9506816, v8
    v_cndmask_b32 v8, v12, v8, vcc
    buffer_store_dword v9, v8, s[40:43], 0 offen sc1
    s_or_b32 s3, s63, s60
    s_cmp_lg_u32 s3, 0
    s_cbranch_scc1 L_no512
    v_add_f32 v10, v29, v31
    v_mul_f32 v128, v10, v20
    v_fma_f32 v128, v80, v25, -v128
    v_fma_f32 v128, v112, v27, v128
    v_mul_f32 v136, v88, v25
    v_fma_f32 v136, -v120, v27, v136
    v_mul_f32 v129, v10, v21
    v_fma_f32 v129, v81, v25, -v129
    v_fma_f32 v129, v113, v27, v129
    v_mul_f32 v137, v89, v25
    v_fma_f32 v137, -v121, v27, v137
    v_mul_f32 v130, v10, v21
    v_fma_f32 v130, v82, v25, -v130
    v_fma_f32 v130, v114, v27, v130
    v_mul_f32 v138, v90, v25
    v_fma_f32 v138, -v122, v27, v138
    v_mul_f32 v131, v10, v21
    v_fma_f32 v131, v83, v25, -v131
    v_fma_f32 v131, v115, v27, v131
    v_mul_f32 v139, v91, v25
    v_fma_f32 v139, -v123, v27, v139
    v_mul_f32 v132, v10, v21
    v_fma_f32 v132, v84, v25, -v132
    v_fma_f32 v132, v116, v27, v132
    v_mul_f32 v140, v92, v25
    v_fma_f32 v140, -v124, v27, v140
    v_mul_f32 v133, v10, v21
    v_fma_f32 v133, v85, v25, -v133
    v_fma_f32 v133, v117, v27, v133
    v_mul_f32 v141, v93, v25
    v_fma_f32 v141, -v125, v27, v141
    v_mul_f32 v134, v10, v21
    v_fma_f32 v134, v86, v25, -v134
    v_fma_f32 v134, v118, v27, v134
    v_mul_f32 v142, v94, v25
    v_fma_f32 v142, -v126, v27, v142
    v_mul_f32 v135, v10, v21
    v_fma_f32 v135, v87, v25, -v135
    v_fma_f32 v135, v119, v27, v135
    v_mul_f32 v143, v95, v25
    v_fma_f32 v143, -v127, v27, v143
    v_cvt_pk_bf16_f32 v32, v128, v129
    v_cvt_pk_bf16_f32 v36, v136, v137
    v_cvt_pk_bf16_f32 v33, v130, v131
    v_cvt_pk_bf16_f32 v37, v138, v139
    v_cvt_pk_bf16_f32 v34, v132, v133
    v_cvt_pk_bf16_f32 v38, v140, v141
    v_cvt_pk_bf16_f32 v35, v134, v135
    v_cvt_pk_bf16_f32 v39, v142, v143
    v_lshlrev_b32 v10, 4, v3
    v_add_u32 v10, 9502720, v10
    v_cndmask_b32 v10, v12, v10, s[100:101]
    buffer_store_dwordx4 v[32:35], v10, s[40:43], 0 offen sc1
    buffer_store_dwordx4 v[36:39], v10, s[40:43], 0 offen offset:1536 sc1
    s_nop 1
L_no512:
    v_cndmask_b32 v25, v25, 0, s[100:101]
    v_cndmask_b32 v27, v27, 0, s[100:101]
    v_cndmask_b32 v29, v29, 0, s[100:101]
    v_cndmask_b32 v31, v31, 0, s[100:101]
    v_add_f32 v28, v28, v29
    v_add_f32 v30, v30, v31
    v_pk_mul_f32 v[8:9], v[20:21], v[28:29] op_sel_hi:[1,0] neg_lo:[1,0] neg_hi:[1,0]
    v_pk_mul_f32 v[10:11], v[20:21], v[30:31] op_sel_hi:[1,0] neg_lo:[1,0] neg_hi:[1,0]
    v_pk_fma_f32 v[128:129], v[64:65], v[24:25], v[8:9] op_sel:[0,0,0] op_sel_hi:[1,0,1]
    v_pk_fma_f32 v[130:131], v[96:97], v[26:27], v[10:11] op_sel:[0,0,0] op_sel_hi:[1,0,1]
    v_pk_mul_f32 v[136:137], v[72:73], v[24:25] op_sel_hi:[1,0]
    v_pk_mul_f32 v[138:139], v[120:121], v[26:27] op_sel:[0,1] op_sel_hi:[1,1]
    v_pk_fma_f32 v[128:129], v[80:81], v[24:25], v[128:129] op_sel:[0,1,0] op_sel_hi:[1,1,1]
    v_pk_fma_f32 v[130:131], v[112:113], v[26:27], v[130:131] op_sel:[0,1,0] op_sel_hi:[1,1,1]
    v_pk_fma_f32 v[136:137], v[88:89], v[24:25], v[136:137] op_sel:[0,1,0] op_sel_hi:[1,1,1] neg_lo:[1,0,0] neg_hi:[1,0,0]
    v_pk_fma_f32 v[138:139], v[104:105], v[26:27], v[138:139] op_sel_hi:[1,0,1] neg_lo:[1,0,0] neg_hi:[1,0,0]
    v_pk_add_f32 v[32:33], v[128:129], v[130:131]
    v_pk_add_f32 v[40:41], v[128:129], v[130:131] neg_lo:[0,1] neg_hi:[0,1]
    v_pk_add_f32 v[48:49], v[136:137], v[138:139]
    v_pk_add_f32 v[56:57], v[136:137], v[138:139] neg_lo:[0,1] neg_hi:[0,1]
    v_pk_fma_f32 v[128:129], v[66:67], v[24:25], v[8:9] op_sel:[0,0,1] op_sel_hi:[1,0,1]
    v_pk_fma_f32 v[130:131], v[98:99], v[26:27], v[10:11] op_sel:[0,0,1] op_sel_hi:[1,0,1]
    v_pk_mul_f32 v[136:137], v[74:75], v[24:25] op_sel_hi:[1,0]
    v_pk_mul_f32 v[138:139], v[122:123], v[26:27] op_sel:[0,1] op_sel_hi:[1,1]
    v_pk_fma_f32 v[128:129], v[82:83], v[24:25], v[128:129] op_sel:[0,1,0] op_sel_hi:[1,1,1]
    v_pk_fma_f32 v[130:131], v[114:115], v[26:27], v[130:131] op_sel:[0,1,0] op_sel_hi:[1,1,1]
    v_pk_fma_f32 v[136:137], v[90:91], v[24:25], v[136:137] op_sel:[0,1,0] op_sel_hi:[1,1,1] neg_lo:[1,0,0] neg_hi:[1,0,0]
    v_pk_fma_f32 v[138:139], v[106:107], v[26:27], v[138:139] op_sel_hi:[1,0,1] neg_lo:[1,0,0] neg_hi:[1,0,0]
    v_pk_add_f32 v[34:35], v[128:129], v[130:131]
    v_pk_add_f32 v[42:43], v[128:129], v[130:131] neg_lo:[0,1] neg_hi:[0,1]
    v_pk_add_f32 v[50:51], v[136:137], v[138:139]
    v_pk_add_f32 v[58:59], v[136:137], v[138:139] neg_lo:[0,1] neg_hi:[0,1]
    v_pk_fma_f32 v[128:129], v[68:69], v[24:25], v[8:9] op_sel:[0,0,1] op_sel_hi:[1,0,1]
    v_pk_fma_f32 v[130:131], v[100:101], v[26:27], v[10:11] op_sel:[0,0,1] op_sel_hi:[1,0,1]
    v_pk_mul_f32 v[136:137], v[76:77], v[24:25] op_sel_hi:[1,0]
    v_pk_mul_f32 v[138:139], v[124:125], v[26:27] op_sel:[0,1] op_sel_hi:[1,1]
    v_pk_fma_f32 v[128:129], v[84:85], v[24:25], v[128:129] op_sel:[0,1,0] op_sel_hi:[1,1,1]
    v_pk_fma_f32 v[130:131], v[116:117], v[26:27], v[130:131] op_sel:[0,1,0] op_sel_hi:[1,1,1]
    v_pk_fma_f32 v[136:137], v[92:93], v[24:25], v[136:137] op_sel:[0,1,0] op_sel_hi:[1,1,1] neg_lo:[1,0,0] neg_hi:[1,0,0]
    v_pk_fma_f32 v[138:139], v[108:109], v[26:27], v[138:139] op_sel_hi:[1,0,1] neg_lo:[1,0,0] neg_hi:[1,0,0]
    v_pk_add_f32 v[36:37], v[128:129], v[130:131]
    v_pk_add_f32 v[44:45], v[128:129], v[130:131] neg_lo:[0,1] neg_hi:[0,1]
    v_pk_add_f32 v[52:53], v[136:137], v[138:139]
    v_pk_add_f32 v[60:61], v[136:137], v[138:139] neg_lo:[0,1] neg_hi:[0,1]
    v_pk_fma_f32 v[128:129], v[70:71], v[24:25], v[8:9] op_sel:[0,0,1] op_sel_hi:[1,0,1]
    v_pk_fma_f32 v[130:131], v[102:103], v[26:27], v[10:11] op_sel:[0,0,1] op_sel_hi:[1,0,1]
    v_pk_mul_f32 v[136:137], v[78:79], v[24:25] op_sel_hi:[1,0]
    v_pk_mul_f32 v[138:139], v[126:127], v[26:27] op_sel:[0,1] op_sel_hi:[1,1]
    v_pk_fma_f32 v[128:129], v[86:87], v[24:25], v[128:129] op_sel:[0,1,0] op_sel_hi:[1,1,1]
    v_pk_fma_f32 v[130:131], v[118:119], v[26:27], v[130:131] op_sel:[0,1,0] op_sel_hi:[1,1,1]
    v_pk_fma_f32 v[136:137], v[94:95], v[24:25], v[136:137] op_sel:[0,1,0] op_sel_hi:[1,1,1] neg_lo:[1,0,0] neg_hi:[1,0,0]
    v_pk_fma_f32 v[138:139], v[110:111], v[26:27], v[138:139] op_sel_hi:[1,0,1] neg_lo:[1,0,0] neg_hi:[1,0,0]
    v_pk_add_f32 v[38:39], v[128:129], v[130:131]
    v_pk_add_f32 v[46:47], v[128:129], v[130:131] neg_lo:[0,1] neg_hi:[0,1]
    v_pk_add_f32 v[54:55], v[136:137], v[138:139]
    v_pk_add_f32 v[62:63], v[136:137], v[138:139] neg_lo:[0,1] neg_hi:[0,1]
    v_lshlrev_b32 v8, 13, v2
    v_lshrrev_b32 v9, 1, v3
    v_lshl_add_u32 v8, v9, 9, v8
    v_and_b32 v10, 7, v9
    v_lshl_add_u32 v8, v10, 4, v8
    v_and_b32 v10, 1, v3
    v_lshl_add_u32 v8, v10, 7, v8
    v_and_b32 v9, 8, v9
    v_or_b32 v8, v8, v9
    s_lshr_b32 s3, s60, 2
    s_lshl_b32 s3, s3, 8
    s_and_b32 s27, s60, 3
    s_lshl_b32 s27, s27, 2
    s_add_u32 s3, s3, s27
    s_add_u32 s3, s3, 131072
    v_xor_b32 v8, s3, v8
    v_xor_b32 v9, 16, v8
    v_xor_b32 v10, 32, v8
    v_xor_b32 v11, 48, v8
    v_xor_b32 v12, 64, v8
    v_xor_b32 v13, 80, v8
    v_xor_b32 v14, 96, v8
    v_xor_b32 v15, 112, v8
    v_permlane32_swap_b32 v32, v40
    v_permlane32_swap_b32 v33, v41
    v_permlane32_swap_b32 v34, v42
    v_permlane32_swap_b32 v35, v43
    v_permlane32_swap_b32 v36, v44
    v_permlane32_swap_b32 v37, v45
    v_permlane32_swap_b32 v38, v46
    v_permlane32_swap_b32 v39, v47
    v_cvt_pk_bf16_f32 v64, v32, v40
    v_cvt_pk_bf16_f32 v65, v33, v41
    v_cvt_pk_bf16_f32 v66, v34, v42
    v_cvt_pk_bf16_f32 v67, v35, v43
    v_cvt_pk_bf16_f32 v68, v36, v44
    v_cvt_pk_bf16_f32 v69, v37, v45
    v_cvt_pk_bf16_f32 v70, v38, v46
    v_cvt_pk_bf16_f32 v71, v39, v47
    ds_write_b32 v8, v64 offset:0
    ds_write_b32 v9, v65 offset:0
    ds_write_b32 v10, v66 offset:0
    ds_write_b32 v11, v67 offset:0
    ds_write_b32 v12, v68 offset:0
    ds_write_b32 v13, v69 offset:0
    ds_write_b32 v14, v70 offset:0
    ds_write_b32 v15, v71 offset:0
    v_permlane32_swap_b32 v48, v56
    v_permlane32_swap_b32 v49, v57
    v_permlane32_swap_b32 v50, v58
    v_permlane32_swap_b32 v51, v59
    v_permlane32_swap_b32 v52, v60
    v_permlane32_swap_b32 v53, v61
    v_permlane32_swap_b32 v54, v62
    v_permlane32_swap_b32 v55, v63
    v_cvt_pk_bf16_f32 v72, v48, v56
    v_cvt_pk_bf16_f32 v73, v49, v57
    v_cvt_pk_bf16_f32 v74, v50, v58
    v_cvt_pk_bf16_f32 v75, v51, v59
    v_cvt_pk_bf16_f32 v76, v52, v60
    v_cvt_pk_bf16_f32 v77, v53, v61
    v_cvt_pk_bf16_f32 v78, v54, v62
    v_cvt_pk_bf16_f32 v79, v55, v63
    ds_write_b32 v8, v72 offset:16384
    ds_write_b32 v9, v73 offset:16384
    ds_write_b32 v10, v74 offset:16384
    ds_write_b32 v11, v75 offset:16384
    ds_write_b32 v12, v76 offset:16384
    ds_write_b32 v13, v77 offset:16384
    ds_write_b32 v14, v78 offset:16384
    ds_write_b32 v15, v79 offset:16384
    v_xor_b32 v28, v3, v2
    v_lshlrev_b32 v28, 4, v28
    v_lshl_add_u32 v28, v2, 9, v28
    s_lshl_b32 s3, s60, 12
    s_and_b32 s27, s60, 1
    s_lshl_b32 s27, s27, 3
    s_add_u32 s3, s3, s27
    s_add_u32 s3, s3, 131072
    v_add_u32 v28, s3, v28
    v_lshlrev_b32 v27, 4, v3
    v_lshl_add_u32 v27, v2, 14, v27
    s_lshr_b32 s3, s63, 1
    s_lshl_b32 s3, s3, 10
    s_and_b32 s27, s63, 1
    s_lshl_b32 s27, s27, 9
    s_add_u32 s3, s3, s27
    s_lshl_b32 s27, s60, 17
    s_add_u32 s3, s3, s27
    s_add_u32 s3, s3, 8454144
    v_xor_b32 v49, 8, v28
    v_xor_b32 v50, 32, v28
    v_xor_b32 v51, 40, v28
    v_xor_b32 v52, 64, v28
    v_xor_b32 v53, 72, v28
    v_xor_b32 v54, 96, v28
    v_xor_b32 v55, 104, v28
    s_waitcnt lgkmcnt(0)
    s_barrier
    ds_read_b64 v[32:33], v28 offset:0
    ds_read_b64 v[34:35], v49 offset:0
    ds_read_b64 v[36:37], v50 offset:1024
    ds_read_b64 v[38:39], v51 offset:1024
    ds_read_b64 v[40:41], v52 offset:2048
    ds_read_b64 v[42:43], v53 offset:2048
    ds_read_b64 v[44:45], v54 offset:3072
    ds_read_b64 v[46:47], v55 offset:3072
    s_waitcnt lgkmcnt(6)
    buffer_store_dwordx4 v[32:35], v27, s[40:43], s3 offen sc1
    s_add_u32 s3, s3, 32768
    s_waitcnt lgkmcnt(4)
    buffer_store_dwordx4 v[36:39], v27, s[40:43], s3 offen sc1
    s_add_u32 s3, s3, 32768
    s_waitcnt lgkmcnt(2)
    buffer_store_dwordx4 v[40:43], v27, s[40:43], s3 offen sc1
    s_add_u32 s3, s3, 32768
    s_waitcnt lgkmcnt(0)
    buffer_store_dwordx4 v[44:47], v27, s[40:43], s3 offen sc1
    s_add_u32 s3, s3, 32768
    v_pk_fma_f32 v[160:161], v[168:169], v[184:185], v[160:161] op_sel_hi:[1,0,1] neg_lo:[0,0,1] neg_hi:[0,0,1]
    v_pk_fma_f32 v[162:163], v[170:171], v[184:185], v[162:163] op_sel_hi:[1,0,1] neg_lo:[0,0,1] neg_hi:[0,0,1]
    v_pk_fma_f32 v[164:165], v[172:173], v[184:185], v[164:165] op_sel_hi:[1,0,1] neg_lo:[0,0,1] neg_hi:[0,0,1]
    v_pk_fma_f32 v[166:167], v[174:175], v[184:185], v[166:167] op_sel_hi:[1,0,1] neg_lo:[0,0,1] neg_hi:[0,0,1]
    v_cvt_pk_bf16_f32 v176, v160, v161
    v_cvt_pk_bf16_f32 v177, v162, v163
    v_cvt_pk_bf16_f32 v178, v164, v165
    v_cvt_pk_bf16_f32 v179, v166, v167
    ds_write_b128 v186, v[176:179] offset:32768
    v_pk_fma_f32 v[168:169], v[160:161], v[184:185], v[168:169] op_sel_hi:[1,0,1] neg_lo:[0,0,1] neg_hi:[0,0,1]
    v_pk_fma_f32 v[170:171], v[162:163], v[184:185], v[170:171] op_sel_hi:[1,0,1] neg_lo:[0,0,1] neg_hi:[0,0,1]
    v_pk_fma_f32 v[172:173], v[164:165], v[184:185], v[172:173] op_sel_hi:[1,0,1] neg_lo:[0,0,1] neg_hi:[0,0,1]
    v_pk_fma_f32 v[174:175], v[166:167], v[184:185], v[174:175] op_sel_hi:[1,0,1] neg_lo:[0,0,1] neg_hi:[0,0,1]
    v_cvt_pk_bf16_f32 v180, v168, v169
    v_cvt_pk_bf16_f32 v181, v170, v171
    v_cvt_pk_bf16_f32 v182, v172, v173
    v_cvt_pk_bf16_f32 v183, v174, v175
    ds_write_b128 v186, v[180:183] offset:40960
    v_pk_fma_f32 v[160:161], v[168:169], v[184:185], v[160:161] op_sel_hi:[1,0,1] neg_lo:[0,0,1] neg_hi:[0,0,1]
    v_pk_fma_f32 v[162:163], v[170:171], v[184:185], v[162:163] op_sel_hi:[1,0,1] neg_lo:[0,0,1] neg_hi:[0,0,1]
    v_pk_fma_f32 v[164:165], v[172:173], v[184:185], v[164:165] op_sel_hi:[1,0,1] neg_lo:[0,0,1] neg_hi:[0,0,1]
    v_pk_fma_f32 v[166:167], v[174:175], v[184:185], v[166:167] op_sel_hi:[1,0,1] neg_lo:[0,0,1] neg_hi:[0,0,1]
    v_cvt_pk_bf16_f32 v176, v160, v161
    v_cvt_pk_bf16_f32 v177, v162, v163
    v_cvt_pk_bf16_f32 v178, v164, v165
    v_cvt_pk_bf16_f32 v179, v166, v167
    ds_write_b128 v186, v[176:179] offset:49152
    v_pk_fma_f32 v[168:169], v[160:161], v[184:185], v[168:169] op_sel_hi:[1,0,1] neg_lo:[0,0,1] neg_hi:[0,0,1]
    v_pk_fma_f32 v[170:171], v[162:163], v[184:185], v[170:171] op_sel_hi:[1,0,1] neg_lo:[0,0,1] neg_hi:[0,0,1]
    v_pk_fma_f32 v[172:173], v[164:165], v[184:185], v[172:173] op_sel_hi:[1,0,1] neg_lo:[0,0,1] neg_hi:[0,0,1]
    v_pk_fma_f32 v[174:175], v[166:167], v[184:185], v[174:175] op_sel_hi:[1,0,1] neg_lo:[0,0,1] neg_hi:[0,0,1]
    v_cvt_pk_bf16_f32 v180, v168, v169
    v_cvt_pk_bf16_f32 v181, v170, v171
    v_cvt_pk_bf16_f32 v182, v172, v173
    v_cvt_pk_bf16_f32 v183, v174, v175
    ds_write_b128 v186, v[180:183] offset:57344
    v_pk_fma_f32 v[160:161], v[168:169], v[184:185], v[160:161] op_sel_hi:[1,0,1] neg_lo:[0,0,1] neg_hi:[0,0,1]
    v_pk_fma_f32 v[162:163], v[170:171], v[184:185], v[162:163] op_sel_hi:[1,0,1] neg_lo:[0,0,1] neg_hi:[0,0,1]
    v_pk_fma_f32 v[164:165], v[172:173], v[184:185], v[164:165] op_sel_hi:[1,0,1] neg_lo:[0,0,1] neg_hi:[0,0,1]
    v_pk_fma_f32 v[166:167], v[174:175], v[184:185], v[166:167] op_sel_hi:[1,0,1] neg_lo:[0,0,1] neg_hi:[0,0,1]
    v_cvt_pk_bf16_f32 v176, v160, v161
    v_cvt_pk_bf16_f32 v177, v162, v163
    v_cvt_pk_bf16_f32 v178, v164, v165
    v_cvt_pk_bf16_f32 v179, v166, v167
    ds_write_b128 v187, v[176:179] offset:0
    v_pk_fma_f32 v[168:169], v[160:161], v[184:185], v[168:169] op_sel_hi:[1,0,1] neg_lo:[0,0,1] neg_hi:[0,0,1]
    v_pk_fma_f32 v[170:171], v[162:163], v[184:185], v[170:171] op_sel_hi:[1,0,1] neg_lo:[0,0,1] neg_hi:[0,0,1]
    v_pk_fma_f32 v[172:173], v[164:165], v[184:185], v[172:173] op_sel_hi:[1,0,1] neg_lo:[0,0,1] neg_hi:[0,0,1]
    v_pk_fma_f32 v[174:175], v[166:167], v[184:185], v[174:175] op_sel_hi:[1,0,1] neg_lo:[0,0,1] neg_hi:[0,0,1]
    v_cvt_pk_bf16_f32 v180, v168, v169
    v_cvt_pk_bf16_f32 v181, v170, v171
    v_cvt_pk_bf16_f32 v182, v172, v173
    v_cvt_pk_bf16_f32 v183, v174, v175
    ds_write_b128 v187, v[180:183] offset:8192
    s_cmp_ge_u32 s60, 4
    s_cbranch_scc1 L_dft_helper
    v_lshlrev_b32 v22, 4, v1
    v_and_b32 v26, 1, v1
    s_cmp_ge_u32 s96, 2
    s_cselect_b32 s100, 1, 0
    s_cselect_b32 s101, 0x80008000, 0
    v_xor_b32 v26, s100, v26
    v_lshlrev_b32 v26, 15, v26
    v_or_b32 v8, 0x3f80, v26
    s_lshl_b32 s26, s98, 3
    s_lshl_b32 s27, s60, 1
    s_add_u32 s26, s26, s27
    s_lshl_b32 s3, s96, 4
    s_add_u32 s3, s3, s26
    s_lshl_b32 s15, s3, 14
    s_add_u32 s15, s15, 8454144
    s_add_u32 s14, s97, 1
    s_and_b32 s14, s14, 3
    s_lshl_b32 s3, s14, 15
    v_add_u32 v22, s3, v22
    s_add_u32 s3, s3, 32768
    s_and_b32 s3, s3, 0x1ffff
    v_lshl_add_u32 v23, v1, 4, s3
    v_xor_b32 v24, 0x10000, v22
    v_xor_b32 v25, 0x10000, v23
    s_lshl_b32 s26, s26, 5
    s_lshl_b32 s27, s96, 9
    s_add_u32 s26, s26, s27
    s_add_u32 s26, s26, 9502720
    v_lshl_add_u32 v27, v1, 1, s26
    s_add_u32 s3, s96, 1
    s_and_b32 s3, s3, 2
    s_cmp_eq_u32 s3, 0
    s_cselect_b32 s3, 16, 0
    v_cmp_gt_u32 vcc, s3, v1
    v_mov_b32 v26, 2147483392
    v_lshlrev_b32 v28, 4, v1
    v_cndmask_b32 v27, v26, v27, vcc
    v_add_u32 v29, 16384, v28
    s_or_b32 s3, s97, s96
    s_cmp_eq_u32 s3, 0
    s_cselect_b32 vcc_lo, 1, 0
    s_mov_b32 vcc_hi, 0
    v_mov_b32 v4, 0xbf803f80
    v_mov_b32 v5, 0xbf803f80
    v_mov_b32 v6, 0xbf803f80
    v_mov_b32 v7, 0xbf803f80
    v_mov_b32 v96, 0
    v_mov_b32 v97, 0
    v_mov_b32 v98, 0
    v_mov_b32 v99, 0
    v_mov_b32 v100, 0
    v_mov_b32 v101, 0
    v_mov_b32 v102, 0
    v_mov_b32 v103, 0
    s_waitcnt vmcnt(0)
    s_barrier
    v_pk_fma_f32 v[160:161], v[168:169], v[184:185], v[160:161] op_sel_hi:[1,0,1] neg_lo:[0,0,1] neg_hi:[0,0,1]
    v_pk_fma_f32 v[162:163], v[170:171], v[184:185], v[162:163] op_sel_hi:[1,0,1] neg_lo:[0,0,1] neg_hi:[0,0,1]
    v_pk_fma_f32 v[164:165], v[172:173], v[184:185], v[164:165] op_sel_hi:[1,0,1] neg_lo:[0,0,1] neg_hi:[0,0,1]
    v_pk_fma_f32 v[166:167], v[174:175], v[184:185], v[166:167] op_sel_hi:[1,0,1] neg_lo:[0,0,1] neg_hi:[0,0,1]
    v_cvt_pk_bf16_f32 v176, v160, v161
    v_cvt_pk_bf16_f32 v177, v162, v163
    v_cvt_pk_bf16_f32 v178, v164, v165
    v_cvt_pk_bf16_f32 v179, v166, v167
    ds_write_b128 v187, v[176:179] offset:16384
    v_pk_fma_f32 v[168:169], v[160:161], v[184:185], v[168:169] op_sel_hi:[1,0,1] neg_lo:[0,0,1] neg_hi:[0,0,1]
    v_pk_fma_f32 v[170:171], v[162:163], v[184:185], v[170:171] op_sel_hi:[1,0,1] neg_lo:[0,0,1] neg_hi:[0,0,1]
    v_pk_fma_f32 v[172:173], v[164:165], v[184:185], v[172:173] op_sel_hi:[1,0,1] neg_lo:[0,0,1] neg_hi:[0,0,1]
    v_pk_fma_f32 v[174:175], v[166:167], v[184:185], v[174:175] op_sel_hi:[1,0,1] neg_lo:[0,0,1] neg_hi:[0,0,1]
    v_cvt_pk_bf16_f32 v180, v168, v169
    v_cvt_pk_bf16_f32 v181, v170, v171
    v_cvt_pk_bf16_f32 v182, v172, v173
    v_cvt_pk_bf16_f32 v183, v174, v175
    ds_write_b128 v187, v[180:183] offset:24576
    v_pk_fma_f32 v[160:161], v[168:169], v[184:185], v[160:161] op_sel_hi:[1,0,1] neg_lo:[0,0,1] neg_hi:[0,0,1]
    v_pk_fma_f32 v[162:163], v[170:171], v[184:185], v[162:163] op_sel_hi:[1,0,1] neg_lo:[0,0,1] neg_hi:[0,0,1]
    v_pk_fma_f32 v[164:165], v[172:173], v[184:185], v[164:165] op_sel_hi:[1,0,1] neg_lo:[0,0,1] neg_hi:[0,0,1]
    v_pk_fma_f32 v[166:167], v[174:175], v[184:185], v[166:167] op_sel_hi:[1,0,1] neg_lo:[0,0,1] neg_hi:[0,0,1]
    v_cvt_pk_bf16_f32 v176, v160, v161
    v_cvt_pk_bf16_f32 v177, v162, v163
    v_cvt_pk_bf16_f32 v178, v164, v165
    v_cvt_pk_bf16_f32 v179, v166, v167
    ds_write_b128 v187, v[176:179] offset:32768
    v_pk_fma_f32 v[168:169], v[160:161], v[184:185], v[168:169] op_sel_hi:[1,0,1] neg_lo:[0,0,1] neg_hi:[0,0,1]
    v_pk_fma_f32 v[170:171], v[162:163], v[184:185], v[170:171] op_sel_hi:[1,0,1] neg_lo:[0,0,1] neg_hi:[0,0,1]
    v_pk_fma_f32 v[172:173], v[164:165], v[184:185], v[172:173] op_sel_hi:[1,0,1] neg_lo:[0,0,1] neg_hi:[0,0,1]
    v_pk_fma_f32 v[174:175], v[166:167], v[184:185], v[174:175] op_sel_hi:[1,0,1] neg_lo:[0,0,1] neg_hi:[0,0,1]
    v_cvt_pk_bf16_f32 v180, v168, v169
    v_cvt_pk_bf16_f32 v181, v170, v171
    v_cvt_pk_bf16_f32 v182, v172, v173
    v_cvt_pk_bf16_f32 v183, v174, v175
    ds_write_b128 v187, v[180:183] offset:40960
    v_pk_fma_f32 v[160:161], v[168:169], v[184:185], v[160:161] op_sel_hi:[1,0,1] neg_lo:[0,0,1] neg_hi:[0,0,1]
    v_pk_fma_f32 v[162:163], v[170:171], v[184:185], v[162:163] op_sel_hi:[1,0,1] neg_lo:[0,0,1] neg_hi:[0,0,1]
    v_pk_fma_f32 v[164:165], v[172:173], v[184:185], v[164:165] op_sel_hi:[1,0,1] neg_lo:[0,0,1] neg_hi:[0,0,1]
    v_pk_fma_f32 v[166:167], v[174:175], v[184:185], v[166:167] op_sel_hi:[1,0,1] neg_lo:[0,0,1] neg_hi:[0,0,1]
    v_cvt_pk_bf16_f32 v176, v160, v161
    v_cvt_pk_bf16_f32 v177, v162, v163
    v_cvt_pk_bf16_f32 v178, v164, v165
    v_cvt_pk_bf16_f32 v179, v166, v167
    ds_write_b128 v187, v[176:179] offset:49152
    v_pk_fma_f32 v[168:169], v[160:161], v[184:185], v[168:169] op_sel_hi:[1,0,1] neg_lo:[0,0,1] neg_hi:[0,0,1]
    v_pk_fma_f32 v[170:171], v[162:163], v[184:185], v[170:171] op_sel_hi:[1,0,1] neg_lo:[0,0,1] neg_hi:[0,0,1]
    v_pk_fma_f32 v[172:173], v[164:165], v[184:185], v[172:173] op_sel_hi:[1,0,1] neg_lo:[0,0,1] neg_hi:[0,0,1]
    v_pk_fma_f32 v[174:175], v[166:167], v[184:185], v[174:175] op_sel_hi:[1,0,1] neg_lo:[0,0,1] neg_hi:[0,0,1]
    v_cvt_pk_bf16_f32 v180, v168, v169
    v_cvt_pk_bf16_f32 v181, v170, v171
    v_cvt_pk_bf16_f32 v182, v172, v173
    v_cvt_pk_bf16_f32 v183, v174, v175
    ds_write_b128 v187, v[180:183] offset:57344
    s_waitcnt lgkmcnt(0)
    v_mov_b32 v9, 0
    v_mov_b32 v13, 0
    v_mov_b32 v17, 0
    v_mov_b32 v10, 0
    v_mov_b32 v14, 0
    v_mov_b32 v18, 0
    v_mov_b32 v11, 0
    v_mov_b32 v15, 0
    v_mov_b32 v19, 0
    s_barrier
    s_add_u32 s94, s14, 0
    s_and_b32 s94, s94, 3
    s_lshl_b32 s94, s94, 12
    s_add_u32 s94, s94, s15
    buffer_load_dwordx4 v[168:171], v28, s[40:43], s94 offen offset:0 sc1
    buffer_load_dwordx4 v[172:175], v29, s[40:43], s94 offen offset:0 sc1
    buffer_load_dwordx4 v[176:179], v28, s[40:43], s94 offen offset:1024 sc1
    buffer_load_dwordx4 v[180:183], v29, s[40:43], s94 offen offset:1024 sc1
    buffer_load_dwordx4 v[184:187], v28, s[40:43], s94 offen offset:2048 sc1
    buffer_load_dwordx4 v[188:191], v29, s[40:43], s94 offen offset:2048 sc1
    buffer_load_dwordx4 v[192:195], v28, s[40:43], s94 offen offset:3072 sc1
    buffer_load_dwordx4 v[196:199], v29, s[40:43], s94 offen offset:3072 sc1
    ds_read_b128 v[104:107], v22 offset:0
    ds_read_b128 v[108:111], v22 offset:1024
    ds_read_b128 v[112:115], v22 offset:2048
    ds_read_b128 v[116:119], v22 offset:3072
    ds_read_b128 v[120:123], v22 offset:4096
    ds_read_b128 v[124:127], v22 offset:5120
    ds_read_b128 v[128:131], v22 offset:6144
    ds_read_b128 v[132:135], v22 offset:7168
    s_cbranch_vccnz L_s2x
    s_barrier
    s_waitcnt vmcnt(6) lgkmcnt(0)
    v_mfma_f32_16x16x32_bf16 v[32:35], v[168:171], v[104:107], 0
    ds_read_b128 v[136:139], v22 offset:8192
    v_mfma_f32_16x16x32_bf16 v[36:39], v[168:171], v[108:111], 0
    ds_read_b128 v[140:143], v22 offset:9216
    v_mfma_f32_16x16x32_bf16 v[40:43], v[168:171], v[112:115], 0
    ds_read_b128 v[144:147], v22 offset:10240
    v_mfma_f32_16x16x32_bf16 v[44:47], v[168:171], v[116:119], 0
    ds_read_b128 v[148:151], v22 offset:11264
    v_mfma_f32_16x16x32_bf16 v[48:51], v[168:171], v[120:123], 0
    ds_read_b128 v[152:155], v22 offset:12288
    v_mfma_f32_16x16x32_bf16 v[52:55], v[168:171], v[124:127], 0
    ds_read_b128 v[156:159], v22 offset:13312
    v_mfma_f32_16x16x32_bf16 v[56:59], v[168:171], v[128:131], 0
    ds_read_b128 v[160:163], v22 offset:14336
    v_mfma_f32_16x16x32_bf16 v[60:63], v[168:171], v[132:135], 0
    ds_read_b128 v[164:167], v22 offset:15360
    v_mfma_f32_16x16x32_bf16 v[64:67], v[172:175], v[104:107], 0
    s_add_u32 s94, s14, 1
    s_and_b32 s94, s94, 3
    s_lshl_b32 s94, s94, 12
    s_add_u32 s94, s94, s15
    buffer_load_dwordx4 v[200:203], v28, s[40:43], s94 offen offset:0 sc1
    v_mfma_f32_16x16x32_bf16 v[68:71], v[172:175], v[108:111], 0
    v_mfma_f32_16x16x32_bf16 v[72:75], v[172:175], v[112:115], 0
    buffer_load_dwordx4 v[204:207], v29, s[40:43], s94 offen offset:0 sc1
    v_mfma_f32_16x16x32_bf16 v[76:79], v[172:175], v[116:119], 0
    v_mfma_f32_16x16x32_bf16 v[80:83], v[172:175], v[120:123], 0
    buffer_load_dwordx4 v[208:211], v28, s[40:43], s94 offen offset:1024 sc1
    v_mfma_f32_16x16x32_bf16 v[84:87], v[172:175], v[124:127], 0
    v_mfma_f32_16x16x32_bf16 v[88:91], v[172:175], v[128:131], 0
    buffer_load_dwordx4 v[212:215], v29, s[40:43], s94 offen offset:1024 sc1
    v_mfma_f32_16x16x32_bf16 v[92:95], v[172:175], v[132:135], 0
    s_waitcnt vmcnt(8) lgkmcnt(0)
    v_mfma_f32_16x16x32_bf16 v[32:35], v[176:179], v[136:139], v[32:35]
    ds_read_b128 v[104:107], v22 offset:16384
    v_mfma_f32_16x16x32_bf16 v[36:39], v[176:179], v[140:143], v[36:39]
    ds_read_b128 v[108:111], v22 offset:17408
    v_mfma_f32_16x16x32_bf16 v[40:43], v[176:179], v[144:147], v[40:43]
    ds_read_b128 v[112:115], v22 offset:18432
    v_mfma_f32_16x16x32_bf16 v[44:47], v[176:179], v[148:151], v[44:47]
    ds_read_b128 v[116:119], v22 offset:19456
    v_mfma_f32_16x16x32_bf16 v[48:51], v[176:179], v[152:155], v[48:51]
    ds_read_b128 v[120:123], v22 offset:20480
    v_mfma_f32_16x16x32_bf16 v[52:55], v[176:179], v[156:159], v[52:55]
    ds_read_b128 v[124:127], v22 offset:21504
    v_mfma_f32_16x16x32_bf16 v[56:59], v[176:179], v[160:163], v[56:59]
    ds_read_b128 v[128:131], v22 offset:22528
    v_mfma_f32_16x16x32_bf16 v[60:63], v[176:179], v[164:167], v[60:63]
    ds_read_b128 v[132:135], v22 offset:23552
    v_mfma_f32_16x16x32_bf16 v[64:67], v[180:183], v[136:139], v[64:67]
    buffer_load_dwordx4 v[216:219], v28, s[40:43], s94 offen offset:2048 sc1
    v_mfma_f32_16x16x32_bf16 v[68:71], v[180:183], v[140:143], v[68:71]
    v_mfma_f32_16x16x32_bf16 v[72:75], v[180:183], v[144:147], v[72:75]
    buffer_load_dwordx4 v[220:223], v29, s[40:43], s94 offen offset:2048 sc1
    v_mfma_f32_16x16x32_bf16 v[76:79], v[180:183], v[148:151], v[76:79]
    v_mfma_f32_16x16x32_bf16 v[80:83], v[180:183], v[152:155], v[80:83]
    buffer_load_dwordx4 v[224:227], v28, s[40:43], s94 offen offset:3072 sc1
    v_mfma_f32_16x16x32_bf16 v[84:87], v[180:183], v[156:159], v[84:87]
    v_mfma_f32_16x16x32_bf16 v[88:91], v[180:183], v[160:163], v[88:91]
    buffer_load_dwordx4 v[228:231], v29, s[40:43], s94 offen offset:3072 sc1
    v_mfma_f32_16x16x32_bf16 v[92:95], v[180:183], v[164:167], v[92:95]
    s_barrier
    s_waitcnt vmcnt(10) lgkmcnt(0)
    v_mfma_f32_16x16x32_bf16 v[32:35], v[184:187], v[104:107], v[32:35]
    ds_read_b128 v[136:139], v22 offset:24576
    v_mfma_f32_16x16x32_bf16 v[36:39], v[184:187], v[108:111], v[36:39]
    ds_read_b128 v[140:143], v22 offset:25600
    v_mfma_f32_16x16x32_bf16 v[40:43], v[184:187], v[112:115], v[40:43]
    ds_read_b128 v[144:147], v22 offset:26624
    v_mfma_f32_16x16x32_bf16 v[44:47], v[184:187], v[116:119], v[44:47]
    ds_read_b128 v[148:151], v22 offset:27648
    v_mfma_f32_16x16x32_bf16 v[48:51], v[184:187], v[120:123], v[48:51]
    ds_read_b128 v[152:155], v22 offset:28672
    v_mfma_f32_16x16x32_bf16 v[52:55], v[184:187], v[124:127], v[52:55]
    ds_read_b128 v[156:159], v22 offset:29696
    v_mfma_f32_16x16x32_bf16 v[56:59], v[184:187], v[128:131], v[56:59]
    ds_read_b128 v[160:163], v22 offset:30720
    v_mfma_f32_16x16x32_bf16 v[60:63], v[184:187], v[132:135], v[60:63]
    ds_read_b128 v[164:167], v22 offset:31744
    v_mfma_f32_16x16x32_bf16 v[64:67], v[188:191], v[104:107], v[64:67]
    s_add_u32 s94, s14, 2
    s_and_b32 s94, s94, 3
    s_lshl_b32 s94, s94, 12
    s_add_u32 s94, s94, s15
    buffer_load_dwordx4 v[232:235], v28, s[40:43], s94 offen offset:0 sc1
    v_mfma_f32_16x16x32_bf16 v[68:71], v[188:191], v[108:111], v[68:71]
    v_mfma_f32_16x16x32_bf16 v[72:75], v[188:191], v[112:115], v[72:75]
    buffer_load_dwordx4 v[236:239], v29, s[40:43], s94 offen offset:0 sc1
    v_mfma_f32_16x16x32_bf16 v[76:79], v[188:191], v[116:119], v[76:79]
    v_mfma_f32_16x16x32_bf16 v[80:83], v[188:191], v[120:123], v[80:83]
    v_mfma_f32_16x16x32_bf16 v[84:87], v[188:191], v[124:127], v[84:87]
    v_mfma_f32_16x16x32_bf16 v[88:91], v[188:191], v[128:131], v[88:91]
    v_mfma_f32_16x16x32_bf16 v[92:95], v[188:191], v[132:135], v[92:95]
    s_waitcnt vmcnt(10) lgkmcnt(0)
    v_mfma_f32_16x16x32_bf16 v[32:35], v[192:195], v[136:139], v[32:35]
    ds_read_b128 v[104:107], v23 offset:0
    v_mfma_f32_16x16x32_bf16 v[36:39], v[192:195], v[140:143], v[36:39]
    ds_read_b128 v[108:111], v23 offset:1024
    v_mfma_f32_16x16x32_bf16 v[40:43], v[192:195], v[144:147], v[40:43]
    ds_read_b128 v[112:115], v23 offset:2048
    v_mfma_f32_16x16x32_bf16 v[44:47], v[192:195], v[148:151], v[44:47]
    ds_read_b128 v[116:119], v23 offset:3072
    v_mfma_f32_16x16x32_bf16 v[48:51], v[192:195], v[152:155], v[48:51]
    ds_read_b128 v[120:123], v23 offset:4096
    v_mfma_f32_16x16x32_bf16 v[52:55], v[192:195], v[156:159], v[52:55]
    ds_read_b128 v[124:127], v23 offset:5120
    v_mfma_f32_16x16x32_bf16 v[56:59], v[192:195], v[160:163], v[56:59]
    ds_read_b128 v[128:131], v23 offset:6144
    v_mfma_f32_16x16x32_bf16 v[60:63], v[192:195], v[164:167], v[60:63]
    ds_read_b128 v[132:135], v23 offset:7168
    v_mfma_f32_16x16x32_bf16 v[64:67], v[196:199], v[136:139], v[64:67]
    buffer_load_dwordx4 v[240:243], v28, s[40:43], s94 offen offset:1024 sc1
    v_mfma_f32_16x16x32_bf16 v[68:71], v[196:199], v[140:143], v[68:71]
    v_mfma_f32_16x16x32_bf16 v[72:75], v[196:199], v[144:147], v[72:75]
    buffer_load_dwordx4 v[244:247], v29, s[40:43], s94 offen offset:1024 sc1
    v_mfma_f32_16x16x32_bf16 v[76:79], v[196:199], v[148:151], v[76:79]
    v_mfma_f32_16x16x32_bf16 v[80:83], v[196:199], v[152:155], v[80:83]
    v_mfma_f32_16x16x32_bf16 v[84:87], v[196:199], v[156:159], v[84:87]
    v_mfma_f32_16x16x32_bf16 v[88:91], v[196:199], v[160:163], v[88:91]
    v_mfma_f32_16x16x32_bf16 v[92:95], v[196:199], v[164:167], v[92:95]
    s_waitcnt vmcnt(10) lgkmcnt(0)
    v_mfma_f32_16x16x32_bf16 v[32:35], v[200:203], v[104:107], v[32:35]
    ds_read_b128 v[136:139], v23 offset:8192
    v_mfma_f32_16x16x32_bf16 v[36:39], v[200:203], v[108:111], v[36:39]
    ds_read_b128 v[140:143], v23 offset:9216
    v_mfma_f32_16x16x32_bf16 v[40:43], v[200:203], v[112:115], v[40:43]
    ds_read_b128 v[144:147], v23 offset:10240
    v_mfma_f32_16x16x32_bf16 v[44:47], v[200:203], v[116:119], v[44:47]
    ds_read_b128 v[148:151], v23 offset:11264
    v_mfma_f32_16x16x32_bf16 v[48:51], v[200:203], v[120:123], v[48:51]
    ds_read_b128 v[152:155], v23 offset:12288
    v_mfma_f32_16x16x32_bf16 v[52:55], v[200:203], v[124:127], v[52:55]
    ds_read_b128 v[156:159], v23 offset:13312
    v_mfma_f32_16x16x32_bf16 v[56:59], v[200:203], v[128:131], v[56:59]
    ds_read_b128 v[160:163], v23 offset:14336
    v_mfma_f32_16x16x32_bf16 v[60:63], v[200:203], v[132:135], v[60:63]
    ds_read_b128 v[164:167], v23 offset:15360
    v_mfma_f32_16x16x32_bf16 v[64:67], v[204:207], v[104:107], v[64:67]
    buffer_load_dwordx4 v[248:251], v28, s[40:43], s94 offen offset:2048 sc1
    v_mfma_f32_16x16x32_bf16 v[68:71], v[204:207], v[108:111], v[68:71]
    v_mfma_f32_16x16x32_bf16 v[72:75], v[204:207], v[112:115], v[72:75]
    buffer_load_dwordx4 v[252:255], v29, s[40:43], s94 offen offset:2048 sc1
    v_mfma_f32_16x16x32_bf16 v[76:79], v[204:207], v[116:119], v[76:79]
    v_mfma_f32_16x16x32_bf16 v[80:83], v[204:207], v[120:123], v[80:83]
    v_mfma_f32_16x16x32_bf16 v[84:87], v[204:207], v[124:127], v[84:87]
    v_mfma_f32_16x16x32_bf16 v[88:91], v[204:207], v[128:131], v[88:91]
    v_mfma_f32_16x16x32_bf16 v[92:95], v[204:207], v[132:135], v[92:95]
    s_waitcnt vmcnt(10) lgkmcnt(0)
    v_mfma_f32_16x16x32_bf16 v[32:35], v[208:211], v[136:139], v[32:35]
    ds_read_b128 v[104:107], v23 offset:16384
    v_mfma_f32_16x16x32_bf16 v[36:39], v[208:211], v[140:143], v[36:39]
    ds_read_b128 v[108:111], v23 offset:17408
    v_mfma_f32_16x16x32_bf16 v[40:43], v[208:211], v[144:147], v[40:43]
    ds_read_b128 v[112:115], v23 offset:18432
    v_mfma_f32_16x16x32_bf16 v[44:47], v[208:211], v[148:151], v[44:47]
    ds_read_b128 v[116:119], v23 offset:19456
    v_mfma_f32_16x16x32_bf16 v[48:51], v[208:211], v[152:155], v[48:51]
    ds_read_b128 v[120:123], v23 offset:20480
    v_mfma_f32_16x16x32_bf16 v[52:55], v[208:211], v[156:159], v[52:55]
    ds_read_b128 v[124:127], v23 offset:21504
    v_mfma_f32_16x16x32_bf16 v[56:59], v[208:211], v[160:163], v[56:59]
    ds_read_b128 v[128:131], v23 offset:22528
    v_mfma_f32_16x16x32_bf16 v[60:63], v[208:211], v[164:167], v[60:63]
    ds_read_b128 v[132:135], v23 offset:23552
    v_mfma_f32_16x16x32_bf16 v[64:67], v[212:215], v[136:139], v[64:67]
    buffer_load_dwordx4 v[168:171], v28, s[40:43], s94 offen offset:3072 sc1
    v_mfma_f32_16x16x32_bf16 v[68:71], v[212:215], v[140:143], v[68:71]
    v_mfma_f32_16x16x32_bf16 v[72:75], v[212:215], v[144:147], v[72:75]
    buffer_load_dwordx4 v[172:175], v29, s[40:43], s94 offen offset:3072 sc1
    v_mfma_f32_16x16x32_bf16 v[76:79], v[212:215], v[148:151], v[76:79]
    v_mfma_f32_16x16x32_bf16 v[80:83], v[212:215], v[152:155], v[80:83]
    v_mfma_f32_16x16x32_bf16 v[84:87], v[212:215], v[156:159], v[84:87]
    v_mfma_f32_16x16x32_bf16 v[88:91], v[212:215], v[160:163], v[88:91]
    v_mfma_f32_16x16x32_bf16 v[92:95], v[212:215], v[164:167], v[92:95]
    s_barrier
    s_waitcnt vmcnt(10) lgkmcnt(0)
    v_mfma_f32_16x16x32_bf16 v[32:35], v[216:219], v[104:107], v[32:35]
    ds_read_b128 v[136:139], v23 offset:24576
    v_mfma_f32_16x16x32_bf16 v[36:39], v[216:219], v[108:111], v[36:39]
    ds_read_b128 v[140:143], v23 offset:25600
    v_mfma_f32_16x16x32_bf16 v[40:43], v[216:219], v[112:115], v[40:43]
    ds_read_b128 v[144:147], v23 offset:26624
    v_mfma_f32_16x16x32_bf16 v[44:47], v[216:219], v[116:119], v[44:47]
    ds_read_b128 v[148:151], v23 offset:27648
    v_mfma_f32_16x16x32_bf16 v[48:51], v[216:219], v[120:123], v[48:51]
    ds_read_b128 v[152:155], v23 offset:28672
    v_mfma_f32_16x16x32_bf16 v[52:55], v[216:219], v[124:127], v[52:55]
    ds_read_b128 v[156:159], v23 offset:29696
    v_mfma_f32_16x16x32_bf16 v[56:59], v[216:219], v[128:131], v[56:59]
    ds_read_b128 v[160:163], v23 offset:30720
    v_mfma_f32_16x16x32_bf16 v[60:63], v[216:219], v[132:135], v[60:63]
    ds_read_b128 v[164:167], v23 offset:31744
    v_mfma_f32_16x16x32_bf16 v[64:67], v[220:223], v[104:107], v[64:67]
    s_add_u32 s94, s14, 3
    s_and_b32 s94, s94, 3
    s_lshl_b32 s94, s94, 12
    s_add_u32 s94, s94, s15
    buffer_load_dwordx4 v[176:179], v28, s[40:43], s94 offen offset:0 sc1
    v_mfma_f32_16x16x32_bf16 v[68:71], v[220:223], v[108:111], v[68:71]
    v_mfma_f32_16x16x32_bf16 v[72:75], v[220:223], v[112:115], v[72:75]
    buffer_load_dwordx4 v[180:183], v29, s[40:43], s94 offen offset:0 sc1
    v_mfma_f32_16x16x32_bf16 v[76:79], v[220:223], v[116:119], v[76:79]
    v_mfma_f32_16x16x32_bf16 v[80:83], v[220:223], v[120:123], v[80:83]
    v_mfma_f32_16x16x32_bf16 v[84:87], v[220:223], v[124:127], v[84:87]
    v_mfma_f32_16x16x32_bf16 v[88:91], v[220:223], v[128:131], v[88:91]
    v_mfma_f32_16x16x32_bf16 v[92:95], v[220:223], v[132:135], v[92:95]
    s_waitcnt vmcnt(10) lgkmcnt(0)
    v_mfma_f32_16x16x32_bf16 v[32:35], v[224:227], v[136:139], v[32:35]
    ds_read_b128 v[104:107], v24 offset:0
    v_mfma_f32_16x16x32_bf16 v[36:39], v[224:227], v[140:143], v[36:39]
    ds_read_b128 v[108:111], v24 offset:1024
    v_mfma_f32_16x16x32_bf16 v[40:43], v[224:227], v[144:147], v[40:43]
    ds_read_b128 v[112:115], v24 offset:2048
    v_mfma_f32_16x16x32_bf16 v[44:47], v[224:227], v[148:151], v[44:47]
    ds_read_b128 v[116:119], v24 offset:3072
    v_mfma_f32_16x16x32_bf16 v[48:51], v[224:227], v[152:155], v[48:51]
    ds_read_b128 v[120:123], v24 offset:4096
    v_mfma_f32_16x16x32_bf16 v[52:55], v[224:227], v[156:159], v[52:55]
    ds_read_b128 v[124:127], v24 offset:5120
    v_mfma_f32_16x16x32_bf16 v[56:59], v[224:227], v[160:163], v[56:59]
    ds_read_b128 v[128:131], v24 offset:6144
    v_mfma_f32_16x16x32_bf16 v[60:63], v[224:227], v[164:167], v[60:63]
    ds_read_b128 v[132:135], v24 offset:7168
    v_mfma_f32_16x16x32_bf16 v[64:67], v[228:231], v[136:139], v[64:67]
    buffer_load_dwordx4 v[184:187], v28, s[40:43], s94 offen offset:1024 sc1
    v_mfma_f32_16x16x32_bf16 v[68:71], v[228:231], v[140:143], v[68:71]
    v_mfma_f32_16x16x32_bf16 v[72:75], v[228:231], v[144:147], v[72:75]
    buffer_load_dwordx4 v[188:191], v29, s[40:43], s94 offen offset:1024 sc1
    v_mfma_f32_16x16x32_bf16 v[76:79], v[228:231], v[148:151], v[76:79]
    v_mfma_f32_16x16x32_bf16 v[80:83], v[228:231], v[152:155], v[80:83]
    v_mfma_f32_16x16x32_bf16 v[84:87], v[228:231], v[156:159], v[84:87]
    v_mfma_f32_16x16x32_bf16 v[88:91], v[228:231], v[160:163], v[88:91]
    v_mfma_f32_16x16x32_bf16 v[92:95], v[228:231], v[164:167], v[92:95]
    s_waitcnt vmcnt(10) lgkmcnt(0)
    v_mfma_f32_16x16x32_bf16 v[32:35], v[232:235], v[104:107], v[32:35]
    ds_read_b128 v[136:139], v24 offset:8192
    v_mfma_f32_16x16x32_bf16 v[36:39], v[232:235], v[108:111], v[36:39]
    ds_read_b128 v[140:143], v24 offset:9216
    v_mfma_f32_16x16x32_bf16 v[40:43], v[232:235], v[112:115], v[40:43]
    ds_read_b128 v[144:147], v24 offset:10240
    v_mfma_f32_16x16x32_bf16 v[44:47], v[232:235], v[116:119], v[44:47]
    ds_read_b128 v[148:151], v24 offset:11264
    v_mfma_f32_16x16x32_bf16 v[48:51], v[232:235], v[120:123], v[48:51]
    ds_read_b128 v[152:155], v24 offset:12288
    v_mfma_f32_16x16x32_bf16 v[52:55], v[232:235], v[124:127], v[52:55]
    ds_read_b128 v[156:159], v24 offset:13312
    v_mfma_f32_16x16x32_bf16 v[56:59], v[232:235], v[128:131], v[56:59]
    ds_read_b128 v[160:163], v24 offset:14336
    v_mfma_f32_16x16x32_bf16 v[60:63], v[232:235], v[132:135], v[60:63]
    ds_read_b128 v[164:167], v24 offset:15360
    v_mfma_f32_16x16x32_bf16 v[64:67], v[236:239], v[104:107], v[64:67]
    buffer_load_dwordx4 v[192:195], v28, s[40:43], s94 offen offset:2048 sc1
    v_mfma_f32_16x16x32_bf16 v[68:71], v[236:239], v[108:111], v[68:71]
    v_mfma_f32_16x16x32_bf16 v[72:75], v[236:239], v[112:115], v[72:75]
    buffer_load_dwordx4 v[196:199], v29, s[40:43], s94 offen offset:2048 sc1
    v_mfma_f32_16x16x32_bf16 v[76:79], v[236:239], v[116:119], v[76:79]
    v_mfma_f32_16x16x32_bf16 v[80:83], v[236:239], v[120:123], v[80:83]
    v_mfma_f32_16x16x32_bf16 v[84:87], v[236:239], v[124:127], v[84:87]
    v_mfma_f32_16x16x32_bf16 v[88:91], v[236:239], v[128:131], v[88:91]
    v_mfma_f32_16x16x32_bf16 v[92:95], v[236:239], v[132:135], v[92:95]
    s_waitcnt vmcnt(10) lgkmcnt(0)
    v_mfma_f32_16x16x32_bf16 v[32:35], v[240:243], v[136:139], v[32:35]
    ds_read_b128 v[104:107], v24 offset:16384
    v_mfma_f32_16x16x32_bf16 v[36:39], v[240:243], v[140:143], v[36:39]
    ds_read_b128 v[108:111], v24 offset:17408
    v_mfma_f32_16x16x32_bf16 v[40:43], v[240:243], v[144:147], v[40:43]
    ds_read_b128 v[112:115], v24 offset:18432
    v_mfma_f32_16x16x32_bf16 v[44:47], v[240:243], v[148:151], v[44:47]
    ds_read_b128 v[116:119], v24 offset:19456
    v_mfma_f32_16x16x32_bf16 v[48:51], v[240:243], v[152:155], v[48:51]
    ds_read_b128 v[120:123], v24 offset:20480
    v_mfma_f32_16x16x32_bf16 v[52:55], v[240:243], v[156:159], v[52:55]
    ds_read_b128 v[124:127], v24 offset:21504
    v_mfma_f32_16x16x32_bf16 v[56:59], v[240:243], v[160:163], v[56:59]
    ds_read_b128 v[128:131], v24 offset:22528
    v_mfma_f32_16x16x32_bf16 v[60:63], v[240:243], v[164:167], v[60:63]
    ds_read_b128 v[132:135], v24 offset:23552
    v_mfma_f32_16x16x32_bf16 v[64:67], v[244:247], v[136:139], v[64:67]
    buffer_load_dwordx4 v[200:203], v28, s[40:43], s94 offen offset:3072 sc1
    v_mfma_f32_16x16x32_bf16 v[68:71], v[244:247], v[140:143], v[68:71]
    v_mfma_f32_16x16x32_bf16 v[72:75], v[244:247], v[144:147], v[72:75]
    buffer_load_dwordx4 v[204:207], v29, s[40:43], s94 offen offset:3072 sc1
    v_mfma_f32_16x16x32_bf16 v[76:79], v[244:247], v[148:151], v[76:79]
    v_mfma_f32_16x16x32_bf16 v[80:83], v[244:247], v[152:155], v[80:83]
    v_mfma_f32_16x16x32_bf16 v[84:87], v[244:247], v[156:159], v[84:87]
    v_mfma_f32_16x16x32_bf16 v[88:91], v[244:247], v[160:163], v[88:91]
    v_mfma_f32_16x16x32_bf16 v[92:95], v[244:247], v[164:167], v[92:95]
    s_waitcnt vmcnt(10) lgkmcnt(0)
    v_mfma_f32_16x16x32_bf16 v[32:35], v[248:251], v[104:107], v[32:35]
    ds_read_b128 v[136:139], v24 offset:24576
    v_mfma_f32_16x16x32_bf16 v[36:39], v[248:251], v[108:111], v[36:39]
    ds_read_b128 v[140:143], v24 offset:25600
    v_mfma_f32_16x16x32_bf16 v[40:43], v[248:251], v[112:115], v[40:43]
    ds_read_b128 v[144:147], v24 offset:26624
    v_mfma_f32_16x16x32_bf16 v[44:47], v[248:251], v[116:119], v[44:47]
    ds_read_b128 v[148:151], v24 offset:27648
    v_mfma_f32_16x16x32_bf16 v[48:51], v[248:251], v[120:123], v[48:51]
    ds_read_b128 v[152:155], v24 offset:28672
    v_mfma_f32_16x16x32_bf16 v[52:55], v[248:251], v[124:127], v[52:55]
    ds_read_b128 v[156:159], v24 offset:29696
    v_mfma_f32_16x16x32_bf16 v[56:59], v[248:251], v[128:131], v[56:59]
    ds_read_b128 v[160:163], v24 offset:30720
    v_mfma_f32_16x16x32_bf16 v[60:63], v[248:251], v[132:135], v[60:63]
    ds_read_b128 v[164:167], v24 offset:31744
    v_mfma_f32_16x16x32_bf16 v[64:67], v[252:255], v[104:107], v[64:67]
    v_mfma_f32_16x16x32_bf16 v[68:71], v[252:255], v[108:111], v[68:71]
    v_mfma_f32_16x16x32_bf16 v[72:75], v[252:255], v[112:115], v[72:75]
    v_mfma_f32_16x16x32_bf16 v[76:79], v[252:255], v[116:119], v[76:79]
    v_mfma_f32_16x16x32_bf16 v[80:83], v[252:255], v[120:123], v[80:83]
    v_mfma_f32_16x16x32_bf16 v[84:87], v[252:255], v[124:127], v[84:87]
    v_mfma_f32_16x16x32_bf16 v[88:91], v[252:255], v[128:131], v[88:91]
    v_mfma_f32_16x16x32_bf16 v[92:95], v[252:255], v[132:135], v[92:95]
    s_waitcnt vmcnt(8) lgkmcnt(0)
    v_mfma_f32_16x16x32_bf16 v[32:35], v[168:171], v[136:139], v[32:35]
    ds_read_b128 v[104:107], v25 offset:0
    v_mfma_f32_16x16x32_bf16 v[36:39], v[168:171], v[140:143], v[36:39]
    ds_read_b128 v[108:111], v25 offset:1024
    v_mfma_f32_16x16x32_bf16 v[40:43], v[168:171], v[144:147], v[40:43]
    ds_read_b128 v[112:115], v25 offset:2048
    v_mfma_f32_16x16x32_bf16 v[44:47], v[168:171], v[148:151], v[44:47]
    ds_read_b128 v[116:119], v25 offset:3072
    v_mfma_f32_16x16x32_bf16 v[48:51], v[168:171], v[152:155], v[48:51]
    ds_read_b128 v[120:123], v25 offset:4096
    v_mfma_f32_16x16x32_bf16 v[52:55], v[168:171], v[156:159], v[52:55]
    ds_read_b128 v[124:127], v25 offset:5120
    v_mfma_f32_16x16x32_bf16 v[56:59], v[168:171], v[160:163], v[56:59]
    ds_read_b128 v[128:131], v25 offset:6144
    v_mfma_f32_16x16x32_bf16 v[60:63], v[168:171], v[164:167], v[60:63]
    ds_read_b128 v[132:135], v25 offset:7168
    v_mfma_f32_16x16x32_bf16 v[64:67], v[172:175], v[136:139], v[64:67]
    v_mfma_f32_16x16x32_bf16 v[68:71], v[172:175], v[140:143], v[68:71]
    v_mfma_f32_16x16x32_bf16 v[72:75], v[172:175], v[144:147], v[72:75]
    v_mfma_f32_16x16x32_bf16 v[76:79], v[172:175], v[148:151], v[76:79]
    v_mfma_f32_16x16x32_bf16 v[80:83], v[172:175], v[152:155], v[80:83]
    v_mfma_f32_16x16x32_bf16 v[84:87], v[172:175], v[156:159], v[84:87]
    v_mfma_f32_16x16x32_bf16 v[88:91], v[172:175], v[160:163], v[88:91]
    v_mfma_f32_16x16x32_bf16 v[92:95], v[172:175], v[164:167], v[92:95]
    s_waitcnt vmcnt(6) lgkmcnt(0)
    v_mfma_f32_16x16x32_bf16 v[32:35], v[176:179], v[104:107], v[32:35]
    ds_read_b128 v[136:139], v25 offset:8192
    v_mfma_f32_16x16x32_bf16 v[36:39], v[176:179], v[108:111], v[36:39]
    ds_read_b128 v[140:143], v25 offset:9216
    v_mfma_f32_16x16x32_bf16 v[40:43], v[176:179], v[112:115], v[40:43]
    ds_read_b128 v[144:147], v25 offset:10240
    v_mfma_f32_16x16x32_bf16 v[44:47], v[176:179], v[116:119], v[44:47]
    ds_read_b128 v[148:151], v25 offset:11264
    v_mfma_f32_16x16x32_bf16 v[48:51], v[176:179], v[120:123], v[48:51]
    ds_read_b128 v[152:155], v25 offset:12288
    v_mfma_f32_16x16x32_bf16 v[52:55], v[176:179], v[124:127], v[52:55]
    ds_read_b128 v[156:159], v25 offset:13312
    v_mfma_f32_16x16x32_bf16 v[56:59], v[176:179], v[128:131], v[56:59]
    ds_read_b128 v[160:163], v25 offset:14336
    v_mfma_f32_16x16x32_bf16 v[60:63], v[176:179], v[132:135], v[60:63]
    ds_read_b128 v[164:167], v25 offset:15360
    v_mfma_f32_16x16x32_bf16 v[64:67], v[180:183], v[104:107], v[64:67]
    v_mfma_f32_16x16x32_bf16 v[68:71], v[180:183], v[108:111], v[68:71]
    v_mfma_f32_16x16x32_bf16 v[72:75], v[180:183], v[112:115], v[72:75]
    v_mfma_f32_16x16x32_bf16 v[76:79], v[180:183], v[116:119], v[76:79]
    v_mfma_f32_16x16x32_bf16 v[80:83], v[180:183], v[120:123], v[80:83]
    v_mfma_f32_16x16x32_bf16 v[84:87], v[180:183], v[124:127], v[84:87]
    v_mfma_f32_16x16x32_bf16 v[88:91], v[180:183], v[128:131], v[88:91]
    v_mfma_f32_16x16x32_bf16 v[92:95], v[180:183], v[132:135], v[92:95]
    s_waitcnt vmcnt(4) lgkmcnt(0)
    v_mfma_f32_16x16x32_bf16 v[32:35], v[184:187], v[136:139], v[32:35]
    ds_read_b128 v[104:107], v25 offset:16384
    v_mfma_f32_16x16x32_bf16 v[36:39], v[184:187], v[140:143], v[36:39]
    ds_read_b128 v[108:111], v25 offset:17408
    v_mfma_f32_16x16x32_bf16 v[40:43], v[184:187], v[144:147], v[40:43]
    ds_read_b128 v[112:115], v25 offset:18432
    v_mfma_f32_16x16x32_bf16 v[44:47], v[184:187], v[148:151], v[44:47]
    ds_read_b128 v[116:119], v25 offset:19456
    v_mfma_f32_16x16x32_bf16 v[48:51], v[184:187], v[152:155], v[48:51]
    ds_read_b128 v[120:123], v25 offset:20480
    v_mfma_f32_16x16x32_bf16 v[52:55], v[184:187], v[156:159], v[52:55]
    ds_read_b128 v[124:127], v25 offset:21504
    v_mfma_f32_16x16x32_bf16 v[56:59], v[184:187], v[160:163], v[56:59]
    ds_read_b128 v[128:131], v25 offset:22528
    v_mfma_f32_16x16x32_bf16 v[60:63], v[184:187], v[164:167], v[60:63]
    ds_read_b128 v[132:135], v25 offset:23552
    v_mfma_f32_16x16x32_bf16 v[64:67], v[188:191], v[136:139], v[64:67]
    v_mfma_f32_16x16x32_bf16 v[68:71], v[188:191], v[140:143], v[68:71]
    v_mfma_f32_16x16x32_bf16 v[72:75], v[188:191], v[144:147], v[72:75]
    v_mfma_f32_16x16x32_bf16 v[76:79], v[188:191], v[148:151], v[76:79]
    v_mfma_f32_16x16x32_bf16 v[80:83], v[188:191], v[152:155], v[80:83]
    v_mfma_f32_16x16x32_bf16 v[84:87], v[188:191], v[156:159], v[84:87]
    buffer_load_ushort v12, v27, s[40:43], 0 offen sc1
    v_mfma_f32_16x16x32_bf16 v[88:91], v[188:191], v[160:163], v[88:91]
    v_mfma_f32_16x16x32_bf16 v[92:95], v[188:191], v[164:167], v[92:95]
    buffer_load_ushort v16, v27, s[40:43], 0 offen offset:32 sc1
    s_waitcnt vmcnt(4) lgkmcnt(0)
    v_mfma_f32_16x16x32_bf16 v[32:35], v[192:195], v[104:107], v[32:35]
    ds_read_b128 v[136:139], v25 offset:24576
    v_mfma_f32_16x16x32_bf16 v[36:39], v[192:195], v[108:111], v[36:39]
    ds_read_b128 v[140:143], v25 offset:25600
    v_mfma_f32_16x16x32_bf16 v[40:43], v[192:195], v[112:115], v[40:43]
    ds_read_b128 v[144:147], v25 offset:26624
    v_mfma_f32_16x16x32_bf16 v[44:47], v[192:195], v[116:119], v[44:47]
    ds_read_b128 v[148:151], v25 offset:27648
    v_mfma_f32_16x16x32_bf16 v[48:51], v[192:195], v[120:123], v[48:51]
    ds_read_b128 v[152:155], v25 offset:28672
    v_mfma_f32_16x16x32_bf16 v[52:55], v[192:195], v[124:127], v[52:55]
    ds_read_b128 v[156:159], v25 offset:29696
    v_mfma_f32_16x16x32_bf16 v[56:59], v[192:195], v[128:131], v[56:59]
    ds_read_b128 v[160:163], v25 offset:30720
    v_mfma_f32_16x16x32_bf16 v[60:63], v[192:195], v[132:135], v[60:63]
    ds_read_b128 v[164:167], v25 offset:31744
    v_mfma_f32_16x16x32_bf16 v[64:67], v[196:199], v[104:107], v[64:67]
    v_mfma_f32_16x16x32_bf16 v[68:71], v[196:199], v[108:111], v[68:71]
    v_mfma_f32_16x16x32_bf16 v[72:75], v[196:199], v[112:115], v[72:75]
    v_mfma_f32_16x16x32_bf16 v[76:79], v[196:199], v[116:119], v[76:79]
    v_mfma_f32_16x16x32_bf16 v[80:83], v[196:199], v[120:123], v[80:83]
    v_mfma_f32_16x16x32_bf16 v[84:87], v[196:199], v[124:127], v[84:87]
    v_mfma_f32_16x16x32_bf16 v[88:91], v[196:199], v[128:131], v[88:91]
    v_mfma_f32_16x16x32_bf16 v[92:95], v[196:199], v[132:135], v[92:95]
    s_waitcnt vmcnt(2) lgkmcnt(0)
    v_mfma_f32_16x16x32_bf16 v[32:35], v[200:203], v[136:139], v[32:35]
    v_mfma_f32_16x16x32_bf16 v[36:39], v[200:203], v[140:143], v[36:39]
    v_mfma_f32_16x16x32_bf16 v[40:43], v[200:203], v[144:147], v[40:43]
    v_mfma_f32_16x16x32_bf16 v[44:47], v[200:203], v[148:151], v[44:47]
    v_mfma_f32_16x16x32_bf16 v[48:51], v[200:203], v[152:155], v[48:51]
    v_mfma_f32_16x16x32_bf16 v[52:55], v[200:203], v[156:159], v[52:55]
    v_mfma_f32_16x16x32_bf16 v[56:59], v[200:203], v[160:163], v[56:59]
    v_mfma_f32_16x16x32_bf16 v[60:63], v[200:203], v[164:167], v[60:63]
    v_mfma_f32_16x16x32_bf16 v[64:67], v[204:207], v[136:139], v[64:67]
    v_mfma_f32_16x16x32_bf16 v[68:71], v[204:207], v[140:143], v[68:71]
    v_mfma_f32_16x16x32_bf16 v[72:75], v[204:207], v[144:147], v[72:75]
    v_mfma_f32_16x16x32_bf16 v[76:79], v[204:207], v[148:151], v[76:79]
    v_mfma_f32_16x16x32_bf16 v[80:83], v[204:207], v[152:155], v[80:83]
    v_mfma_f32_16x16x32_bf16 v[84:87], v[204:207], v[156:159], v[84:87]
    v_mfma_f32_16x16x32_bf16 v[88:91], v[204:207], v[160:163], v[88:91]
    v_mfma_f32_16x16x32_bf16 v[92:95], v[204:207], v[164:167], v[92:95]
    s_waitcnt vmcnt(0)
L_s2done:
    s_lshl_b32 s3, s97, 3
    s_add_u32 s3, s3, s99
    s_lshl_b32 s3, s3, 5
    s_lshl_b32 s27, s100, 3
    s_lshl_b32 s26, s98, 2
    s_add_u32 s27, s27, s26
    s_add_u32 s27, s27, s60
    s_add_u32 s3, s3, s27
    s_lshl_b32 s3, s3, 10
    s_add_u32 s3, s3, 7340032
    s_lshl_b32 s27, s27, 10
    s_add_u32 s15, s27, 8388608
    v_mfma_f32_16x16x32_bf16 v[32:35], v[12:15], v[8:11], v[32:35]
    v_mfma_f32_16x16x32_bf16 v[64:67], v[16:19], v[8:11], v[64:67]
    v_mfma_f32_16x16x32_bf16 v[36:39], v[12:15], v[8:11], v[36:39]
    v_mfma_f32_16x16x32_bf16 v[68:71], v[16:19], v[8:11], v[68:71]
    s_nop 5
    v_cvt_pk_bf16_f32 v104, v32, v33
    v_cvt_pk_bf16_f32 v105, v34, v35
    v_cvt_pk_bf16_f32 v106, v64, v65
    v_cvt_pk_bf16_f32 v107, v66, v67
    v_xor_b32 v104, s101, v104
    v_xor_b32 v105, s101, v105
    v_xor_b32 v106, s101, v106
    v_xor_b32 v107, s101, v107
    s_add_u32 s27, s3, 0
    buffer_store_dwordx4 v[104:107], v28, s[40:43], s27 offen sc1
    v_mfma_f32_16x16x32_bf16 v[40:43], v[12:15], v[8:11], v[40:43]
    v_mfma_f32_16x16x32_bf16 v[72:75], v[16:19], v[8:11], v[72:75]
    v_cvt_pk_bf16_f32 v108, v36, v37
    v_cvt_pk_bf16_f32 v109, v38, v39
    v_cvt_pk_bf16_f32 v110, v68, v69
    v_cvt_pk_bf16_f32 v111, v70, v71
    v_xor_b32 v108, s101, v108
    v_xor_b32 v109, s101, v109
    v_xor_b32 v110, s101, v110
    v_xor_b32 v111, s101, v111
    s_add_u32 s27, s3, 16384
    buffer_store_dwordx4 v[108:111], v28, s[40:43], s27 offen sc1
    v_mfma_f32_16x16x32_bf16 v[44:47], v[12:15], v[8:11], v[44:47]
    v_mfma_f32_16x16x32_bf16 v[76:79], v[16:19], v[8:11], v[76:79]
    v_cvt_pk_bf16_f32 v112, v40, v41
    v_cvt_pk_bf16_f32 v113, v42, v43
    v_cvt_pk_bf16_f32 v114, v72, v73
    v_cvt_pk_bf16_f32 v115, v74, v75
    v_xor_b32 v112, s101, v112
    v_xor_b32 v113, s101, v113
    v_xor_b32 v114, s101, v114
    v_xor_b32 v115, s101, v115
    s_add_u32 s27, s3, 65536
    buffer_store_dwordx4 v[112:115], v28, s[40:43], s27 offen sc1
    v_mfma_f32_16x16x32_bf16 v[48:51], v[12:15], v[8:11], v[48:51]
    v_mfma_f32_16x16x32_bf16 v[80:83], v[16:19], v[8:11], v[80:83]
    v_cvt_pk_bf16_f32 v116, v44, v45
    v_cvt_pk_bf16_f32 v117, v46, v47
    v_cvt_pk_bf16_f32 v118, v76, v77
    v_cvt_pk_bf16_f32 v119, v78, v79
    v_xor_b32 v116, s101, v116
    v_xor_b32 v117, s101, v117
    v_xor_b32 v118, s101, v118
    v_xor_b32 v119, s101, v119
    s_add_u32 s27, s3, 81920
    buffer_store_dwordx4 v[116:119], v28, s[40:43], s27 offen sc1
    v_mfma_f32_16x16x32_bf16 v[52:55], v[12:15], v[8:11], v[52:55]
    v_mfma_f32_16x16x32_bf16 v[84:87], v[16:19], v[8:11], v[84:87]
    v_cvt_pk_bf16_f32 v120, v48, v49
    v_cvt_pk_bf16_f32 v121, v50, v51
    v_cvt_pk_bf16_f32 v122, v80, v81
    v_cvt_pk_bf16_f32 v123, v82, v83
    v_xor_b32 v120, s101, v120
    v_xor_b32 v121, s101, v121
    v_xor_b32 v122, s101, v122
    v_xor_b32 v123, s101, v123
    s_add_u32 s27, s3, 131072
    buffer_store_dwordx4 v[120:123], v28, s[40:43], s27 offen sc1
    v_mfma_f32_16x16x32_bf16 v[56:59], v[12:15], v[8:11], v[56:59]
    v_mfma_f32_16x16x32_bf16 v[88:91], v[16:19], v[8:11], v[88:91]
    v_cvt_pk_bf16_f32 v124, v52, v53
    v_cvt_pk_bf16_f32 v125, v54, v55
    v_cvt_pk_bf16_f32 v126, v84, v85
    v_cvt_pk_bf16_f32 v127, v86, v87
    v_xor_b32 v124, s101, v124
    v_xor_b32 v125, s101, v125
    v_xor_b32 v126, s101, v126
    v_xor_b32 v127, s101, v127
    s_add_u32 s27, s3, 147456
    buffer_store_dwordx4 v[124:127], v28, s[40:43], s27 offen sc1
    v_mfma_f32_16x16x32_bf16 v[60:63], v[12:15], v[8:11], v[60:63]
    v_mfma_f32_16x16x32_bf16 v[92:95], v[16:19], v[8:11], v[92:95]
    v_cvt_pk_bf16_f32 v128, v56, v57
    v_cvt_pk_bf16_f32 v129, v58, v59
    v_cvt_pk_bf16_f32 v130, v88, v89
    v_cvt_pk_bf16_f32 v131, v90, v91
    v_xor_b32 v128, s101, v128
    v_xor_b32 v129, s101, v129
    v_xor_b32 v130, s101, v130
    v_xor_b32 v131, s101, v131
    s_add_u32 s27, s3, 196608
    buffer_store_dwordx4 v[128:131], v28, s[40:43], s27 offen sc1
    v_cvt_pk_bf16_f32 v132, v60, v61
    v_cvt_pk_bf16_f32 v133, v62, v63
    v_cvt_pk_bf16_f32 v134, v92, v93
    v_cvt_pk_bf16_f32 v135, v94, v95
    v_xor_b32 v132, s101, v132
    v_xor_b32 v133, s101, v133
    v_xor_b32 v134, s101, v134
    v_xor_b32 v135, s101, v135
    s_add_u32 s27, s3, 212992
    buffer_store_dwordx4 v[132:135], v28, s[40:43], s27 offen sc1
    s_cbranch_vccz L_nospecial
    s_mov_b32 s26, 0x00010001
    s_mov_b32 s27, 0x00010001
    v_cvt_pk_bf16_f32 v168, v96, v97
    v_cvt_pk_bf16_f32 v169, v98, v99
    v_cvt_pk_bf16_f32 v170, v100, v101
    v_cvt_pk_bf16_f32 v171, v102, v103
    v_cndmask_b32 v168, v104, v168, s[26:27]
    v_cndmask_b32 v169, v105, v169, s[26:27]
    v_cndmask_b32 v170, v106, v170, s[26:27]
    v_cndmask_b32 v171, v107, v171, s[26:27]
    buffer_store_dwordx4 v[168:171], v28, s[40:43], s15 offen sc1
L_nospecial:
    s_waitcnt vmcnt(0)
    s_barrier
    s_endpgm
L_s2x:
    s_barrier
    s_waitcnt vmcnt(6) lgkmcnt(0)
    v_mfma_f32_16x16x32_bf16 v[32:35], v[168:171], v[104:107], 0
    ds_read_b128 v[136:139], v22 offset:8192
    v_mfma_f32_16x16x32_bf16 v[36:39], v[168:171], v[108:111], 0
    ds_read_b128 v[140:143], v22 offset:9216
    v_mfma_f32_16x16x32_bf16 v[40:43], v[168:171], v[112:115], 0
    ds_read_b128 v[144:147], v22 offset:10240
    v_mfma_f32_16x16x32_bf16 v[44:47], v[168:171], v[116:119], 0
    ds_read_b128 v[148:151], v22 offset:11264
    v_mfma_f32_16x16x32_bf16 v[48:51], v[168:171], v[120:123], 0
    ds_read_b128 v[152:155], v22 offset:12288
    v_mfma_f32_16x16x32_bf16 v[52:55], v[168:171], v[124:127], 0
    ds_read_b128 v[156:159], v22 offset:13312
    v_mfma_f32_16x16x32_bf16 v[56:59], v[168:171], v[128:131], 0
    ds_read_b128 v[160:163], v22 offset:14336
    v_mfma_f32_16x16x32_bf16 v[60:63], v[168:171], v[132:135], 0
    ds_read_b128 v[164:167], v22 offset:15360
    v_mfma_f32_16x16x32_bf16 v[64:67], v[172:175], v[104:107], 0
    s_add_u32 s94, s14, 1
    s_and_b32 s94, s94, 3
    s_lshl_b32 s94, s94, 12
    s_add_u32 s94, s94, s15
    buffer_load_dwordx4 v[200:203], v28, s[40:43], s94 offen offset:0 sc1
    v_mfma_f32_16x16x32_bf16 v[68:71], v[172:175], v[108:111], 0
    v_mfma_f32_16x16x32_bf16 v[72:75], v[172:175], v[112:115], 0
    buffer_load_dwordx4 v[204:207], v29, s[40:43], s94 offen offset:0 sc1
    v_mfma_f32_16x16x32_bf16 v[76:79], v[172:175], v[116:119], 0
    v_mfma_f32_16x16x32_bf16 v[80:83], v[172:175], v[120:123], 0
    buffer_load_dwordx4 v[208:211], v28, s[40:43], s94 offen offset:1024 sc1
    v_mfma_f32_16x16x32_bf16 v[84:87], v[172:175], v[124:127], 0
    v_mfma_f32_16x16x32_bf16 v[88:91], v[172:175], v[128:131], 0
    buffer_load_dwordx4 v[212:215], v29, s[40:43], s94 offen offset:1024 sc1
    v_mfma_f32_16x16x32_bf16 v[92:95], v[172:175], v[132:135], 0
    v_mfma_f32_16x16x32_bf16 v[96:99], v[168:171], v[4:7], v[96:99]
    v_mfma_f32_16x16x32_bf16 v[100:103], v[172:175], v[4:7], v[100:103]
    s_waitcnt vmcnt(8) lgkmcnt(0)
    v_mfma_f32_16x16x32_bf16 v[32:35], v[176:179], v[136:139], v[32:35]
    ds_read_b128 v[104:107], v22 offset:16384
    v_mfma_f32_16x16x32_bf16 v[36:39], v[176:179], v[140:143], v[36:39]
    ds_read_b128 v[108:111], v22 offset:17408
    v_mfma_f32_16x16x32_bf16 v[40:43], v[176:179], v[144:147], v[40:43]
    ds_read_b128 v[112:115], v22 offset:18432
    v_mfma_f32_16x16x32_bf16 v[44:47], v[176:179], v[148:151], v[44:47]
    ds_read_b128 v[116:119], v22 offset:19456
    v_mfma_f32_16x16x32_bf16 v[48:51], v[176:179], v[152:155], v[48:51]
    ds_read_b128 v[120:123], v22 offset:20480
    v_mfma_f32_16x16x32_bf16 v[52:55], v[176:179], v[156:159], v[52:55]
    ds_read_b128 v[124:127], v22 offset:21504
    v_mfma_f32_16x16x32_bf16 v[56:59], v[176:179], v[160:163], v[56:59]
    ds_read_b128 v[128:131], v22 offset:22528
    v_mfma_f32_16x16x32_bf16 v[60:63], v[176:179], v[164:167], v[60:63]
    ds_read_b128 v[132:135], v22 offset:23552
    v_mfma_f32_16x16x32_bf16 v[64:67], v[180:183], v[136:139], v[64:67]
    buffer_load_dwordx4 v[216:219], v28, s[40:43], s94 offen offset:2048 sc1
    v_mfma_f32_16x16x32_bf16 v[68:71], v[180:183], v[140:143], v[68:71]
    v_mfma_f32_16x16x32_bf16 v[72:75], v[180:183], v[144:147], v[72:75]
    buffer_load_dwordx4 v[220:223], v29, s[40:43], s94 offen offset:2048 sc1
    v_mfma_f32_16x16x32_bf16 v[76:79], v[180:183], v[148:151], v[76:79]
    v_mfma_f32_16x16x32_bf16 v[80:83], v[180:183], v[152:155], v[80:83]
    buffer_load_dwordx4 v[224:227], v28, s[40:43], s94 offen offset:3072 sc1
    v_mfma_f32_16x16x32_bf16 v[84:87], v[180:183], v[156:159], v[84:87]
    v_mfma_f32_16x16x32_bf16 v[88:91], v[180:183], v[160:163], v[88:91]
    buffer_load_dwordx4 v[228:231], v29, s[40:43], s94 offen offset:3072 sc1
    v_mfma_f32_16x16x32_bf16 v[92:95], v[180:183], v[164:167], v[92:95]
    v_mfma_f32_16x16x32_bf16 v[96:99], v[176:179], v[4:7], v[96:99]
    v_mfma_f32_16x16x32_bf16 v[100:103], v[180:183], v[4:7], v[100:103]
    s_barrier
    s_waitcnt vmcnt(10) lgkmcnt(0)
    v_mfma_f32_16x16x32_bf16 v[32:35], v[184:187], v[104:107], v[32:35]
    ds_read_b128 v[136:139], v22 offset:24576
    v_mfma_f32_16x16x32_bf16 v[36:39], v[184:187], v[108:111], v[36:39]
    ds_read_b128 v[140:143], v22 offset:25600
    v_mfma_f32_16x16x32_bf16 v[40:43], v[184:187], v[112:115], v[40:43]
    ds_read_b128 v[144:147], v22 offset:26624
    v_mfma_f32_16x16x32_bf16 v[44:47], v[184:187], v[116:119], v[44:47]
    ds_read_b128 v[148:151], v22 offset:27648
    v_mfma_f32_16x16x32_bf16 v[48:51], v[184:187], v[120:123], v[48:51]
    ds_read_b128 v[152:155], v22 offset:28672
    v_mfma_f32_16x16x32_bf16 v[52:55], v[184:187], v[124:127], v[52:55]
    ds_read_b128 v[156:159], v22 offset:29696
    v_mfma_f32_16x16x32_bf16 v[56:59], v[184:187], v[128:131], v[56:59]
    ds_read_b128 v[160:163], v22 offset:30720
    v_mfma_f32_16x16x32_bf16 v[60:63], v[184:187], v[132:135], v[60:63]
    ds_read_b128 v[164:167], v22 offset:31744
    v_mfma_f32_16x16x32_bf16 v[64:67], v[188:191], v[104:107], v[64:67]
    s_add_u32 s94, s14, 2
    s_and_b32 s94, s94, 3
    s_lshl_b32 s94, s94, 12
    s_add_u32 s94, s94, s15
    buffer_load_dwordx4 v[232:235], v28, s[40:43], s94 offen offset:0 sc1
    v_mfma_f32_16x16x32_bf16 v[68:71], v[188:191], v[108:111], v[68:71]
    v_mfma_f32_16x16x32_bf16 v[72:75], v[188:191], v[112:115], v[72:75]
    buffer_load_dwordx4 v[236:239], v29, s[40:43], s94 offen offset:0 sc1
    v_mfma_f32_16x16x32_bf16 v[76:79], v[188:191], v[116:119], v[76:79]
    v_mfma_f32_16x16x32_bf16 v[80:83], v[188:191], v[120:123], v[80:83]
    v_mfma_f32_16x16x32_bf16 v[84:87], v[188:191], v[124:127], v[84:87]
    v_mfma_f32_16x16x32_bf16 v[88:91], v[188:191], v[128:131], v[88:91]
    v_mfma_f32_16x16x32_bf16 v[92:95], v[188:191], v[132:135], v[92:95]
    v_mfma_f32_16x16x32_bf16 v[96:99], v[184:187], v[4:7], v[96:99]
    v_mfma_f32_16x16x32_bf16 v[100:103], v[188:191], v[4:7], v[100:103]
    s_waitcnt vmcnt(10) lgkmcnt(0)
    v_mfma_f32_16x16x32_bf16 v[32:35], v[192:195], v[136:139], v[32:35]
    ds_read_b128 v[104:107], v23 offset:0
    v_mfma_f32_16x16x32_bf16 v[36:39], v[192:195], v[140:143], v[36:39]
    ds_read_b128 v[108:111], v23 offset:1024
    v_mfma_f32_16x16x32_bf16 v[40:43], v[192:195], v[144:147], v[40:43]
    ds_read_b128 v[112:115], v23 offset:2048
    v_mfma_f32_16x16x32_bf16 v[44:47], v[192:195], v[148:151], v[44:47]
    ds_read_b128 v[116:119], v23 offset:3072
    v_mfma_f32_16x16x32_bf16 v[48:51], v[192:195], v[152:155], v[48:51]
    ds_read_b128 v[120:123], v23 offset:4096
    v_mfma_f32_16x16x32_bf16 v[52:55], v[192:195], v[156:159], v[52:55]
    ds_read_b128 v[124:127], v23 offset:5120
    v_mfma_f32_16x16x32_bf16 v[56:59], v[192:195], v[160:163], v[56:59]
    ds_read_b128 v[128:131], v23 offset:6144
    v_mfma_f32_16x16x32_bf16 v[60:63], v[192:195], v[164:167], v[60:63]
    ds_read_b128 v[132:135], v23 offset:7168
    v_mfma_f32_16x16x32_bf16 v[64:67], v[196:199], v[136:139], v[64:67]
    buffer_load_dwordx4 v[240:243], v28, s[40:43], s94 offen offset:1024 sc1
    v_mfma_f32_16x16x32_bf16 v[68:71], v[196:199], v[140:143], v[68:71]
    v_mfma_f32_16x16x32_bf16 v[72:75], v[196:199], v[144:147], v[72:75]
    buffer_load_dwordx4 v[244:247], v29, s[40:43], s94 offen offset:1024 sc1
    v_mfma_f32_16x16x32_bf16 v[76:79], v[196:199], v[148:151], v[76:79]
    v_mfma_f32_16x16x32_bf16 v[80:83], v[196:199], v[152:155], v[80:83]
    v_mfma_f32_16x16x32_bf16 v[84:87], v[196:199], v[156:159], v[84:87]
    v_mfma_f32_16x16x32_bf16 v[88:91], v[196:199], v[160:163], v[88:91]
    v_mfma_f32_16x16x32_bf16 v[92:95], v[196:199], v[164:167], v[92:95]
    v_mfma_f32_16x16x32_bf16 v[96:99], v[192:195], v[4:7], v[96:99]
    v_mfma_f32_16x16x32_bf16 v[100:103], v[196:199], v[4:7], v[100:103]
    s_waitcnt vmcnt(10) lgkmcnt(0)
    v_mfma_f32_16x16x32_bf16 v[32:35], v[200:203], v[104:107], v[32:35]
    ds_read_b128 v[136:139], v23 offset:8192
    v_mfma_f32_16x16x32_bf16 v[36:39], v[200:203], v[108:111], v[36:39]
    ds_read_b128 v[140:143], v23 offset:9216
    v_mfma_f32_16x16x32_bf16 v[40:43], v[200:203], v[112:115], v[40:43]
    ds_read_b128 v[144:147], v23 offset:10240
    v_mfma_f32_16x16x32_bf16 v[44:47], v[200:203], v[116:119], v[44:47]
    ds_read_b128 v[148:151], v23 offset:11264
    v_mfma_f32_16x16x32_bf16 v[48:51], v[200:203], v[120:123], v[48:51]
    ds_read_b128 v[152:155], v23 offset:12288
    v_mfma_f32_16x16x32_bf16 v[52:55], v[200:203], v[124:127], v[52:55]
    ds_read_b128 v[156:159], v23 offset:13312
    v_mfma_f32_16x16x32_bf16 v[56:59], v[200:203], v[128:131], v[56:59]
    ds_read_b128 v[160:163], v23 offset:14336
    v_mfma_f32_16x16x32_bf16 v[60:63], v[200:203], v[132:135], v[60:63]
    ds_read_b128 v[164:167], v23 offset:15360
    v_mfma_f32_16x16x32_bf16 v[64:67], v[204:207], v[104:107], v[64:67]
    buffer_load_dwordx4 v[248:251], v28, s[40:43], s94 offen offset:2048 sc1
    v_mfma_f32_16x16x32_bf16 v[68:71], v[204:207], v[108:111], v[68:71]
    v_mfma_f32_16x16x32_bf16 v[72:75], v[204:207], v[112:115], v[72:75]
    buffer_load_dwordx4 v[252:255], v29, s[40:43], s94 offen offset:2048 sc1
    v_mfma_f32_16x16x32_bf16 v[76:79], v[204:207], v[116:119], v[76:79]
    v_mfma_f32_16x16x32_bf16 v[80:83], v[204:207], v[120:123], v[80:83]
    v_mfma_f32_16x16x32_bf16 v[84:87], v[204:207], v[124:127], v[84:87]
    v_mfma_f32_16x16x32_bf16 v[88:91], v[204:207], v[128:131], v[88:91]
    v_mfma_f32_16x16x32_bf16 v[92:95], v[204:207], v[132:135], v[92:95]
    v_mfma_f32_16x16x32_bf16 v[96:99], v[200:203], v[4:7], v[96:99]
    v_mfma_f32_16x16x32_bf16 v[100:103], v[204:207], v[4:7], v[100:103]
    s_waitcnt vmcnt(10) lgkmcnt(0)
    v_mfma_f32_16x16x32_bf16 v[32:35], v[208:211], v[136:139], v[32:35]
    ds_read_b128 v[104:107], v23 offset:16384
    v_mfma_f32_16x16x32_bf16 v[36:39], v[208:211], v[140:143], v[36:39]
    ds_read_b128 v[108:111], v23 offset:17408
    v_mfma_f32_16x16x32_bf16 v[40:43], v[208:211], v[144:147], v[40:43]
    ds_read_b128 v[112:115], v23 offset:18432
    v_mfma_f32_16x16x32_bf16 v[44:47], v[208:211], v[148:151], v[44:47]
    ds_read_b128 v[116:119], v23 offset:19456
    v_mfma_f32_16x16x32_bf16 v[48:51], v[208:211], v[152:155], v[48:51]
    ds_read_b128 v[120:123], v23 offset:20480
    v_mfma_f32_16x16x32_bf16 v[52:55], v[208:211], v[156:159], v[52:55]
    ds_read_b128 v[124:127], v23 offset:21504
    v_mfma_f32_16x16x32_bf16 v[56:59], v[208:211], v[160:163], v[56:59]
    ds_read_b128 v[128:131], v23 offset:22528
    v_mfma_f32_16x16x32_bf16 v[60:63], v[208:211], v[164:167], v[60:63]
    ds_read_b128 v[132:135], v23 offset:23552
    v_mfma_f32_16x16x32_bf16 v[64:67], v[212:215], v[136:139], v[64:67]
    buffer_load_dwordx4 v[168:171], v28, s[40:43], s94 offen offset:3072 sc1
    v_mfma_f32_16x16x32_bf16 v[68:71], v[212:215], v[140:143], v[68:71]
    v_mfma_f32_16x16x32_bf16 v[72:75], v[212:215], v[144:147], v[72:75]
    buffer_load_dwordx4 v[172:175], v29, s[40:43], s94 offen offset:3072 sc1
    v_mfma_f32_16x16x32_bf16 v[76:79], v[212:215], v[148:151], v[76:79]
    v_mfma_f32_16x16x32_bf16 v[80:83], v[212:215], v[152:155], v[80:83]
    v_mfma_f32_16x16x32_bf16 v[84:87], v[212:215], v[156:159], v[84:87]
    v_mfma_f32_16x16x32_bf16 v[88:91], v[212:215], v[160:163], v[88:91]
    v_mfma_f32_16x16x32_bf16 v[92:95], v[212:215], v[164:167], v[92:95]
    v_mfma_f32_16x16x32_bf16 v[96:99], v[208:211], v[4:7], v[96:99]
    v_mfma_f32_16x16x32_bf16 v[100:103], v[212:215], v[4:7], v[100:103]
    s_barrier
    s_waitcnt vmcnt(10) lgkmcnt(0)
    v_mfma_f32_16x16x32_bf16 v[32:35], v[216:219], v[104:107], v[32:35]
    ds_read_b128 v[136:139], v23 offset:24576
    v_mfma_f32_16x16x32_bf16 v[36:39], v[216:219], v[108:111], v[36:39]
    ds_read_b128 v[140:143], v23 offset:25600
    v_mfma_f32_16x16x32_bf16 v[40:43], v[216:219], v[112:115], v[40:43]
    ds_read_b128 v[144:147], v23 offset:26624
    v_mfma_f32_16x16x32_bf16 v[44:47], v[216:219], v[116:119], v[44:47]
    ds_read_b128 v[148:151], v23 offset:27648
    v_mfma_f32_16x16x32_bf16 v[48:51], v[216:219], v[120:123], v[48:51]
    ds_read_b128 v[152:155], v23 offset:28672
    v_mfma_f32_16x16x32_bf16 v[52:55], v[216:219], v[124:127], v[52:55]
    ds_read_b128 v[156:159], v23 offset:29696
    v_mfma_f32_16x16x32_bf16 v[56:59], v[216:219], v[128:131], v[56:59]
    ds_read_b128 v[160:163], v23 offset:30720
    v_mfma_f32_16x16x32_bf16 v[60:63], v[216:219], v[132:135], v[60:63]
    ds_read_b128 v[164:167], v23 offset:31744
    v_mfma_f32_16x16x32_bf16 v[64:67], v[220:223], v[104:107], v[64:67]
    s_add_u32 s94, s14, 3
    s_and_b32 s94, s94, 3
    s_lshl_b32 s94, s94, 12
    s_add_u32 s94, s94, s15
    buffer_load_dwordx4 v[176:179], v28, s[40:43], s94 offen offset:0 sc1
    v_mfma_f32_16x16x32_bf16 v[68:71], v[220:223], v[108:111], v[68:71]
    v_mfma_f32_16x16x32_bf16 v[72:75], v[220:223], v[112:115], v[72:75]
    buffer_load_dwordx4 v[180:183], v29, s[40:43], s94 offen offset:0 sc1
    v_mfma_f32_16x16x32_bf16 v[76:79], v[220:223], v[116:119], v[76:79]
    v_mfma_f32_16x16x32_bf16 v[80:83], v[220:223], v[120:123], v[80:83]
    v_mfma_f32_16x16x32_bf16 v[84:87], v[220:223], v[124:127], v[84:87]
    v_mfma_f32_16x16x32_bf16 v[88:91], v[220:223], v[128:131], v[88:91]
    v_mfma_f32_16x16x32_bf16 v[92:95], v[220:223], v[132:135], v[92:95]
    v_mfma_f32_16x16x32_bf16 v[96:99], v[216:219], v[4:7], v[96:99]
    v_mfma_f32_16x16x32_bf16 v[100:103], v[220:223], v[4:7], v[100:103]
    s_waitcnt vmcnt(10) lgkmcnt(0)
    v_mfma_f32_16x16x32_bf16 v[32:35], v[224:227], v[136:139], v[32:35]
    ds_read_b128 v[104:107], v24 offset:0
    v_mfma_f32_16x16x32_bf16 v[36:39], v[224:227], v[140:143], v[36:39]
    ds_read_b128 v[108:111], v24 offset:1024
    v_mfma_f32_16x16x32_bf16 v[40:43], v[224:227], v[144:147], v[40:43]
    ds_read_b128 v[112:115], v24 offset:2048
    v_mfma_f32_16x16x32_bf16 v[44:47], v[224:227], v[148:151], v[44:47]
    ds_read_b128 v[116:119], v24 offset:3072
    v_mfma_f32_16x16x32_bf16 v[48:51], v[224:227], v[152:155], v[48:51]
    ds_read_b128 v[120:123], v24 offset:4096
    v_mfma_f32_16x16x32_bf16 v[52:55], v[224:227], v[156:159], v[52:55]
    ds_read_b128 v[124:127], v24 offset:5120
    v_mfma_f32_16x16x32_bf16 v[56:59], v[224:227], v[160:163], v[56:59]
    ds_read_b128 v[128:131], v24 offset:6144
    v_mfma_f32_16x16x32_bf16 v[60:63], v[224:227], v[164:167], v[60:63]
    ds_read_b128 v[132:135], v24 offset:7168
    v_mfma_f32_16x16x32_bf16 v[64:67], v[228:231], v[136:139], v[64:67]
    buffer_load_dwordx4 v[184:187], v28, s[40:43], s94 offen offset:1024 sc1
    v_mfma_f32_16x16x32_bf16 v[68:71], v[228:231], v[140:143], v[68:71]
    v_mfma_f32_16x16x32_bf16 v[72:75], v[228:231], v[144:147], v[72:75]
    buffer_load_dwordx4 v[188:191], v29, s[40:43], s94 offen offset:1024 sc1
    v_mfma_f32_16x16x32_bf16 v[76:79], v[228:231], v[148:151], v[76:79]
    v_mfma_f32_16x16x32_bf16 v[80:83], v[228:231], v[152:155], v[80:83]
    v_mfma_f32_16x16x32_bf16 v[84:87], v[228:231], v[156:159], v[84:87]
    v_mfma_f32_16x16x32_bf16 v[88:91], v[228:231], v[160:163], v[88:91]
    v_mfma_f32_16x16x32_bf16 v[92:95], v[228:231], v[164:167], v[92:95]
    v_mfma_f32_16x16x32_bf16 v[96:99], v[224:227], v[4:7], v[96:99]
    v_mfma_f32_16x16x32_bf16 v[100:103], v[228:231], v[4:7], v[100:103]
    s_waitcnt vmcnt(10) lgkmcnt(0)
    v_mfma_f32_16x16x32_bf16 v[32:35], v[232:235], v[104:107], v[32:35]
    ds_read_b128 v[136:139], v24 offset:8192
    v_mfma_f32_16x16x32_bf16 v[36:39], v[232:235], v[108:111], v[36:39]
    ds_read_b128 v[140:143], v24 offset:9216
    v_mfma_f32_16x16x32_bf16 v[40:43], v[232:235], v[112:115], v[40:43]
    ds_read_b128 v[144:147], v24 offset:10240
    v_mfma_f32_16x16x32_bf16 v[44:47], v[232:235], v[116:119], v[44:47]
    ds_read_b128 v[148:151], v24 offset:11264
    v_mfma_f32_16x16x32_bf16 v[48:51], v[232:235], v[120:123], v[48:51]
    ds_read_b128 v[152:155], v24 offset:12288
    v_mfma_f32_16x16x32_bf16 v[52:55], v[232:235], v[124:127], v[52:55]
    ds_read_b128 v[156:159], v24 offset:13312
    v_mfma_f32_16x16x32_bf16 v[56:59], v[232:235], v[128:131], v[56:59]
    ds_read_b128 v[160:163], v24 offset:14336
    v_mfma_f32_16x16x32_bf16 v[60:63], v[232:235], v[132:135], v[60:63]
    ds_read_b128 v[164:167], v24 offset:15360
    v_mfma_f32_16x16x32_bf16 v[64:67], v[236:239], v[104:107], v[64:67]
    buffer_load_dwordx4 v[192:195], v28, s[40:43], s94 offen offset:2048 sc1
    v_mfma_f32_16x16x32_bf16 v[68:71], v[236:239], v[108:111], v[68:71]
    v_mfma_f32_16x16x32_bf16 v[72:75], v[236:239], v[112:115], v[72:75]
    buffer_load_dwordx4 v[196:199], v29, s[40:43], s94 offen offset:2048 sc1
    v_mfma_f32_16x16x32_bf16 v[76:79], v[236:239], v[116:119], v[76:79]
    v_mfma_f32_16x16x32_bf16 v[80:83], v[236:239], v[120:123], v[80:83]
    v_mfma_f32_16x16x32_bf16 v[84:87], v[236:239], v[124:127], v[84:87]
    v_mfma_f32_16x16x32_bf16 v[88:91], v[236:239], v[128:131], v[88:91]
    v_mfma_f32_16x16x32_bf16 v[92:95], v[236:239], v[132:135], v[92:95]
    v_mfma_f32_16x16x32_bf16 v[96:99], v[232:235], v[4:7], v[96:99]
    v_mfma_f32_16x16x32_bf16 v[100:103], v[236:239], v[4:7], v[100:103]
    s_waitcnt vmcnt(10) lgkmcnt(0)
    v_mfma_f32_16x16x32_bf16 v[32:35], v[240:243], v[136:139], v[32:35]
    ds_read_b128 v[104:107], v24 offset:16384
    v_mfma_f32_16x16x32_bf16 v[36:39], v[240:243], v[140:143], v[36:39]
    ds_read_b128 v[108:111], v24 offset:17408
    v_mfma_f32_16x16x32_bf16 v[40:43], v[240:243], v[144:147], v[40:43]
    ds_read_b128 v[112:115], v24 offset:18432
    v_mfma_f32_16x16x32_bf16 v[44:47], v[240:243], v[148:151], v[44:47]
    ds_read_b128 v[116:119], v24 offset:19456
    v_mfma_f32_16x16x32_bf16 v[48:51], v[240:243], v[152:155], v[48:51]
    ds_read_b128 v[120:123], v24 offset:20480
    v_mfma_f32_16x16x32_bf16 v[52:55], v[240:243], v[156:159], v[52:55]
    ds_read_b128 v[124:127], v24 offset:21504
    v_mfma_f32_16x16x32_bf16 v[56:59], v[240:243], v[160:163], v[56:59]
    ds_read_b128 v[128:131], v24 offset:22528
    v_mfma_f32_16x16x32_bf16 v[60:63], v[240:243], v[164:167], v[60:63]
    ds_read_b128 v[132:135], v24 offset:23552
    v_mfma_f32_16x16x32_bf16 v[64:67], v[244:247], v[136:139], v[64:67]
    buffer_load_dwordx4 v[200:203], v28, s[40:43], s94 offen offset:3072 sc1
    v_mfma_f32_16x16x32_bf16 v[68:71], v[244:247], v[140:143], v[68:71]
    v_mfma_f32_16x16x32_bf16 v[72:75], v[244:247], v[144:147], v[72:75]
    buffer_load_dwordx4 v[204:207], v29, s[40:43], s94 offen offset:3072 sc1
    v_mfma_f32_16x16x32_bf16 v[76:79], v[244:247], v[148:151], v[76:79]
    v_mfma_f32_16x16x32_bf16 v[80:83], v[244:247], v[152:155], v[80:83]
    v_mfma_f32_16x16x32_bf16 v[84:87], v[244:247], v[156:159], v[84:87]
    v_mfma_f32_16x16x32_bf16 v[88:91], v[244:247], v[160:163], v[88:91]
    v_mfma_f32_16x16x32_bf16 v[92:95], v[244:247], v[164:167], v[92:95]
    v_mfma_f32_16x16x32_bf16 v[96:99], v[240:243], v[4:7], v[96:99]
    v_mfma_f32_16x16x32_bf16 v[100:103], v[244:247], v[4:7], v[100:103]
    s_waitcnt vmcnt(10) lgkmcnt(0)
    v_mfma_f32_16x16x32_bf16 v[32:35], v[248:251], v[104:107], v[32:35]
    ds_read_b128 v[136:139], v24 offset:24576
    v_mfma_f32_16x16x32_bf16 v[36:39], v[248:251], v[108:111], v[36:39]
    ds_read_b128 v[140:143], v24 offset:25600
    v_mfma_f32_16x16x32_bf16 v[40:43], v[248:251], v[112:115], v[40:43]
    ds_read_b128 v[144:147], v24 offset:26624
    v_mfma_f32_16x16x32_bf16 v[44:47], v[248:251], v[116:119], v[44:47]
    ds_read_b128 v[148:151], v24 offset:27648
    v_mfma_f32_16x16x32_bf16 v[48:51], v[248:251], v[120:123], v[48:51]
    ds_read_b128 v[152:155], v24 offset:28672
    v_mfma_f32_16x16x32_bf16 v[52:55], v[248:251], v[124:127], v[52:55]
    ds_read_b128 v[156:159], v24 offset:29696
    v_mfma_f32_16x16x32_bf16 v[56:59], v[248:251], v[128:131], v[56:59]
    ds_read_b128 v[160:163], v24 offset:30720
    v_mfma_f32_16x16x32_bf16 v[60:63], v[248:251], v[132:135], v[60:63]
    ds_read_b128 v[164:167], v24 offset:31744
    v_mfma_f32_16x16x32_bf16 v[64:67], v[252:255], v[104:107], v[64:67]
    v_mfma_f32_16x16x32_bf16 v[68:71], v[252:255], v[108:111], v[68:71]
    v_mfma_f32_16x16x32_bf16 v[72:75], v[252:255], v[112:115], v[72:75]
    v_mfma_f32_16x16x32_bf16 v[76:79], v[252:255], v[116:119], v[76:79]
    v_mfma_f32_16x16x32_bf16 v[80:83], v[252:255], v[120:123], v[80:83]
    v_mfma_f32_16x16x32_bf16 v[84:87], v[252:255], v[124:127], v[84:87]
    v_mfma_f32_16x16x32_bf16 v[88:91], v[252:255], v[128:131], v[88:91]
    v_mfma_f32_16x16x32_bf16 v[92:95], v[252:255], v[132:135], v[92:95]
    v_mfma_f32_16x16x32_bf16 v[96:99], v[248:251], v[4:7], v[96:99]
    v_mfma_f32_16x16x32_bf16 v[100:103], v[252:255], v[4:7], v[100:103]
    s_waitcnt vmcnt(8) lgkmcnt(0)
    v_mfma_f32_16x16x32_bf16 v[32:35], v[168:171], v[136:139], v[32:35]
    ds_read_b128 v[104:107], v25 offset:0
    v_mfma_f32_16x16x32_bf16 v[36:39], v[168:171], v[140:143], v[36:39]
    ds_read_b128 v[108:111], v25 offset:1024
    v_mfma_f32_16x16x32_bf16 v[40:43], v[168:171], v[144:147], v[40:43]
    ds_read_b128 v[112:115], v25 offset:2048
    v_mfma_f32_16x16x32_bf16 v[44:47], v[168:171], v[148:151], v[44:47]
    ds_read_b128 v[116:119], v25 offset:3072
    v_mfma_f32_16x16x32_bf16 v[48:51], v[168:171], v[152:155], v[48:51]
    ds_read_b128 v[120:123], v25 offset:4096
    v_mfma_f32_16x16x32_bf16 v[52:55], v[168:171], v[156:159], v[52:55]
    ds_read_b128 v[124:127], v25 offset:5120
    v_mfma_f32_16x16x32_bf16 v[56:59], v[168:171], v[160:163], v[56:59]
    ds_read_b128 v[128:131], v25 offset:6144
    v_mfma_f32_16x16x32_bf16 v[60:63], v[168:171], v[164:167], v[60:63]
    ds_read_b128 v[132:135], v25 offset:7168
    v_mfma_f32_16x16x32_bf16 v[64:67], v[172:175], v[136:139], v[64:67]
    v_mfma_f32_16x16x32_bf16 v[68:71], v[172:175], v[140:143], v[68:71]
    v_mfma_f32_16x16x32_bf16 v[72:75], v[172:175], v[144:147], v[72:75]
    v_mfma_f32_16x16x32_bf16 v[76:79], v[172:175], v[148:151], v[76:79]
    v_mfma_f32_16x16x32_bf16 v[80:83], v[172:175], v[152:155], v[80:83]
    v_mfma_f32_16x16x32_bf16 v[84:87], v[172:175], v[156:159], v[84:87]
    v_mfma_f32_16x16x32_bf16 v[88:91], v[172:175], v[160:163], v[88:91]
    v_mfma_f32_16x16x32_bf16 v[92:95], v[172:175], v[164:167], v[92:95]
    v_mfma_f32_16x16x32_bf16 v[96:99], v[168:171], v[4:7], v[96:99]
    v_mfma_f32_16x16x32_bf16 v[100:103], v[172:175], v[4:7], v[100:103]
    s_waitcnt vmcnt(6) lgkmcnt(0)
    v_mfma_f32_16x16x32_bf16 v[32:35], v[176:179], v[104:107], v[32:35]
    ds_read_b128 v[136:139], v25 offset:8192
    v_mfma_f32_16x16x32_bf16 v[36:39], v[176:179], v[108:111], v[36:39]
    ds_read_b128 v[140:143], v25 offset:9216
    v_mfma_f32_16x16x32_bf16 v[40:43], v[176:179], v[112:115], v[40:43]
    ds_read_b128 v[144:147], v25 offset:10240
    v_mfma_f32_16x16x32_bf16 v[44:47], v[176:179], v[116:119], v[44:47]
    ds_read_b128 v[148:151], v25 offset:11264
    v_mfma_f32_16x16x32_bf16 v[48:51], v[176:179], v[120:123], v[48:51]
    ds_read_b128 v[152:155], v25 offset:12288
    v_mfma_f32_16x16x32_bf16 v[52:55], v[176:179], v[124:127], v[52:55]
    ds_read_b128 v[156:159], v25 offset:13312
    v_mfma_f32_16x16x32_bf16 v[56:59], v[176:179], v[128:131], v[56:59]
    ds_read_b128 v[160:163], v25 offset:14336
    v_mfma_f32_16x16x32_bf16 v[60:63], v[176:179], v[132:135], v[60:63]
    ds_read_b128 v[164:167], v25 offset:15360
    v_mfma_f32_16x16x32_bf16 v[64:67], v[180:183], v[104:107], v[64:67]
    v_mfma_f32_16x16x32_bf16 v[68:71], v[180:183], v[108:111], v[68:71]
    v_mfma_f32_16x16x32_bf16 v[72:75], v[180:183], v[112:115], v[72:75]
    v_mfma_f32_16x16x32_bf16 v[76:79], v[180:183], v[116:119], v[76:79]
    v_mfma_f32_16x16x32_bf16 v[80:83], v[180:183], v[120:123], v[80:83]
    v_mfma_f32_16x16x32_bf16 v[84:87], v[180:183], v[124:127], v[84:87]
    v_mfma_f32_16x16x32_bf16 v[88:91], v[180:183], v[128:131], v[88:91]
    v_mfma_f32_16x16x32_bf16 v[92:95], v[180:183], v[132:135], v[92:95]
    v_mfma_f32_16x16x32_bf16 v[96:99], v[176:179], v[4:7], v[96:99]
    v_mfma_f32_16x16x32_bf16 v[100:103], v[180:183], v[4:7], v[100:103]
    s_waitcnt vmcnt(4) lgkmcnt(0)
    v_mfma_f32_16x16x32_bf16 v[32:35], v[184:187], v[136:139], v[32:35]
    ds_read_b128 v[104:107], v25 offset:16384
    v_mfma_f32_16x16x32_bf16 v[36:39], v[184:187], v[140:143], v[36:39]
    ds_read_b128 v[108:111], v25 offset:17408
    v_mfma_f32_16x16x32_bf16 v[40:43], v[184:187], v[144:147], v[40:43]
    ds_read_b128 v[112:115], v25 offset:18432
    v_mfma_f32_16x16x32_bf16 v[44:47], v[184:187], v[148:151], v[44:47]
    ds_read_b128 v[116:119], v25 offset:19456
    v_mfma_f32_16x16x32_bf16 v[48:51], v[184:187], v[152:155], v[48:51]
    ds_read_b128 v[120:123], v25 offset:20480
    v_mfma_f32_16x16x32_bf16 v[52:55], v[184:187], v[156:159], v[52:55]
    ds_read_b128 v[124:127], v25 offset:21504
    v_mfma_f32_16x16x32_bf16 v[56:59], v[184:187], v[160:163], v[56:59]
    ds_read_b128 v[128:131], v25 offset:22528
    v_mfma_f32_16x16x32_bf16 v[60:63], v[184:187], v[164:167], v[60:63]
    ds_read_b128 v[132:135], v25 offset:23552
    v_mfma_f32_16x16x32_bf16 v[64:67], v[188:191], v[136:139], v[64:67]
    v_mfma_f32_16x16x32_bf16 v[68:71], v[188:191], v[140:143], v[68:71]
    v_mfma_f32_16x16x32_bf16 v[72:75], v[188:191], v[144:147], v[72:75]
    v_mfma_f32_16x16x32_bf16 v[76:79], v[188:191], v[148:151], v[76:79]
    v_mfma_f32_16x16x32_bf16 v[80:83], v[188:191], v[152:155], v[80:83]
    v_mfma_f32_16x16x32_bf16 v[84:87], v[188:191], v[156:159], v[84:87]
    buffer_load_ushort v12, v27, s[40:43], 0 offen sc1
    v_mfma_f32_16x16x32_bf16 v[88:91], v[188:191], v[160:163], v[88:91]
    v_mfma_f32_16x16x32_bf16 v[92:95], v[188:191], v[164:167], v[92:95]
    buffer_load_ushort v16, v27, s[40:43], 0 offen offset:32 sc1
    v_mfma_f32_16x16x32_bf16 v[96:99], v[184:187], v[4:7], v[96:99]
    v_mfma_f32_16x16x32_bf16 v[100:103], v[188:191], v[4:7], v[100:103]
    s_waitcnt vmcnt(4) lgkmcnt(0)
    v_mfma_f32_16x16x32_bf16 v[32:35], v[192:195], v[104:107], v[32:35]
    ds_read_b128 v[136:139], v25 offset:24576
    v_mfma_f32_16x16x32_bf16 v[36:39], v[192:195], v[108:111], v[36:39]
    ds_read_b128 v[140:143], v25 offset:25600
    v_mfma_f32_16x16x32_bf16 v[40:43], v[192:195], v[112:115], v[40:43]
    ds_read_b128 v[144:147], v25 offset:26624
    v_mfma_f32_16x16x32_bf16 v[44:47], v[192:195], v[116:119], v[44:47]
    ds_read_b128 v[148:151], v25 offset:27648
    v_mfma_f32_16x16x32_bf16 v[48:51], v[192:195], v[120:123], v[48:51]
    ds_read_b128 v[152:155], v25 offset:28672
    v_mfma_f32_16x16x32_bf16 v[52:55], v[192:195], v[124:127], v[52:55]
    ds_read_b128 v[156:159], v25 offset:29696
    v_mfma_f32_16x16x32_bf16 v[56:59], v[192:195], v[128:131], v[56:59]
    ds_read_b128 v[160:163], v25 offset:30720
    v_mfma_f32_16x16x32_bf16 v[60:63], v[192:195], v[132:135], v[60:63]
    ds_read_b128 v[164:167], v25 offset:31744
    v_mfma_f32_16x16x32_bf16 v[64:67], v[196:199], v[104:107], v[64:67]
    v_mfma_f32_16x16x32_bf16 v[68:71], v[196:199], v[108:111], v[68:71]
    v_mfma_f32_16x16x32_bf16 v[72:75], v[196:199], v[112:115], v[72:75]
    v_mfma_f32_16x16x32_bf16 v[76:79], v[196:199], v[116:119], v[76:79]
    v_mfma_f32_16x16x32_bf16 v[80:83], v[196:199], v[120:123], v[80:83]
    v_mfma_f32_16x16x32_bf16 v[84:87], v[196:199], v[124:127], v[84:87]
    v_mfma_f32_16x16x32_bf16 v[88:91], v[196:199], v[128:131], v[88:91]
    v_mfma_f32_16x16x32_bf16 v[92:95], v[196:199], v[132:135], v[92:95]
    v_mfma_f32_16x16x32_bf16 v[96:99], v[192:195], v[4:7], v[96:99]
    v_mfma_f32_16x16x32_bf16 v[100:103], v[196:199], v[4:7], v[100:103]
    s_waitcnt vmcnt(2) lgkmcnt(0)
    v_mfma_f32_16x16x32_bf16 v[32:35], v[200:203], v[136:139], v[32:35]
    v_mfma_f32_16x16x32_bf16 v[36:39], v[200:203], v[140:143], v[36:39]
    v_mfma_f32_16x16x32_bf16 v[40:43], v[200:203], v[144:147], v[40:43]
    v_mfma_f32_16x16x32_bf16 v[44:47], v[200:203], v[148:151], v[44:47]
    v_mfma_f32_16x16x32_bf16 v[48:51], v[200:203], v[152:155], v[48:51]
    v_mfma_f32_16x16x32_bf16 v[52:55], v[200:203], v[156:159], v[52:55]
    v_mfma_f32_16x16x32_bf16 v[56:59], v[200:203], v[160:163], v[56:59]
    v_mfma_f32_16x16x32_bf16 v[60:63], v[200:203], v[164:167], v[60:63]
    v_mfma_f32_16x16x32_bf16 v[64:67], v[204:207], v[136:139], v[64:67]
    v_mfma_f32_16x16x32_bf16 v[68:71], v[204:207], v[140:143], v[68:71]
    v_mfma_f32_16x16x32_bf16 v[72:75], v[204:207], v[144:147], v[72:75]
    v_mfma_f32_16x16x32_bf16 v[76:79], v[204:207], v[148:151], v[76:79]
    v_mfma_f32_16x16x32_bf16 v[80:83], v[204:207], v[152:155], v[80:83]
    v_mfma_f32_16x16x32_bf16 v[84:87], v[204:207], v[156:159], v[84:87]
    v_mfma_f32_16x16x32_bf16 v[88:91], v[204:207], v[160:163], v[88:91]
    v_mfma_f32_16x16x32_bf16 v[92:95], v[204:207], v[164:167], v[92:95]
    v_mfma_f32_16x16x32_bf16 v[96:99], v[200:203], v[4:7], v[96:99]
    v_mfma_f32_16x16x32_bf16 v[100:103], v[204:207], v[4:7], v[100:103]
    s_waitcnt vmcnt(0)
    v_mfma_f32_16x16x32_bf16 v[96:99], v[12:15], v[4:7], v[96:99]
    v_mfma_f32_16x16x32_bf16 v[100:103], v[16:19], v[4:7], v[100:103]
    s_branch L_s2done
L_dft_helper:
    s_waitcnt vmcnt(0)
    v_readlane_b32 s94, v191, 63
    v_lshlrev_b32 v4, 9, v1
    v_lshlrev_b32 v6, 2, v1
    s_lshr_b32 s3, s63, 3
    s_lshl_b32 s3, s3, 7
    s_and_b32 s27, s63, 7
    s_lshl_b32 s27, s27, 2
    s_add_u32 s3, s3, s27
    s_add_u32 s3, s3, 9527296
    s_mul_i32 s94, s94, 2654435761
    s_add_u32 s94, s94, 2135587861
    v_mov_b32 v5, s94
    s_barrier
    s_cmp_eq_u32 s60, 4
    s_cbranch_scc0 L_nox
    s_setprio 3
    s_mov_b64 exec, 0xff
    buffer_store_dword v5, v4, s[40:43], s3 offen sc1
    s_mov_b64 exec, -1
L_nox:
    v_pk_fma_f32 v[160:161], v[168:169], v[184:185], v[160:161] op_sel_hi:[1,0,1] neg_lo:[0,0,1] neg_hi:[0,0,1]
    v_pk_fma_f32 v[162:163], v[170:171], v[184:185], v[162:163] op_sel_hi:[1,0,1] neg_lo:[0,0,1] neg_hi:[0,0,1]
    v_pk_fma_f32 v[164:165], v[172:173], v[184:185], v[164:165] op_sel_hi:[1,0,1] neg_lo:[0,0,1] neg_hi:[0,0,1]
    v_pk_fma_f32 v[166:167], v[174:175], v[184:185], v[166:167] op_sel_hi:[1,0,1] neg_lo:[0,0,1] neg_hi:[0,0,1]
    v_cvt_pk_bf16_f32 v176, v160, v161
    v_cvt_pk_bf16_f32 v177, v162, v163
    v_cvt_pk_bf16_f32 v178, v164, v165
    v_cvt_pk_bf16_f32 v179, v166, v167
    ds_write_b128 v187, v[176:179] offset:16384
    v_pk_fma_f32 v[168:169], v[160:161], v[184:185], v[168:169] op_sel_hi:[1,0,1] neg_lo:[0,0,1] neg_hi:[0,0,1]
    v_pk_fma_f32 v[170:171], v[162:163], v[184:185], v[170:171] op_sel_hi:[1,0,1] neg_lo:[0,0,1] neg_hi:[0,0,1]
    v_pk_fma_f32 v[172:173], v[164:165], v[184:185], v[172:173] op_sel_hi:[1,0,1] neg_lo:[0,0,1] neg_hi:[0,0,1]
    v_pk_fma_f32 v[174:175], v[166:167], v[184:185], v[174:175] op_sel_hi:[1,0,1] neg_lo:[0,0,1] neg_hi:[0,0,1]
    v_cvt_pk_bf16_f32 v180, v168, v169
    v_cvt_pk_bf16_f32 v181, v170, v171
    v_cvt_pk_bf16_f32 v182, v172, v173
    v_cvt_pk_bf16_f32 v183, v174, v175
    ds_write_b128 v187, v[180:183] offset:24576
    v_pk_fma_f32 v[160:161], v[168:169], v[184:185], v[160:161] op_sel_hi:[1,0,1] neg_lo:[0,0,1] neg_hi:[0,0,1]
    v_pk_fma_f32 v[162:163], v[170:171], v[184:185], v[162:163] op_sel_hi:[1,0,1] neg_lo:[0,0,1] neg_hi:[0,0,1]
    v_pk_fma_f32 v[164:165], v[172:173], v[184:185], v[164:165] op_sel_hi:[1,0,1] neg_lo:[0,0,1] neg_hi:[0,0,1]
    v_pk_fma_f32 v[166:167], v[174:175], v[184:185], v[166:167] op_sel_hi:[1,0,1] neg_lo:[0,0,1] neg_hi:[0,0,1]
    v_cvt_pk_bf16_f32 v176, v160, v161
    v_cvt_pk_bf16_f32 v177, v162, v163
    v_cvt_pk_bf16_f32 v178, v164, v165
    v_cvt_pk_bf16_f32 v179, v166, v167
    ds_write_b128 v187, v[176:179] offset:32768
    v_pk_fma_f32 v[168:169], v[160:161], v[184:185], v[168:169] op_sel_hi:[1,0,1] neg_lo:[0,0,1] neg_hi:[0,0,1]
    v_pk_fma_f32 v[170:171], v[162:163], v[184:185], v[170:171] op_sel_hi:[1,0,1] neg_lo:[0,0,1] neg_hi:[0,0,1]
    v_pk_fma_f32 v[172:173], v[164:165], v[184:185], v[172:173] op_sel_hi:[1,0,1] neg_lo:[0,0,1] neg_hi:[0,0,1]
    v_pk_fma_f32 v[174:175], v[166:167], v[184:185], v[174:175] op_sel_hi:[1,0,1] neg_lo:[0,0,1] neg_hi:[0,0,1]
    v_cvt_pk_bf16_f32 v180, v168, v169
    v_cvt_pk_bf16_f32 v181, v170, v171
    v_cvt_pk_bf16_f32 v182, v172, v173
    v_cvt_pk_bf16_f32 v183, v174, v175
    ds_write_b128 v187, v[180:183] offset:40960
    v_pk_fma_f32 v[160:161], v[168:169], v[184:185], v[160:161] op_sel_hi:[1,0,1] neg_lo:[0,0,1] neg_hi:[0,0,1]
    v_pk_fma_f32 v[162:163], v[170:171], v[184:185], v[162:163] op_sel_hi:[1,0,1] neg_lo:[0,0,1] neg_hi:[0,0,1]
    v_pk_fma_f32 v[164:165], v[172:173], v[184:185], v[164:165] op_sel_hi:[1,0,1] neg_lo:[0,0,1] neg_hi:[0,0,1]
    v_pk_fma_f32 v[166:167], v[174:175], v[184:185], v[166:167] op_sel_hi:[1,0,1] neg_lo:[0,0,1] neg_hi:[0,0,1]
    v_cvt_pk_bf16_f32 v176, v160, v161
    v_cvt_pk_bf16_f32 v177, v162, v163
    v_cvt_pk_bf16_f32 v178, v164, v165
    v_cvt_pk_bf16_f32 v179, v166, v167
    ds_write_b128 v187, v[176:179] offset:49152
    v_pk_fma_f32 v[168:169], v[160:161], v[184:185], v[168:169] op_sel_hi:[1,0,1] neg_lo:[0,0,1] neg_hi:[0,0,1]
    v_pk_fma_f32 v[170:171], v[162:163], v[184:185], v[170:171] op_sel_hi:[1,0,1] neg_lo:[0,0,1] neg_hi:[0,0,1]
    v_pk_fma_f32 v[172:173], v[164:165], v[184:185], v[172:173] op_sel_hi:[1,0,1] neg_lo:[0,0,1] neg_hi:[0,0,1]
    v_pk_fma_f32 v[174:175], v[166:167], v[184:185], v[174:175] op_sel_hi:[1,0,1] neg_lo:[0,0,1] neg_hi:[0,0,1]
    v_cvt_pk_bf16_f32 v180, v168, v169
    v_cvt_pk_bf16_f32 v181, v170, v171
    v_cvt_pk_bf16_f32 v182, v172, v173
    v_cvt_pk_bf16_f32 v183, v174, v175
    ds_write_b128 v187, v[180:183] offset:57344
    s_waitcnt lgkmcnt(0)
    s_cmp_eq_u32 s60, 4
    s_cbranch_scc0 L_end
    s_lshl_b32 s3, s61, 9
    s_add_u32 s3, s3, 9527296
    s_add_u32 s26, s97, 1
    s_and_b32 s26, s26, 3
    s_lshl_b32 s26, s26, 7
    s_add_u32 s26, s26, s3
    s_mov_b64 exec, 0xff
    s_mov_b32 s27, 0x20000
    buffer_load_dword v12, v6, s[40:43], s26 offen sc1
    s_sleep 3
    buffer_load_dword v13, v6, s[40:43], s26 offen sc1
L_poll_3:
    s_sleep 3
    buffer_load_dword v14, v6, s[40:43], s26 offen sc1
    s_waitcnt vmcnt(2)
    v_cmp_eq_u32 vcc, s94, v12
    s_nop 1
    s_cmp_eq_u64 vcc, exec
    s_cbranch_scc1 L_polld_4
    s_sleep 3
    buffer_load_dword v12, v6, s[40:43], s26 offen sc1
    s_waitcnt vmcnt(2)
    v_cmp_eq_u32 vcc, s94, v13
    s_nop 1
    s_cmp_eq_u64 vcc, exec
    s_cbranch_scc1 L_polld_4
    s_sleep 3
    buffer_load_dword v13, v6, s[40:43], s26 offen sc1
    s_waitcnt vmcnt(2)
    v_cmp_eq_u32 vcc, s94, v14
    s_nop 1
    s_cmp_eq_u64 vcc, exec
    s_cbranch_scc1 L_polld_4
    s_sub_u32 s27, s27, 1
    s_cbranch_scc0 L_poll_3
L_polld_4:
    s_mov_b64 exec, -1
    s_barrier
    s_add_u32 s26, s97, 2
    s_and_b32 s26, s26, 3
    s_lshl_b32 s26, s26, 7
    s_add_u32 s26, s26, s3
    s_mov_b64 exec, 0xff
    s_mov_b32 s27, 0x40000
L_poll_5:
    buffer_load_dword v3, v6, s[40:43], s26 offen sc1
    s_waitcnt vmcnt(0)
    v_cmp_eq_u32 vcc, s94, v3
    s_nop 1
    s_cmp_eq_u64 vcc, exec
    s_cbranch_scc1 L_polld_6
    s_sleep 1
    s_sub_u32 s27, s27, 1
    s_cbranch_scc0 L_poll_5
L_polld_6:
    s_mov_b64 exec, -1
    s_barrier
    s_add_u32 s26, s97, 3
    s_and_b32 s26, s26, 3
    s_lshl_b32 s26, s26, 7
    s_add_u32 s26, s26, s3
    s_mov_b64 exec, 0xff
    s_mov_b32 s27, 0x40000
L_poll_7:
    buffer_load_dword v3, v6, s[40:43], s26 offen sc1
    s_waitcnt vmcnt(0)
    v_cmp_eq_u32 vcc, s94, v3
    s_nop 1
    s_cmp_eq_u64 vcc, exec
    s_cbranch_scc1 L_polld_8
    s_sleep 1
    s_sub_u32 s27, s27, 1
    s_cbranch_scc0 L_poll_7
L_polld_8:
    s_mov_b64 exec, -1
    s_barrier
    s_add_u32 s26, s97, 4
    s_and_b32 s26, s26, 3
    s_lshl_b32 s26, s26, 7
    s_add_u32 s26, s26, s3
    s_mov_b64 exec, 0xff
    s_mov_b32 s27, 0x40000
L_poll_9:
    buffer_load_dword v3, v6, s[40:43], s26 offen sc1
    s_waitcnt vmcnt(0)
    v_cmp_eq_u32 vcc, s94, v3
    s_nop 1
    s_cmp_eq_u64 vcc, exec
    s_cbranch_scc1 L_polld_10
    s_sleep 1
    s_sub_u32 s27, s27, 1
    s_cbranch_scc0 L_poll_9
L_polld_10:
    s_mov_b64 exec, -1
    s_barrier
    v_mov_b32 v8, 0
    s_lshl_b32 s3, s96, 2
    s_add_u32 s3, s3, s97
    s_lshl_b32 s3, s3, 5
    s_add_u32 s3, s3, s98
    s_lshl_b32 s3, s3, 2
    s_add_u32 s3, s3, 9531392
    s_barrier
    s_mov_b64 exec, 1
    buffer_store_dword v5, v8, s[40:43], s3 offen sc1
    s_cmp_lg_u32 s63, 0
    s_cbranch_scc1 L_noepw
    s_mov_b64 exec, -1
    v_and_b32 v9, 7, v1
    v_min_u32 v9, 6, v9
    v_lshlrev_b32 v9, 2, v9
    v_lshrrev_b32 v10, 3, v1
    v_lshl_add_u32 v9, v10, 7, v9
    s_mov_b32 s27, 0x40000
    s_mov_b32 s3, 9519120
L_epl:
    buffer_load_dword v12, v9, s[40:43], s3 offen offset:0 sc1
    buffer_load_dword v13, v9, s[40:43], s3 offen offset:1024 sc1
    buffer_load_dword v14, v9, s[40:43], s3 offen offset:2048 sc1
    buffer_load_dword v15, v9, s[40:43], s3 offen offset:3072 sc1
    s_waitcnt vmcnt(0)
    v_xor_b32 v12, s94, v12
    v_xor_b32 v13, s94, v13
    v_xor_b32 v14, s94, v14
    v_xor_b32 v15, s94, v15
    v_or3_b32 v12, v12, v13, v14
    v_or_b32 v12, v12, v15
    v_cmp_eq_u32 vcc, 0, v12
    s_nop 1
    s_cmp_eq_u64 vcc, exec
    s_cbranch_scc1 L_epok
    s_sleep 2
    s_sub_u32 s27, s27, 1
    s_cbranch_scc0 L_epl
L_epok:
    s_mov_b32 s3, 9535488
    s_mov_b64 exec, 1
    buffer_store_dword v5, v8, s[40:43], s3 offen sc1
L_noepw:
L_end:
    s_endpgm
L_code_end:
.section .rodata,"a"
.p2align 6
.amdhsa_kernel parallel_sum__spectral_fnet__dense_activation_relu__prompt_kernel
  .amdhsa_next_free_vgpr 256
  .amdhsa_next_free_sgpr 102
  .amdhsa_accum_offset 256
  .amdhsa_group_segment_fixed_size 0
  .amdhsa_kernarg_size 88
  .amdhsa_user_sgpr_count 2
  .amdhsa_user_sgpr_kernarg_segment_ptr 1
  .amdhsa_system_sgpr_workgroup_id_x 1
.end_amdhsa_kernel
```
